```python
import torch

def _softmax(x, axis=-1):
    return torch.softmax(x, dim=axis)
def _gelu(x):
    return torch.nn.functional.gelu(x, approximate="tanh")
def _silu(x):
    return torch.nn.functional.silu(x)
def _sigmoid(x):
    return torch.sigmoid(x)
def _layernorm(x, axis=-1, eps=1e-5):
    m = x.mean(dim=axis, keepdim=True)
    v = x.var(dim=axis, keepdim=True, unbiased=False)
    return (x - m) / torch.sqrt(v + eps)
def _scatter_add(tgt, idx, src, axis=0):
    return tgt.clone().index_add_(axis, idx, src)
def _segment_sum(src, seg, n):
    out = torch.zeros((n,) + src.shape[1:], dtype=src.dtype)
    return out.index_add_(0, seg, src)
def _pad(x, pw):
    flat = tuple(v for pair in reversed(pw) for v in pair)
    return torch.nn.functional.pad(x, flat)

kernel_name = 'concat_heads__ssm_conv_s5__softmax_full_mha__prompt'

def setup_inputs():

    _w = (lambda a: (lambda t: t.to(torch.bfloat16) if t.is_floating_point() else t)(torch.as_tensor(a)))
    def _A_setup():
        B, S, D = 1, 2048, 640
        P = D
        Lambda_re = -0.5 * (lambda _x: torch.exp(torch.as_tensor(_x)))((lambda *s: torch.randn(*s, dtype=torch.bfloat16) * 0.8)(P))
        Lambda_im = (lambda *s: torch.randn(*s, dtype=torch.bfloat16) * 0.8)(P) * 1.0
        B_re = (lambda *s: torch.randn(*s, dtype=torch.bfloat16) * 0.8)(P, D) * (D ** -0.5)
        B_im = (lambda *s: torch.randn(*s, dtype=torch.bfloat16) * 0.8)(P, D) * (D ** -0.5)
        C_re = (lambda *s: torch.randn(*s, dtype=torch.bfloat16) * 0.8)(D, P) * (P ** -0.5)
        C_im = (lambda *s: torch.randn(*s, dtype=torch.bfloat16) * 0.8)(D, P) * (P ** -0.5)
        log_dt = (lambda *s: torch.randn(*s, dtype=torch.bfloat16) * 0.8)(P) * 0.3 - 2.0
        Dskip = (lambda *s: torch.randn(*s, dtype=torch.bfloat16) * 0.8)(D)
        return {
            "x": _w((lambda *s: torch.randn(*s, dtype=torch.bfloat16) * 0.05)(B, S, D)),
            "Lambda_re": _w(Lambda_re),
            "Lambda_im": _w(Lambda_im),
            "B_re": _w(B_re),
            "B_im": _w(B_im),
            "C_re": _w(C_re),
            "C_im": _w(C_im),
            "log_dt": _w(log_dt),
            "Dskip": _w(Dskip),
        }
    _A_in = _A_setup()

    def _B_setup():
        B, S, D = 1, 2048, 640
        return {
            "x": _w((lambda *s: torch.randn(*s, dtype=torch.bfloat16) * 0.2)(B, S, D)),
            "wqkv": _w((lambda *s: torch.randn(*s, dtype=torch.bfloat16) * 0.2)(D, 3 * D)),
            "wo": _w((lambda *s: torch.randn(*s, dtype=torch.bfloat16) * 0.05)(D, D)),
        }
    _B_in = _B_setup()

    return {
        "A_x": _A_in["x"],
        "A_Lambda_re": _A_in["Lambda_re"],
        "A_Lambda_im": _A_in["Lambda_im"],
        "A_B_re": _A_in["B_re"],
        "A_B_im": _A_in["B_im"],
        "A_C_re": _A_in["C_re"],
        "A_C_im": _A_in["C_im"],
        "A_log_dt": _A_in["log_dt"],
        "A_Dskip": _A_in["Dskip"],
        "B_x": _B_in["x"],
        "B_wqkv": _B_in["wqkv"],
        "B_wo": _B_in["wo"],
    }

def reference(A_x, A_Lambda_re, A_Lambda_im, A_B_re, A_B_im, A_C_re, A_C_im, A_log_dt, A_Dskip, B_x, B_wqkv, B_wo):
    def _A_ref(x, Lambda_re, Lambda_im, B_re, B_im, C_re, C_im, log_dt, Dskip):
        Bsz, L, H = x.shape
        Lam = Lambda_re + 1j * Lambda_im
        Bmat = B_re + 1j * B_im
        Cmat = C_re + 1j * C_im
        dt = torch.exp(log_dt)
        Lam_bar = torch.exp(dt * Lam)
        B_bar = ((Lam_bar - 1.0) / Lam)[:, None] * Bmat
        Bu = torch.einsum("bld,pd->blp", x + 0j, B_bar)
        h = torch.zeros_like(Bu[:, 0, :])
        hs = []
        for t in range(L):
            h = Lam_bar[None, :] * h + Bu[:, t, :]
            hs.append(h)
        hseq = torch.stack(hs, 1)
        y = 2.0 * torch.einsum("blp,dp->bld", hseq, Cmat).real + x * Dskip[None, None, :]
        return y

    def _B_ref(x, wqkv, wo):
        B, S, D = x.shape
        H = 32; Dh = D // H
        qkv = (lambda x, *d: x.permute(*d))((x @ wqkv).reshape(B, S, 3, H, Dh), 2, 0, 3, 1, 4)
        q, k, v = qkv[0], qkv[1], qkv[2]
        scale = Dh ** -0.5
        scores = torch.einsum("bhqd,bhkd->bhqk", q, k) * scale
        p = _softmax(scores, axis=-1)
        o = torch.einsum("bhqk,bhkd->bhqd", p, v)
        return (lambda x, *d: x.permute(*d))(o, 0, 2, 1, 3).reshape(B, S, D) @ wo

    a = _A_ref(A_x, A_Lambda_re, A_Lambda_im, A_B_re, A_B_im, A_C_re, A_C_im, A_log_dt, A_Dskip)
    b = _B_ref(B_x, B_wqkv, B_wo)
    return torch.concatenate([a, b], axis=-1)
```

```asm
; @launch grid=(256,1,1) block=(512,1,1) lds=163840
.amdgcn_target "amdgcn-amd-amdhsa--gfx950"
.text
.globl concat_heads__ssm_conv_s5__softmax_full_mha__prompt_kernel
.p2align 8
.type concat_heads__ssm_conv_s5__softmax_full_mha__prompt_kernel,@function
concat_heads__ssm_conv_s5__softmax_full_mha__prompt_kernel:
  s_cmp_ge_u32 s2, 256
  s_cbranch_scc1 L_exit
  s_load_dwordx16 s[32:47], s[0:1], 0
  s_load_dwordx8 s[48:55], s[0:1], 64
  s_load_dwordx4 s[56:59], s[0:1], 96
  s_load_dwordx2 s[60:61], s[0:1], 112
  s_add_u32 s2, s2, 128
  s_and_b32 s2, s2, 255
  v_lshrrev_b32 v1, 6, v0
  s_nop 0
  v_readfirstlane_b32 s20, v1
  v_and_b32 v1, 63, v0
  s_lshr_b32 s21, s20, 1
  s_and_b32 s22, s20, 1
  s_and_b32 s31, s2, 6
  s_bfe_u32 s25, s2, 0x10003
  s_add_u32 s31, s31, s25
  s_lshr_b32 s29, s2, 4
  s_and_b32 s26, s2, 1
  s_cmp_ge_u32 s29, 13
  s_cbranch_scc1 L_idle
  s_cmp_ge_u32 s29, 8
  s_cbranch_scc1 L_r1
  s_lshl_b32 s30, s26, 3
  s_add_u32 s30, s30, s29
  s_cmp_eq_u32 s30, 15
  s_cbranch_scc1 L_idle
  s_branch L_qkv
L_r1:
  s_mul_i32 s30, s26, 5
  s_add_u32 s30, s30, s29
  s_sub_u32 s30, s30, 8
L_ssm1:
  s_sub_u32 s64, s29, 8
  s_lshl_b32 s64, s64, 1
  s_and_b32 s25, s31, 1
  s_mul_i32 s25, s25, 5
  s_add_u32 s64, s64, s25
  s_bfe_u32 s25, s2, 0x20001
  s_add_u32 s64, s64, s25
  s_lshr_b32 s25, s25, 1
  s_add_u32 s64, s64, s25
  s_and_b32 s25, s2, 1
  s_add_u32 s64, s64, s25
  s_cmp_ge_u32 s64, 10
  s_cselect_b32 s25, 10, 0
  s_sub_u32 s64, s64, s25
  s_lshl_b32 s23, s31, 8
  s_lshl_b32 s24, s30, 6
  s_lshr_b32 s25, s21, 1
  s_lshl_b32 s25, s25, 5
  s_add_u32 s24, s24, s25
  s_lshl_b32 s25, s22, 4
  s_add_u32 s24, s24, s25
  v_lshrrev_b32 v7, 4, v1
  v_xor_b32 v7, v7, v1
  v_and_b32 v7, 7, v7
  v_lshlrev_b32 v7, 4, v7
  v_lshrrev_b32 v6, 3, v1
  v_add_u32 v4, s24, v6
  v_mul_u32_u24 v4, 1280, v4
  v_add_u32 v4, v4, v7
  v_xor_b32 v5, 64, v4
  s_mul_i32 s25, s20, 32
  s_add_u32 s25, s25, s23
  v_add_u32 v6, s25, v6
  v_mul_u32_u24 v6, 1280, v6
  v_add_u32 v2, v6, v7
  v_xor_b32 v3, 64, v2
  s_mul_i32 s27, s20, 4096
  s_mul_i32 s28, s20, 2048
  s_mul_i32 s66, s64, 128
  s_mul_i32 s65, s64, 128
  s_waitcnt lgkmcnt(0)
  s_mov_b32 s4, s32
  s_and_b32 s5, s33, 0xffff
  s_mov_b32 s6, 2621440
  s_mov_b32 s7, 0x00020000
  s_bitcmp0_b32 s21, 0
  s_cselect_b32 s8, s38, s40
  s_cselect_b32 s9, s39, s41
  s_and_b32 s9, s9, 0xffff
  s_mov_b32 s10, 819200
  s_mov_b32 s11, 0x00020000
  s_mov_b32 s12, s60
  s_and_b32 s13, s61, 0xffff
  s_mov_b32 s14, 268435456
  s_mov_b32 s15, 0x00020000
  s_mov_b32 s16, s50
  s_and_b32 s17, s51, 0xffff
  s_mov_b32 s18, 2621440
  s_mov_b32 s19, 0x00020000
  s_mov_b32 s72, s52
  s_and_b32 s73, s53, 0xffff
  s_mov_b32 s74, 2457600
  s_mov_b32 s75, 0x00020000
  s_bfe_u32 s25, s2, 0x20001
  s_lshl_b32 s25, s25, 9
  v_add_u32 v164, s25, v1
  v_mul_u32_u24 v164, 1280, v164
  v_lshrrev_b32 v165, 4, v1
  v_mul_u32_u24 v165, 3840, v165
  v_and_b32 v166, 15, v1
  v_lshl_add_u32 v165, v166, 7, v165
  s_and_b32 s25, s2, 1
  s_mul_i32 s25, s25, 1792
  v_add_u32 v165, s25, v165
  s_lshr_b32 s62, s2, 3
  s_sub_u32 s62, s62, 16
  s_mul_i32 s25, s20, 10
  s_add_u32 s62, s62, s25
  s_add_u32 s62, s62, 0
L_tl0:

  s_cmp_ge_u32 s62, 48
  s_cbranch_scc1 L_te0
  s_mul_i32 s25, s62, 2731
  s_lshr_b32 s25, s25, 16
  s_mul_i32 s26, s25, 24
  s_sub_u32 s26, s62, s26
  s_add_u32 s62, s62, 80
  s_cmp_ge_u32 s26, 8
  s_cbranch_scc1 L_tw0
  s_lshl_b32 s25, s25, 7
  s_mul_i32 s26, s26, 81920
  s_add_u32 s25, s25, s26
  buffer_load_dword v167, v164, s[16:19], s25 offen
  s_branch L_tl0
L_tw0:
  s_lshl_b32 s25, s25, 4
  s_add_u32 s25, s25, s26
  s_sub_u32 s25, s25, 8
  s_mul_i32 s25, s25, 15360
  buffer_load_dword v167, v165, s[72:75], s25 offen
  s_branch L_tl0
L_te0:
  s_add_u32 m0, s27, 0
  s_add_u32 s25, s65, 0
  buffer_load_dwordx4 v2, s[4:7], s25 offen  lds
  s_add_u32 m0, s27, 1024
  s_add_u32 s25, s65, 10240
  buffer_load_dwordx4 v3, s[4:7], s25 offen  lds
  s_add_u32 m0, s27, 2048
  s_add_u32 s25, s65, 20480
  buffer_load_dwordx4 v2, s[4:7], s25 offen  lds
  s_add_u32 m0, s27, 3072
  s_add_u32 s25, s65, 30720
  buffer_load_dwordx4 v3, s[4:7], s25 offen  lds
  s_add_u32 s65, s65, 128
  s_cmp_eq_u32 s65, 1280
  s_cselect_b32 s65, 0, s65
  s_add_u32 m0, s28, 32768
  s_add_u32 s25, s66, 0
  buffer_load_dwordx4 v4, s[8:11], s25 offen  lds
  s_add_u32 m0, s28, 33792
  s_add_u32 s25, s66, 10240
  buffer_load_dwordx4 v5, s[8:11], s25 offen  lds
  s_add_u32 s66, s66, 128
  s_cmp_eq_u32 s66, 1280
  s_cselect_b32 s66, 0, s66
  v_and_b32 v128, 31, v1
  s_lshl_b32 s25, s30, 6
  s_lshl_b32 s26, s22, 5
  s_add_u32 s25, s25, s26
  v_add_u32 v128, s25, v128
  v_lshlrev_b32 v6, 1, v128
  s_mov_b32 s68, s34
  s_and_b32 s69, s35, 0xffff
  s_mov_b32 s70, 1280
  s_mov_b32 s71, 0x00020000
  buffer_load_ushort v129, v6, s[68:71], 0 offen
  s_mov_b32 s68, s36
  s_and_b32 s69, s37, 0xffff
  s_mov_b32 s70, 1280
  s_mov_b32 s71, 0x00020000
  buffer_load_ushort v130, v6, s[68:71], 0 offen
  s_mov_b32 s68, s46
  s_and_b32 s69, s47, 0xffff
  s_mov_b32 s70, 1280
  s_mov_b32 s71, 0x00020000
  buffer_load_ushort v131, v6, s[68:71], 0 offen
  s_add_u32 m0, s27, 49152
  s_add_u32 s25, s65, 0
  buffer_load_dwordx4 v2, s[4:7], s25 offen  lds
  s_add_u32 m0, s27, 50176
  s_add_u32 s25, s65, 10240
  buffer_load_dwordx4 v3, s[4:7], s25 offen  lds
  s_add_u32 m0, s27, 51200
  s_add_u32 s25, s65, 20480
  buffer_load_dwordx4 v2, s[4:7], s25 offen  lds
  v_and_b32 v6, 31, v1
  v_lshrrev_b32 v9, 5, v1
  v_bfe_u32 v7, v6, 2, 1
  v_lshlrev_b32 v7, 5, v7
  v_and_b32 v8, 3, v6
  v_or_b32 v7, v7, v8
  v_lshrrev_b32 v8, 3, v6
  v_lshl_add_u32 v7, v8, 2, v7
  v_bfe_u32 v8, v7, 1, 3
  v_xor_b32 v8, v8, v9
  v_lshlrev_b32 v8, 4, v8
  v_lshl_add_u32 v8, v7, 7, v8
  s_mul_i32 s25, s21, 8192
  v_add_u32 v8, s25, v8
  v_xor_b32 v9, 32, v8
  v_xor_b32 v10, 64, v8
  v_xor_b32 v11, 96, v8
  v_add_u32 v12, 0x10000, v8
  v_add_u32 v13, 0x10000, v9
  v_add_u32 v14, 0x10000, v10
  v_add_u32 v15, 0x10000, v11
  v_add_u32 v16, 0x20000, v8
  v_add_u32 v17, 0x20000, v9
  v_add_u32 v18, 0x20000, v10
  v_add_u32 v19, 0x20000, v11
  v_and_b32 v6, 31, v1
  v_bfe_u32 v20, v6, 1, 3
  v_lshrrev_b32 v7, 5, v1
  v_xor_b32 v20, v20, v7
  v_lshlrev_b32 v20, 4, v20
  v_lshl_add_u32 v20, v6, 7, v20
  s_mul_i32 s25, s22, 8192
  v_add_u32 v20, s25, v20
  v_xor_b32 v21, 32, v20
  v_xor_b32 v22, 64, v20
  v_xor_b32 v23, 96, v20
  v_add_u32 v24, 0x10000, v20
  v_add_u32 v25, 0x10000, v21
  v_add_u32 v26, 0x10000, v22
  v_add_u32 v27, 0x10000, v23
  v_add_u32 v28, 0x20000, v20
  v_add_u32 v29, 0x20000, v21
  v_add_u32 v30, 0x20000, v22
  v_add_u32 v31, 0x20000, v23
  s_waitcnt vmcnt(6)
  s_barrier
  ds_read_b128 v[32:35], v8 offset:0
  ds_read_b128 v[36:39], v8 offset:2048
  ds_read_b128 v[40:43], v20 offset:32768
  ds_read_b128 v[44:47], v20 offset:36864
  ds_read_b128 v[48:51], v9 offset:0
  ds_read_b128 v[52:55], v9 offset:2048
  ds_read_b128 v[56:59], v21 offset:32768
  ds_read_b128 v[60:63], v21 offset:36864
  s_waitcnt lgkmcnt(4)
  v_mfma_f32_32x32x16_bf16 v[168:183], v[32:35], v[40:43], 0
  ds_read_b128 v[144:147], v10 offset:0
  ds_read_b128 v[148:151], v10 offset:2048
  v_mfma_f32_32x32x16_bf16 v[184:199], v[32:35], v[44:47], 0
  ds_read_b128 v[152:155], v22 offset:32768
  ds_read_b128 v[156:159], v22 offset:36864
  v_mfma_f32_32x32x16_bf16 v[200:215], v[36:39], v[40:43], 0
  s_add_u32 m0, s27, 52224
  s_add_u32 s25, s65, 30720
  buffer_load_dwordx4 v3, s[4:7], s25 offen  lds
  s_add_u32 s65, s65, 128
  s_cmp_eq_u32 s65, 1280
  s_cselect_b32 s65, 0, s65
  s_add_u32 m0, s28, 81920
  s_add_u32 s25, s66, 0
  buffer_load_dwordx4 v4, s[8:11], s25 offen  lds
  v_mfma_f32_32x32x16_bf16 v[216:231], v[36:39], v[44:47], 0
  s_add_u32 m0, s28, 82944
  s_add_u32 s25, s66, 10240
  buffer_load_dwordx4 v5, s[8:11], s25 offen  lds
  s_add_u32 s66, s66, 128
  s_cmp_eq_u32 s66, 1280
  s_cselect_b32 s66, 0, s66
  s_waitcnt lgkmcnt(4)
  v_mfma_f32_32x32x16_bf16 v[168:183], v[48:51], v[56:59], v[168:183]
  ds_read_b128 v[32:35], v11 offset:0
  ds_read_b128 v[36:39], v11 offset:2048
  v_mfma_f32_32x32x16_bf16 v[184:199], v[48:51], v[60:63], v[184:199]
  ds_read_b128 v[40:43], v23 offset:32768
  ds_read_b128 v[44:47], v23 offset:36864
  v_mfma_f32_32x32x16_bf16 v[200:215], v[52:55], v[56:59], v[200:215]
  s_add_u32 m0, s27, 98304
  s_add_u32 s25, s65, 0
  buffer_load_dwordx4 v2, s[4:7], s25 offen  lds
  s_add_u32 m0, s27, 99328
  s_add_u32 s25, s65, 10240
  buffer_load_dwordx4 v3, s[4:7], s25 offen  lds
  v_mfma_f32_32x32x16_bf16 v[216:231], v[52:55], v[60:63], v[216:231]
  s_add_u32 m0, s27, 100352
  s_add_u32 s25, s65, 20480
  buffer_load_dwordx4 v2, s[4:7], s25 offen  lds
  s_waitcnt vmcnt(3) lgkmcnt(0)
  s_barrier
  v_mfma_f32_32x32x16_bf16 v[168:183], v[144:147], v[152:155], v[168:183]
  ds_read_b128 v[48:51], v8 offset:49152
  ds_read_b128 v[52:55], v8 offset:51200
  v_mfma_f32_32x32x16_bf16 v[184:199], v[144:147], v[156:159], v[184:199]
  ds_read_b128 v[56:59], v24 offset:16384
  ds_read_b128 v[60:63], v24 offset:20480
  v_mfma_f32_32x32x16_bf16 v[200:215], v[148:151], v[152:155], v[200:215]
  s_add_u32 m0, s27, 101376
  s_add_u32 s25, s65, 30720
  buffer_load_dwordx4 v3, s[4:7], s25 offen  lds
  s_add_u32 s65, s65, 128
  s_cmp_eq_u32 s65, 1280
  s_cselect_b32 s65, 0, s65
  s_add_u32 m0, s28, 131072
  s_add_u32 s25, s66, 0
  buffer_load_dwordx4 v4, s[8:11], s25 offen  lds
  v_mfma_f32_32x32x16_bf16 v[216:231], v[148:151], v[156:159], v[216:231]
  s_add_u32 m0, s28, 132096
  s_add_u32 s25, s66, 10240
  buffer_load_dwordx4 v5, s[8:11], s25 offen  lds
  s_add_u32 s66, s66, 128
  s_cmp_eq_u32 s66, 1280
  s_cselect_b32 s66, 0, s66
  s_waitcnt lgkmcnt(4)
  v_mfma_f32_32x32x16_bf16 v[168:183], v[32:35], v[40:43], v[168:183]
  ds_read_b128 v[144:147], v9 offset:49152
  ds_read_b128 v[148:151], v9 offset:51200
  v_mfma_f32_32x32x16_bf16 v[184:199], v[32:35], v[44:47], v[184:199]
  ds_read_b128 v[152:155], v25 offset:16384
  ds_read_b128 v[156:159], v25 offset:20480
  v_mfma_f32_32x32x16_bf16 v[200:215], v[36:39], v[40:43], v[200:215]
  s_add_u32 m0, s27, 0
  s_add_u32 s25, s65, 0
  buffer_load_dwordx4 v2, s[4:7], s25 offen  lds
  s_add_u32 m0, s27, 1024
  s_add_u32 s25, s65, 10240
  buffer_load_dwordx4 v3, s[4:7], s25 offen  lds
  v_mfma_f32_32x32x16_bf16 v[216:231], v[36:39], v[44:47], v[216:231]
  s_add_u32 m0, s27, 2048
  s_add_u32 s25, s65, 20480
  buffer_load_dwordx4 v2, s[4:7], s25 offen  lds
  v_lshlrev_b32 v129, 16, v129
  v_lshlrev_b32 v130, 16, v130
  v_lshlrev_b32 v131, 16, v131
  v_mul_f32 v131, 0x3fb8aa3b, v131
  v_exp_f32 v131, v131
  s_nop 0
  v_cvt_pk_bf16_f32 v131, v131, v131
  v_lshlrev_b32 v131, 16, v131
  v_mul_f32 v6, v131, v129
  v_mul_f32 v7, v131, v130
  v_mul_f32 v6, 0x3fb8aa3b, v6
  v_exp_f32 v6, v6
  v_mul_f32 v7, 0.15915494, v7
  v_rndne_f32 v232, v7
  v_sub_f32 v7, v7, v232
  v_cos_f32 v232, v7
  v_sin_f32 v233, v7
  s_nop 0
  v_mul_f32 v232, v232, v6
  v_mul_f32 v233, v233, v6
  v_mul_f32 v6, v129, v129
  v_fma_f32 v6, v130, v130, v6
  v_rcp_f32 v6, v6
  v_add_f32 v7, -1.0, v232
  v_add_f32 v6, v6, v6
  v_mul_f32 v234, v7, v129
  v_fma_f32 v234, v233, v130, v234
  v_mul_f32 v235, v233, v129
  v_fma_f32 v235, -v7, v130, v235
  v_mul_f32 v234, v234, v6
  v_mul_f32 v235, v235, v6
  v_mov_b32 v136, v232
  v_mov_b32 v137, v233
  v_mul_f32 v6, v136, v136
  v_fma_f32 v6, -v137, v137, v6
  v_mul_f32 v7, v136, v137
  v_fma_f32 v137, v137, v136, v7
  v_mov_b32 v136, v6
  v_mul_f32 v6, v136, v136
  v_fma_f32 v6, -v137, v137, v6
  v_mul_f32 v7, v136, v137
  v_fma_f32 v137, v137, v136, v7
  v_mov_b32 v136, v6
  v_mul_f32 v6, v136, v136
  v_fma_f32 v6, -v137, v137, v6
  v_mul_f32 v7, v136, v137
  v_fma_f32 v137, v137, v136, v7
  v_mov_b32 v136, v6
  v_mul_f32 v6, v136, v136
  v_fma_f32 v6, -v137, v137, v6
  v_mul_f32 v7, v136, v137
  v_fma_f32 v137, v137, v136, v7
  v_mov_b32 v136, v6
  v_mov_b32 v244, v234
  v_mov_b32 v245, v234
  v_mov_b32 v246, v235
  v_mov_b32 v247, v235
  v_mul_f32 v6, v136, v136
  v_fma_f32 v6, -v137, v137, v6
  v_mul_f32 v7, v136, v137
  v_fma_f32 v137, v137, v136, v7
  v_mov_b32 v136, v6
  v_mul_f32 v6, v136, v136
  v_fma_f32 v6, -v137, v137, v6
  v_mul_f32 v7, v136, v137
  v_fma_f32 v237, v137, v136, v7
  v_mov_b32 v236, v6
  v_mul_f32 v6, v236, v236
  v_fma_f32 v6, -v237, v237, v6
  v_mul_f32 v7, v236, v237
  v_fma_f32 v237, v237, v236, v7
  v_mov_b32 v236, v6
  v_mul_f32 v6, v236, v236
  v_fma_f32 v6, -v237, v237, v6
  v_mul_f32 v7, v236, v237
  v_fma_f32 v237, v237, v236, v7
  v_mov_b32 v236, v6
  s_waitcnt lgkmcnt(4)
  v_mfma_f32_32x32x16_bf16 v[168:183], v[48:51], v[56:59], v[168:183]
  ds_read_b128 v[32:35], v10 offset:49152
  ds_read_b128 v[36:39], v10 offset:51200
  v_mfma_f32_32x32x16_bf16 v[184:199], v[48:51], v[60:63], v[184:199]
  ds_read_b128 v[40:43], v26 offset:16384
  ds_read_b128 v[44:47], v26 offset:20480
  v_mfma_f32_32x32x16_bf16 v[200:215], v[52:55], v[56:59], v[200:215]
  s_add_u32 m0, s27, 3072
  s_add_u32 s25, s65, 30720
  buffer_load_dwordx4 v3, s[4:7], s25 offen  lds
  s_add_u32 s65, s65, 128
  s_cmp_eq_u32 s65, 1280
  s_cselect_b32 s65, 0, s65
  s_add_u32 m0, s28, 32768
  s_add_u32 s25, s66, 0
  buffer_load_dwordx4 v4, s[8:11], s25 offen  lds
  v_mfma_f32_32x32x16_bf16 v[216:231], v[52:55], v[60:63], v[216:231]
  s_add_u32 m0, s28, 33792
  s_add_u32 s25, s66, 10240
  buffer_load_dwordx4 v5, s[8:11], s25 offen  lds
  s_add_u32 s66, s66, 128
  s_cmp_eq_u32 s66, 1280
  s_cselect_b32 s66, 0, s66
  s_waitcnt lgkmcnt(4)
  v_mfma_f32_32x32x16_bf16 v[168:183], v[144:147], v[152:155], v[168:183]
  ds_read_b128 v[48:51], v11 offset:49152
  ds_read_b128 v[52:55], v11 offset:51200
  v_mfma_f32_32x32x16_bf16 v[184:199], v[144:147], v[156:159], v[184:199]
  ds_read_b128 v[56:59], v27 offset:16384
  ds_read_b128 v[60:63], v27 offset:20480
  v_mfma_f32_32x32x16_bf16 v[200:215], v[148:151], v[152:155], v[200:215]
  v_mfma_f32_32x32x16_bf16 v[216:231], v[148:151], v[156:159], v[216:231]
  s_waitcnt vmcnt(6) lgkmcnt(0)
  s_barrier
  v_mfma_f32_32x32x16_bf16 v[168:183], v[32:35], v[40:43], v[168:183]
  ds_read_b128 v[144:147], v12 offset:32768
  ds_read_b128 v[148:151], v12 offset:34816
  v_mfma_f32_32x32x16_bf16 v[184:199], v[32:35], v[44:47], v[184:199]
  ds_read_b128 v[152:155], v28 offset:0
  ds_read_b128 v[156:159], v28 offset:4096
  v_mfma_f32_32x32x16_bf16 v[200:215], v[36:39], v[40:43], v[200:215]
  s_add_u32 m0, s27, 49152
  s_add_u32 s25, s65, 0
  buffer_load_dwordx4 v2, s[4:7], s25 offen  lds
  s_add_u32 m0, s27, 50176
  s_add_u32 s25, s65, 10240
  buffer_load_dwordx4 v3, s[4:7], s25 offen  lds
  v_mfma_f32_32x32x16_bf16 v[216:231], v[36:39], v[44:47], v[216:231]
  s_add_u32 m0, s27, 51200
  s_add_u32 s25, s65, 20480
  buffer_load_dwordx4 v2, s[4:7], s25 offen  lds
  s_waitcnt lgkmcnt(4)
  v_mfma_f32_32x32x16_bf16 v[168:183], v[48:51], v[56:59], v[168:183]
  ds_read_b128 v[32:35], v13 offset:32768
  ds_read_b128 v[36:39], v13 offset:34816
  v_mfma_f32_32x32x16_bf16 v[184:199], v[48:51], v[60:63], v[184:199]
  ds_read_b128 v[40:43], v29 offset:0
  ds_read_b128 v[44:47], v29 offset:4096
  v_mfma_f32_32x32x16_bf16 v[200:215], v[52:55], v[56:59], v[200:215]
  s_add_u32 m0, s27, 52224
  s_add_u32 s25, s65, 30720
  buffer_load_dwordx4 v3, s[4:7], s25 offen  lds
  s_add_u32 s65, s65, 128
  s_cmp_eq_u32 s65, 1280
  s_cselect_b32 s65, 0, s65
  s_add_u32 m0, s28, 81920
  s_add_u32 s25, s66, 0
  buffer_load_dwordx4 v4, s[8:11], s25 offen  lds
  v_mfma_f32_32x32x16_bf16 v[216:231], v[52:55], v[60:63], v[216:231]
  s_add_u32 m0, s28, 82944
  s_add_u32 s25, s66, 10240
  buffer_load_dwordx4 v5, s[8:11], s25 offen  lds
  s_add_u32 s66, s66, 128
  s_cmp_eq_u32 s66, 1280
  s_cselect_b32 s66, 0, s66
  s_waitcnt lgkmcnt(4)
  v_mfma_f32_32x32x16_bf16 v[168:183], v[144:147], v[152:155], v[168:183]
  ds_read_b128 v[48:51], v14 offset:32768
  ds_read_b128 v[52:55], v14 offset:34816
  v_mfma_f32_32x32x16_bf16 v[184:199], v[144:147], v[156:159], v[184:199]
  ds_read_b128 v[56:59], v30 offset:0
  ds_read_b128 v[60:63], v30 offset:4096
  v_mfma_f32_32x32x16_bf16 v[200:215], v[148:151], v[152:155], v[200:215]
  v_mfma_f32_32x32x16_bf16 v[216:231], v[148:151], v[156:159], v[216:231]
  s_waitcnt lgkmcnt(4)
  v_mfma_f32_32x32x16_bf16 v[168:183], v[32:35], v[40:43], v[168:183]
  ds_read_b128 v[144:147], v15 offset:32768
  ds_read_b128 v[148:151], v15 offset:34816
  v_mfma_f32_32x32x16_bf16 v[184:199], v[32:35], v[44:47], v[184:199]
  ds_read_b128 v[152:155], v31 offset:0
  ds_read_b128 v[156:159], v31 offset:4096
  v_mfma_f32_32x32x16_bf16 v[200:215], v[36:39], v[40:43], v[200:215]
  v_mfma_f32_32x32x16_bf16 v[216:231], v[36:39], v[44:47], v[216:231]
  s_waitcnt vmcnt(6) lgkmcnt(0)
  s_barrier
  v_mfma_f32_32x32x16_bf16 v[168:183], v[48:51], v[56:59], v[168:183]
  ds_read_b128 v[32:35], v8 offset:0
  ds_read_b128 v[36:39], v8 offset:2048
  v_mfma_f32_32x32x16_bf16 v[184:199], v[48:51], v[60:63], v[184:199]
  ds_read_b128 v[40:43], v20 offset:32768
  ds_read_b128 v[44:47], v20 offset:36864
  v_mfma_f32_32x32x16_bf16 v[200:215], v[52:55], v[56:59], v[200:215]
  s_add_u32 m0, s27, 98304
  s_add_u32 s25, s65, 0
  buffer_load_dwordx4 v2, s[4:7], s25 offen  lds
  s_add_u32 m0, s27, 99328
  s_add_u32 s25, s65, 10240
  buffer_load_dwordx4 v3, s[4:7], s25 offen  lds
  v_mfma_f32_32x32x16_bf16 v[216:231], v[52:55], v[60:63], v[216:231]
  s_add_u32 m0, s27, 100352
  s_add_u32 s25, s65, 20480
  buffer_load_dwordx4 v2, s[4:7], s25 offen  lds
  s_waitcnt lgkmcnt(4)
  v_mfma_f32_32x32x16_bf16 v[168:183], v[144:147], v[152:155], v[168:183]
  ds_read_b128 v[48:51], v9 offset:0
  ds_read_b128 v[52:55], v9 offset:2048
  v_mfma_f32_32x32x16_bf16 v[184:199], v[144:147], v[156:159], v[184:199]
  ds_read_b128 v[56:59], v21 offset:32768
  ds_read_b128 v[60:63], v21 offset:36864
  v_mfma_f32_32x32x16_bf16 v[200:215], v[148:151], v[152:155], v[200:215]
  s_add_u32 m0, s27, 101376
  s_add_u32 s25, s65, 30720
  buffer_load_dwordx4 v3, s[4:7], s25 offen  lds
  s_add_u32 s65, s65, 128
  s_cmp_eq_u32 s65, 1280
  s_cselect_b32 s65, 0, s65
  s_add_u32 m0, s28, 131072
  s_add_u32 s25, s66, 0
  buffer_load_dwordx4 v4, s[8:11], s25 offen  lds
  v_mfma_f32_32x32x16_bf16 v[216:231], v[148:151], v[156:159], v[216:231]
  s_add_u32 m0, s28, 132096
  s_add_u32 s25, s66, 10240
  buffer_load_dwordx4 v5, s[8:11], s25 offen  lds
  s_add_u32 s66, s66, 128
  s_cmp_eq_u32 s66, 1280
  s_cselect_b32 s66, 0, s66
  s_waitcnt lgkmcnt(4)
  v_mfma_f32_32x32x16_bf16 v[168:183], v[32:35], v[40:43], v[168:183]
  ds_read_b128 v[144:147], v10 offset:0
  ds_read_b128 v[148:151], v10 offset:2048
  v_mfma_f32_32x32x16_bf16 v[184:199], v[32:35], v[44:47], v[184:199]
  ds_read_b128 v[152:155], v22 offset:32768
  ds_read_b128 v[156:159], v22 offset:36864
  v_mfma_f32_32x32x16_bf16 v[200:215], v[36:39], v[40:43], v[200:215]
  v_mfma_f32_32x32x16_bf16 v[216:231], v[36:39], v[44:47], v[216:231]
  s_waitcnt lgkmcnt(4)
  v_mfma_f32_32x32x16_bf16 v[168:183], v[48:51], v[56:59], v[168:183]
  ds_read_b128 v[32:35], v11 offset:0
  ds_read_b128 v[36:39], v11 offset:2048
  v_mfma_f32_32x32x16_bf16 v[184:199], v[48:51], v[60:63], v[184:199]
  ds_read_b128 v[40:43], v23 offset:32768
  ds_read_b128 v[44:47], v23 offset:36864
  v_mfma_f32_32x32x16_bf16 v[200:215], v[52:55], v[56:59], v[200:215]
  v_mfma_f32_32x32x16_bf16 v[216:231], v[52:55], v[60:63], v[216:231]
  s_waitcnt vmcnt(6) lgkmcnt(0)
  s_barrier
  v_mfma_f32_32x32x16_bf16 v[168:183], v[144:147], v[152:155], v[168:183]
  ds_read_b128 v[48:51], v8 offset:49152
  ds_read_b128 v[52:55], v8 offset:51200
  v_mfma_f32_32x32x16_bf16 v[184:199], v[144:147], v[156:159], v[184:199]
  ds_read_b128 v[56:59], v24 offset:16384
  ds_read_b128 v[60:63], v24 offset:20480
  v_mfma_f32_32x32x16_bf16 v[200:215], v[148:151], v[152:155], v[200:215]
  s_add_u32 m0, s27, 0
  s_add_u32 s25, s65, 0
  buffer_load_dwordx4 v2, s[4:7], s25 offen  lds
  s_add_u32 m0, s27, 1024
  s_add_u32 s25, s65, 10240
  buffer_load_dwordx4 v3, s[4:7], s25 offen  lds
  v_mfma_f32_32x32x16_bf16 v[216:231], v[148:151], v[156:159], v[216:231]
  s_add_u32 m0, s27, 2048
  s_add_u32 s25, s65, 20480
  buffer_load_dwordx4 v2, s[4:7], s25 offen  lds
  s_waitcnt lgkmcnt(4)
  v_mfma_f32_32x32x16_bf16 v[168:183], v[32:35], v[40:43], v[168:183]
  ds_read_b128 v[144:147], v9 offset:49152
  ds_read_b128 v[148:151], v9 offset:51200
  v_mfma_f32_32x32x16_bf16 v[184:199], v[32:35], v[44:47], v[184:199]
  ds_read_b128 v[152:155], v25 offset:16384
  ds_read_b128 v[156:159], v25 offset:20480
  v_mfma_f32_32x32x16_bf16 v[200:215], v[36:39], v[40:43], v[200:215]
  s_add_u32 m0, s27, 3072
  s_add_u32 s25, s65, 30720
  buffer_load_dwordx4 v3, s[4:7], s25 offen  lds
  s_add_u32 s65, s65, 128
  s_cmp_eq_u32 s65, 1280
  s_cselect_b32 s65, 0, s65
  s_add_u32 m0, s28, 32768
  s_add_u32 s25, s66, 0
  buffer_load_dwordx4 v4, s[8:11], s25 offen  lds
  v_mfma_f32_32x32x16_bf16 v[216:231], v[36:39], v[44:47], v[216:231]
  s_add_u32 m0, s28, 33792
  s_add_u32 s25, s66, 10240
  buffer_load_dwordx4 v5, s[8:11], s25 offen  lds
  s_add_u32 s66, s66, 128
  s_cmp_eq_u32 s66, 1280
  s_cselect_b32 s66, 0, s66
  s_waitcnt lgkmcnt(4)
  v_mfma_f32_32x32x16_bf16 v[168:183], v[48:51], v[56:59], v[168:183]
  ds_read_b128 v[32:35], v10 offset:49152
  ds_read_b128 v[36:39], v10 offset:51200
  v_mfma_f32_32x32x16_bf16 v[184:199], v[48:51], v[60:63], v[184:199]
  ds_read_b128 v[40:43], v26 offset:16384
  ds_read_b128 v[44:47], v26 offset:20480
  v_mfma_f32_32x32x16_bf16 v[200:215], v[52:55], v[56:59], v[200:215]
  v_mfma_f32_32x32x16_bf16 v[216:231], v[52:55], v[60:63], v[216:231]
  s_waitcnt lgkmcnt(4)
  v_mfma_f32_32x32x16_bf16 v[168:183], v[144:147], v[152:155], v[168:183]
  ds_read_b128 v[48:51], v11 offset:49152
  ds_read_b128 v[52:55], v11 offset:51200
  v_mfma_f32_32x32x16_bf16 v[184:199], v[144:147], v[156:159], v[184:199]
  ds_read_b128 v[56:59], v27 offset:16384
  ds_read_b128 v[60:63], v27 offset:20480
  v_mfma_f32_32x32x16_bf16 v[200:215], v[148:151], v[152:155], v[200:215]
  v_mfma_f32_32x32x16_bf16 v[216:231], v[148:151], v[156:159], v[216:231]
  s_waitcnt vmcnt(6) lgkmcnt(0)
  s_barrier
  v_mfma_f32_32x32x16_bf16 v[168:183], v[32:35], v[40:43], v[168:183]
  ds_read_b128 v[144:147], v12 offset:32768
  ds_read_b128 v[148:151], v12 offset:34816
  v_mfma_f32_32x32x16_bf16 v[184:199], v[32:35], v[44:47], v[184:199]
  ds_read_b128 v[152:155], v28 offset:0
  ds_read_b128 v[156:159], v28 offset:4096
  v_mfma_f32_32x32x16_bf16 v[200:215], v[36:39], v[40:43], v[200:215]
  s_add_u32 m0, s27, 49152
  s_add_u32 s25, s65, 0
  buffer_load_dwordx4 v2, s[4:7], s25 offen  lds
  s_add_u32 m0, s27, 50176
  s_add_u32 s25, s65, 10240
  buffer_load_dwordx4 v3, s[4:7], s25 offen  lds
  v_mfma_f32_32x32x16_bf16 v[216:231], v[36:39], v[44:47], v[216:231]
  s_add_u32 m0, s27, 51200
  s_add_u32 s25, s65, 20480
  buffer_load_dwordx4 v2, s[4:7], s25 offen  lds
  s_waitcnt lgkmcnt(4)
  v_mfma_f32_32x32x16_bf16 v[168:183], v[48:51], v[56:59], v[168:183]
  ds_read_b128 v[32:35], v13 offset:32768
  ds_read_b128 v[36:39], v13 offset:34816
  v_mfma_f32_32x32x16_bf16 v[184:199], v[48:51], v[60:63], v[184:199]
  ds_read_b128 v[40:43], v29 offset:0
  ds_read_b128 v[44:47], v29 offset:4096
  v_mfma_f32_32x32x16_bf16 v[200:215], v[52:55], v[56:59], v[200:215]
  s_add_u32 m0, s27, 52224
  s_add_u32 s25, s65, 30720
  buffer_load_dwordx4 v3, s[4:7], s25 offen  lds
  s_add_u32 s65, s65, 128
  s_cmp_eq_u32 s65, 1280
  s_cselect_b32 s65, 0, s65
  s_add_u32 m0, s28, 81920
  s_add_u32 s25, s66, 0
  buffer_load_dwordx4 v4, s[8:11], s25 offen  lds
  v_mfma_f32_32x32x16_bf16 v[216:231], v[52:55], v[60:63], v[216:231]
  s_add_u32 m0, s28, 82944
  s_add_u32 s25, s66, 10240
  buffer_load_dwordx4 v5, s[8:11], s25 offen  lds
  s_add_u32 s66, s66, 128
  s_cmp_eq_u32 s66, 1280
  s_cselect_b32 s66, 0, s66
  s_waitcnt lgkmcnt(4)
  v_mfma_f32_32x32x16_bf16 v[168:183], v[144:147], v[152:155], v[168:183]
  ds_read_b128 v[48:51], v14 offset:32768
  ds_read_b128 v[52:55], v14 offset:34816
  v_mfma_f32_32x32x16_bf16 v[184:199], v[144:147], v[156:159], v[184:199]
  ds_read_b128 v[56:59], v30 offset:0
  ds_read_b128 v[60:63], v30 offset:4096
  v_mfma_f32_32x32x16_bf16 v[200:215], v[148:151], v[152:155], v[200:215]
  v_mfma_f32_32x32x16_bf16 v[216:231], v[148:151], v[156:159], v[216:231]
  s_waitcnt lgkmcnt(4)
  v_mfma_f32_32x32x16_bf16 v[168:183], v[32:35], v[40:43], v[168:183]
  ds_read_b128 v[144:147], v15 offset:32768
  ds_read_b128 v[148:151], v15 offset:34816
  v_mfma_f32_32x32x16_bf16 v[184:199], v[32:35], v[44:47], v[184:199]
  ds_read_b128 v[152:155], v31 offset:0
  ds_read_b128 v[156:159], v31 offset:4096
  v_mfma_f32_32x32x16_bf16 v[200:215], v[36:39], v[40:43], v[200:215]
  v_mfma_f32_32x32x16_bf16 v[216:231], v[36:39], v[44:47], v[216:231]
  s_waitcnt vmcnt(6) lgkmcnt(0)
  s_barrier
  v_mfma_f32_32x32x16_bf16 v[168:183], v[48:51], v[56:59], v[168:183]
  ds_read_b128 v[32:35], v8 offset:0
  ds_read_b128 v[36:39], v8 offset:2048
  v_mfma_f32_32x32x16_bf16 v[184:199], v[48:51], v[60:63], v[184:199]
  ds_read_b128 v[40:43], v20 offset:32768
  ds_read_b128 v[44:47], v20 offset:36864
  v_mfma_f32_32x32x16_bf16 v[200:215], v[52:55], v[56:59], v[200:215]
  s_add_u32 m0, s27, 98304
  s_add_u32 s25, s65, 0
  buffer_load_dwordx4 v2, s[4:7], s25 offen  lds
  s_add_u32 m0, s27, 99328
  s_add_u32 s25, s65, 10240
  buffer_load_dwordx4 v3, s[4:7], s25 offen  lds
  v_mfma_f32_32x32x16_bf16 v[216:231], v[52:55], v[60:63], v[216:231]
  s_add_u32 m0, s27, 100352
  s_add_u32 s25, s65, 20480
  buffer_load_dwordx4 v2, s[4:7], s25 offen  lds
  s_waitcnt lgkmcnt(4)
  v_mfma_f32_32x32x16_bf16 v[168:183], v[144:147], v[152:155], v[168:183]
  ds_read_b128 v[48:51], v9 offset:0
  ds_read_b128 v[52:55], v9 offset:2048
  v_mfma_f32_32x32x16_bf16 v[184:199], v[144:147], v[156:159], v[184:199]
  ds_read_b128 v[56:59], v21 offset:32768
  ds_read_b128 v[60:63], v21 offset:36864
  v_mfma_f32_32x32x16_bf16 v[200:215], v[148:151], v[152:155], v[200:215]
  s_add_u32 m0, s27, 101376
  s_add_u32 s25, s65, 30720
  buffer_load_dwordx4 v3, s[4:7], s25 offen  lds
  s_add_u32 s65, s65, 128
  s_cmp_eq_u32 s65, 1280
  s_cselect_b32 s65, 0, s65
  s_add_u32 m0, s28, 131072
  s_add_u32 s25, s66, 0
  buffer_load_dwordx4 v4, s[8:11], s25 offen  lds
  v_mfma_f32_32x32x16_bf16 v[216:231], v[148:151], v[156:159], v[216:231]
  s_add_u32 m0, s28, 132096
  s_add_u32 s25, s66, 10240
  buffer_load_dwordx4 v5, s[8:11], s25 offen  lds
  s_add_u32 s66, s66, 128
  s_cmp_eq_u32 s66, 1280
  s_cselect_b32 s66, 0, s66
  s_waitcnt lgkmcnt(4)
  v_mfma_f32_32x32x16_bf16 v[168:183], v[32:35], v[40:43], v[168:183]
  ds_read_b128 v[144:147], v10 offset:0
  ds_read_b128 v[148:151], v10 offset:2048
  v_mfma_f32_32x32x16_bf16 v[184:199], v[32:35], v[44:47], v[184:199]
  ds_read_b128 v[152:155], v22 offset:32768
  ds_read_b128 v[156:159], v22 offset:36864
  v_mfma_f32_32x32x16_bf16 v[200:215], v[36:39], v[40:43], v[200:215]
  v_mfma_f32_32x32x16_bf16 v[216:231], v[36:39], v[44:47], v[216:231]
  s_waitcnt lgkmcnt(4)
  v_mfma_f32_32x32x16_bf16 v[168:183], v[48:51], v[56:59], v[168:183]
  ds_read_b128 v[32:35], v11 offset:0
  ds_read_b128 v[36:39], v11 offset:2048
  v_mfma_f32_32x32x16_bf16 v[184:199], v[48:51], v[60:63], v[184:199]
  ds_read_b128 v[40:43], v23 offset:32768
  ds_read_b128 v[44:47], v23 offset:36864
  v_mfma_f32_32x32x16_bf16 v[200:215], v[52:55], v[56:59], v[200:215]
  v_mfma_f32_32x32x16_bf16 v[216:231], v[52:55], v[60:63], v[216:231]
  s_waitcnt vmcnt(6) lgkmcnt(0)
  s_barrier
  v_mfma_f32_32x32x16_bf16 v[168:183], v[144:147], v[152:155], v[168:183]
  ds_read_b128 v[48:51], v8 offset:49152
  ds_read_b128 v[52:55], v8 offset:51200
  v_mfma_f32_32x32x16_bf16 v[184:199], v[144:147], v[156:159], v[184:199]
  ds_read_b128 v[56:59], v24 offset:16384
  ds_read_b128 v[60:63], v24 offset:20480
  v_mfma_f32_32x32x16_bf16 v[200:215], v[148:151], v[152:155], v[200:215]
  s_add_u32 m0, s27, 0
  s_add_u32 s25, s65, 0
  buffer_load_dwordx4 v2, s[4:7], s25 offen  lds
  s_add_u32 m0, s27, 1024
  s_add_u32 s25, s65, 10240
  buffer_load_dwordx4 v3, s[4:7], s25 offen  lds
  v_mfma_f32_32x32x16_bf16 v[216:231], v[148:151], v[156:159], v[216:231]
  s_add_u32 m0, s27, 2048
  s_add_u32 s25, s65, 20480
  buffer_load_dwordx4 v2, s[4:7], s25 offen  lds
  s_waitcnt lgkmcnt(4)
  v_mfma_f32_32x32x16_bf16 v[168:183], v[32:35], v[40:43], v[168:183]
  ds_read_b128 v[144:147], v9 offset:49152
  ds_read_b128 v[148:151], v9 offset:51200
  v_mfma_f32_32x32x16_bf16 v[184:199], v[32:35], v[44:47], v[184:199]
  ds_read_b128 v[152:155], v25 offset:16384
  ds_read_b128 v[156:159], v25 offset:20480
  v_mfma_f32_32x32x16_bf16 v[200:215], v[36:39], v[40:43], v[200:215]
  s_add_u32 m0, s27, 3072
  s_add_u32 s25, s65, 30720
  buffer_load_dwordx4 v3, s[4:7], s25 offen  lds
  s_add_u32 m0, s28, 32768
  s_add_u32 s25, s66, 0
  buffer_load_dwordx4 v4, s[8:11], s25 offen  lds
  v_mfma_f32_32x32x16_bf16 v[216:231], v[36:39], v[44:47], v[216:231]
  s_add_u32 m0, s28, 33792
  s_add_u32 s25, s66, 10240
  buffer_load_dwordx4 v5, s[8:11], s25 offen  lds
  s_waitcnt lgkmcnt(4)
  v_mfma_f32_32x32x16_bf16 v[168:183], v[48:51], v[56:59], v[168:183]
  ds_read_b128 v[32:35], v10 offset:49152
  ds_read_b128 v[36:39], v10 offset:51200
  v_mfma_f32_32x32x16_bf16 v[184:199], v[48:51], v[60:63], v[184:199]
  ds_read_b128 v[40:43], v26 offset:16384
  ds_read_b128 v[44:47], v26 offset:20480
  v_mfma_f32_32x32x16_bf16 v[200:215], v[52:55], v[56:59], v[200:215]
  v_mfma_f32_32x32x16_bf16 v[216:231], v[52:55], v[60:63], v[216:231]
  s_waitcnt lgkmcnt(4)
  v_mfma_f32_32x32x16_bf16 v[168:183], v[144:147], v[152:155], v[168:183]
  ds_read_b128 v[48:51], v11 offset:49152
  ds_read_b128 v[52:55], v11 offset:51200
  v_mfma_f32_32x32x16_bf16 v[184:199], v[144:147], v[156:159], v[184:199]
  ds_read_b128 v[56:59], v27 offset:16384
  ds_read_b128 v[60:63], v27 offset:20480
  v_mfma_f32_32x32x16_bf16 v[200:215], v[148:151], v[152:155], v[200:215]
  v_mfma_f32_32x32x16_bf16 v[216:231], v[148:151], v[156:159], v[216:231]
  s_waitcnt vmcnt(6) lgkmcnt(0)
  s_barrier
  v_mfma_f32_32x32x16_bf16 v[168:183], v[32:35], v[40:43], v[168:183]
  ds_read_b128 v[144:147], v12 offset:32768
  ds_read_b128 v[152:155], v28 offset:0
  v_mfma_f32_32x32x16_bf16 v[184:199], v[32:35], v[44:47], v[184:199]
  ds_read_b128 v[156:159], v28 offset:4096
  v_mfma_f32_32x32x16_bf16 v[200:215], v[36:39], v[40:43], v[200:215]
  v_mfma_f32_32x32x16_bf16 v[216:231], v[36:39], v[44:47], v[216:231]
  s_mov_b32 s68, s58
  s_and_b32 s69, s59, 0xffff
  s_mov_b32 s70, 256
  s_mov_b32 s71, 0x00020000
  v_mov_b32 v160, 0
  buffer_load_dword v160, v160, s[68:71], 0 offen sc1
  s_waitcnt lgkmcnt(3)
  v_mfma_f32_32x32x16_bf16 v[168:183], v[48:51], v[56:59], v[168:183]
  ds_read_b128 v[32:35], v13 offset:32768
  ds_read_b128 v[40:43], v29 offset:0
  v_mfma_f32_32x32x16_bf16 v[184:199], v[48:51], v[60:63], v[184:199]
  ds_read_b128 v[44:47], v29 offset:4096
  v_mfma_f32_32x32x16_bf16 v[200:215], v[52:55], v[56:59], v[200:215]
  v_mfma_f32_32x32x16_bf16 v[216:231], v[52:55], v[60:63], v[216:231]
  s_waitcnt lgkmcnt(3)
  v_mfma_f32_32x32x16_bf16 v[168:183], v[144:147], v[152:155], v[168:183]
  ds_read_b128 v[48:51], v14 offset:32768
  ds_read_b128 v[56:59], v30 offset:0
  ds_read_b128 v[60:63], v30 offset:4096
  v_mfma_f32_32x32x16_bf16 v[184:199], v[144:147], v[156:159], v[184:199]
  s_waitcnt lgkmcnt(3)
  v_mfma_f32_32x32x16_bf16 v[168:183], v[32:35], v[40:43], v[168:183]
  ds_read_b128 v[144:147], v15 offset:32768
  ds_read_b128 v[152:155], v31 offset:0
  ds_read_b128 v[156:159], v31 offset:4096
  v_mfma_f32_32x32x16_bf16 v[184:199], v[32:35], v[44:47], v[184:199]
  s_waitcnt vmcnt(1) lgkmcnt(0)
  s_barrier
  v_mfma_f32_32x32x16_bf16 v[168:183], v[48:51], v[56:59], v[168:183]
  ds_read_b128 v[32:35], v8 offset:0
  ds_read_b128 v[40:43], v20 offset:32768
  ds_read_b128 v[44:47], v20 offset:36864
  v_mfma_f32_32x32x16_bf16 v[184:199], v[48:51], v[60:63], v[184:199]
  s_waitcnt lgkmcnt(3)
  v_mfma_f32_32x32x16_bf16 v[168:183], v[144:147], v[152:155], v[168:183]
  ds_read_b128 v[48:51], v9 offset:0
  ds_read_b128 v[56:59], v21 offset:32768
  ds_read_b128 v[60:63], v21 offset:36864
  v_mfma_f32_32x32x16_bf16 v[184:199], v[144:147], v[156:159], v[184:199]
  s_waitcnt lgkmcnt(3)
  v_mfma_f32_32x32x16_bf16 v[168:183], v[32:35], v[40:43], v[168:183]
  ds_read_b128 v[144:147], v10 offset:0
  ds_read_b128 v[152:155], v22 offset:32768
  ds_read_b128 v[156:159], v22 offset:36864
  v_mfma_f32_32x32x16_bf16 v[184:199], v[32:35], v[44:47], v[184:199]
  s_waitcnt lgkmcnt(3)
  v_mfma_f32_32x32x16_bf16 v[168:183], v[48:51], v[56:59], v[168:183]
  ds_read_b128 v[32:35], v11 offset:0
  ds_read_b128 v[40:43], v23 offset:32768
  ds_read_b128 v[44:47], v23 offset:36864
  v_mfma_f32_32x32x16_bf16 v[184:199], v[48:51], v[60:63], v[184:199]
  s_waitcnt lgkmcnt(3)
  v_mfma_f32_32x32x16_bf16 v[168:183], v[144:147], v[152:155], v[168:183]
  ds_read_b128 v[52:55], v12 offset:34816
  ds_read_b128 v[56:59], v28 offset:0
  ds_read_b128 v[60:63], v28 offset:4096
  v_mfma_f32_32x32x16_bf16 v[184:199], v[144:147], v[156:159], v[184:199]
  s_waitcnt lgkmcnt(3)
  v_mfma_f32_32x32x16_bf16 v[168:183], v[32:35], v[40:43], v[168:183]
  ds_read_b128 v[148:151], v13 offset:34816
  ds_read_b128 v[152:155], v29 offset:0
  ds_read_b128 v[156:159], v29 offset:4096
  v_mfma_f32_32x32x16_bf16 v[184:199], v[32:35], v[44:47], v[184:199]
  s_waitcnt lgkmcnt(3)
  v_mfma_f32_32x32x16_bf16 v[200:215], v[52:55], v[56:59], v[200:215]
  ds_read_b128 v[36:39], v14 offset:34816
  ds_read_b128 v[40:43], v30 offset:0
  ds_read_b128 v[44:47], v30 offset:4096
  v_mfma_f32_32x32x16_bf16 v[216:231], v[52:55], v[60:63], v[216:231]
  s_waitcnt lgkmcnt(3)
  v_mfma_f32_32x32x16_bf16 v[200:215], v[148:151], v[152:155], v[200:215]
  ds_read_b128 v[52:55], v15 offset:34816
  ds_read_b128 v[56:59], v31 offset:0
  ds_read_b128 v[60:63], v31 offset:4096
  v_mfma_f32_32x32x16_bf16 v[216:231], v[148:151], v[156:159], v[216:231]
  v_pk_mul_f32 v[248:249], v[168:169], v[246:247]
  v_pk_mul_f32 v[168:169], v[168:169], v[244:245]
  v_pk_fma_f32 v[168:169], v[184:185], v[246:247], v[168:169] neg_lo:[1,0,0] neg_hi:[1,0,0]
  v_pk_fma_f32 v[184:185], v[184:185], v[244:245], v[248:249]
  v_pk_mul_f32 v[248:249], v[170:171], v[246:247]
  v_pk_mul_f32 v[170:171], v[170:171], v[244:245]
  v_pk_fma_f32 v[170:171], v[186:187], v[246:247], v[170:171] neg_lo:[1,0,0] neg_hi:[1,0,0]
  v_pk_fma_f32 v[186:187], v[186:187], v[244:245], v[248:249]
  v_fma_f32 v132, v232, v168, v169
  v_fma_f32 v133, v232, v184, v185
  v_fma_f32 v132, -v233, v184, v132
  v_fma_f32 v133, v233, v168, v133
  v_fma_f32 v134, v232, v132, v170
  v_fma_f32 v135, v232, v133, v186
  v_fma_f32 v134, -v233, v133, v134
  v_fma_f32 v135, v233, v132, v135
  s_waitcnt lgkmcnt(3)
  v_mfma_f32_32x32x16_bf16 v[200:215], v[36:39], v[40:43], v[200:215]
  ds_read_b128 v[148:151], v8 offset:2048
  ds_read_b128 v[152:155], v20 offset:32768
  ds_read_b128 v[156:159], v20 offset:36864
  v_mfma_f32_32x32x16_bf16 v[216:231], v[36:39], v[44:47], v[216:231]
  v_pk_mul_f32 v[248:249], v[172:173], v[246:247]
  v_pk_mul_f32 v[172:173], v[172:173], v[244:245]
  v_pk_fma_f32 v[172:173], v[188:189], v[246:247], v[172:173] neg_lo:[1,0,0] neg_hi:[1,0,0]
  v_pk_fma_f32 v[188:189], v[188:189], v[244:245], v[248:249]
  v_fma_f32 v132, v232, v134, v171
  v_fma_f32 v133, v232, v135, v187
  v_fma_f32 v132, -v233, v135, v132
  v_fma_f32 v133, v233, v134, v133
  v_fma_f32 v134, v232, v132, v172
  v_fma_f32 v135, v232, v133, v188
  v_fma_f32 v134, -v233, v133, v134
  v_fma_f32 v135, v233, v132, v135
  v_pk_mul_f32 v[248:249], v[174:175], v[246:247]
  v_pk_mul_f32 v[174:175], v[174:175], v[244:245]
  v_pk_fma_f32 v[174:175], v[190:191], v[246:247], v[174:175] neg_lo:[1,0,0] neg_hi:[1,0,0]
  v_pk_fma_f32 v[190:191], v[190:191], v[244:245], v[248:249]
  s_waitcnt lgkmcnt(3)
  v_mfma_f32_32x32x16_bf16 v[200:215], v[52:55], v[56:59], v[200:215]
  ds_read_b128 v[36:39], v9 offset:2048
  ds_read_b128 v[40:43], v21 offset:32768
  ds_read_b128 v[44:47], v21 offset:36864
  v_mfma_f32_32x32x16_bf16 v[216:231], v[52:55], v[60:63], v[216:231]
  v_fma_f32 v132, v232, v134, v173
  v_fma_f32 v133, v232, v135, v189
  v_fma_f32 v132, -v233, v135, v132
  v_fma_f32 v133, v233, v134, v133
  v_fma_f32 v134, v232, v132, v174
  v_fma_f32 v135, v232, v133, v190
  v_fma_f32 v134, -v233, v133, v134
  v_fma_f32 v135, v233, v132, v135
  v_pk_mul_f32 v[248:249], v[176:177], v[246:247]
  v_pk_mul_f32 v[176:177], v[176:177], v[244:245]
  v_pk_fma_f32 v[176:177], v[192:193], v[246:247], v[176:177] neg_lo:[1,0,0] neg_hi:[1,0,0]
  v_pk_fma_f32 v[192:193], v[192:193], v[244:245], v[248:249]
  v_fma_f32 v132, v232, v134, v175
  v_fma_f32 v133, v232, v135, v191
  v_fma_f32 v132, -v233, v135, v132
  v_fma_f32 v133, v233, v134, v133
  s_waitcnt lgkmcnt(3)
  v_mfma_f32_32x32x16_bf16 v[200:215], v[148:151], v[152:155], v[200:215]
  ds_read_b128 v[52:55], v10 offset:2048
  ds_read_b128 v[56:59], v22 offset:32768
  ds_read_b128 v[60:63], v22 offset:36864
  v_mfma_f32_32x32x16_bf16 v[216:231], v[148:151], v[156:159], v[216:231]
  v_fma_f32 v134, v232, v132, v176
  v_fma_f32 v135, v232, v133, v192
  v_fma_f32 v134, -v233, v133, v134
  v_fma_f32 v135, v233, v132, v135
  v_pk_mul_f32 v[248:249], v[178:179], v[246:247]
  v_pk_mul_f32 v[178:179], v[178:179], v[244:245]
  v_pk_fma_f32 v[178:179], v[194:195], v[246:247], v[178:179] neg_lo:[1,0,0] neg_hi:[1,0,0]
  v_pk_fma_f32 v[194:195], v[194:195], v[244:245], v[248:249]
  v_fma_f32 v132, v232, v134, v177
  v_fma_f32 v133, v232, v135, v193
  v_fma_f32 v132, -v233, v135, v132
  v_fma_f32 v133, v233, v134, v133
  v_fma_f32 v134, v232, v132, v178
  v_fma_f32 v135, v232, v133, v194
  v_fma_f32 v134, -v233, v133, v134
  v_fma_f32 v135, v233, v132, v135
  s_waitcnt lgkmcnt(3)
  v_mfma_f32_32x32x16_bf16 v[200:215], v[36:39], v[40:43], v[200:215]
  ds_read_b128 v[148:151], v11 offset:2048
  ds_read_b128 v[152:155], v23 offset:32768
  ds_read_b128 v[156:159], v23 offset:36864
  v_mfma_f32_32x32x16_bf16 v[216:231], v[36:39], v[44:47], v[216:231]
  v_pk_mul_f32 v[248:249], v[180:181], v[246:247]
  v_pk_mul_f32 v[180:181], v[180:181], v[244:245]
  v_pk_fma_f32 v[180:181], v[196:197], v[246:247], v[180:181] neg_lo:[1,0,0] neg_hi:[1,0,0]
  v_pk_fma_f32 v[196:197], v[196:197], v[244:245], v[248:249]
  v_fma_f32 v132, v232, v134, v179
  v_fma_f32 v133, v232, v135, v195
  v_fma_f32 v132, -v233, v135, v132
  v_fma_f32 v133, v233, v134, v133
  v_fma_f32 v134, v232, v132, v180
  v_fma_f32 v135, v232, v133, v196
  v_fma_f32 v134, -v233, v133, v134
  v_fma_f32 v135, v233, v132, v135
  v_pk_mul_f32 v[248:249], v[182:183], v[246:247]
  v_pk_mul_f32 v[182:183], v[182:183], v[244:245]
  v_pk_fma_f32 v[182:183], v[198:199], v[246:247], v[182:183] neg_lo:[1,0,0] neg_hi:[1,0,0]
  v_pk_fma_f32 v[198:199], v[198:199], v[244:245], v[248:249]
  s_waitcnt lgkmcnt(3)
  v_mfma_f32_32x32x16_bf16 v[200:215], v[52:55], v[56:59], v[200:215]
  v_mfma_f32_32x32x16_bf16 v[216:231], v[52:55], v[60:63], v[216:231]
  v_fma_f32 v132, v232, v134, v181
  v_fma_f32 v133, v232, v135, v197
  v_fma_f32 v132, -v233, v135, v132
  v_fma_f32 v133, v233, v134, v133
  v_fma_f32 v134, v232, v132, v182
  v_fma_f32 v135, v232, v133, v198
  v_fma_f32 v134, -v233, v133, v134
  v_fma_f32 v135, v233, v132, v135
  v_fma_f32 v132, v232, v134, v183
  v_fma_f32 v133, v232, v135, v199
  v_fma_f32 v132, -v233, v135, v132
  v_fma_f32 v133, v233, v134, v133
  s_waitcnt lgkmcnt(0)
  v_mfma_f32_32x32x16_bf16 v[200:215], v[148:151], v[152:155], v[200:215]
  v_mfma_f32_32x32x16_bf16 v[216:231], v[148:151], v[156:159], v[216:231]
  s_mov_b32 s8, s31
  s_mov_b32 s9, s30
  s_mov_b32 s10, 1
  s_lshl_b32 s25, s31, 5
  s_lshl_b32 s26, s21, 3
  s_add_u32 s25, s25, s26
  s_mul_i32 s11, s25, 20480
  s_add_u32 s11, s11, 10485760
  s_mov_b32 s3, s21
  s_waitcnt vmcnt(0)
L_ci0:
  v_readfirstlane_b32 s25, v160
  s_nop 0
  s_cmp_eq_u32 s25, 8
  s_cbranch_scc1 L_cj0
  s_sleep 4
  v_mov_b32 v160, 0
  buffer_load_dword v160, v160, s[68:71], 0 offen sc1
  s_waitcnt vmcnt(0)
  s_branch L_ci0
L_cj0:
  s_branch L_attn
L_qkv:
  s_mov_b32 s64, 0
  s_lshl_b32 s23, s31, 8
  s_lshl_b32 s24, s30, 7
  v_lshrrev_b32 v7, 4, v1
  v_xor_b32 v7, v7, v1
  v_and_b32 v7, 7, v7
  v_lshlrev_b32 v7, 4, v7
  v_lshrrev_b32 v6, 3, v1
  s_mul_i32 s25, s20, 32
  s_add_u32 s25, s25, s23
  v_add_u32 v6, s25, v6
  v_mul_u32_u24 v6, 1280, v6
  v_add_u32 v2, v6, v7
  v_xor_b32 v3, 64, v2
  v_lshrrev_b32 v6, 4, v1
  s_mul_i32 s25, s20, 8
  v_add_u32 v4, s25, v6
  v_mul_u32_u24 v4, 3840, v4
  v_lshlrev_b32 v6, 2, v6
  v_xor_b32 v6, v6, v1
  v_and_b32 v6, 15, v6
  v_lshlrev_b32 v6, 4, v6
  v_add_u32 v4, v4, v6
  s_lshl_b32 s25, s24, 1
  v_add_u32 v4, s25, v4
  s_mul_i32 s27, s20, 4096
  s_mul_i32 s28, s20, 2048
  s_mul_i32 s66, s64, 245760
  s_mul_i32 s65, s64, 128
  s_waitcnt lgkmcnt(0)
  s_mov_b32 s4, s50
  s_and_b32 s5, s51, 0xffff
  s_mov_b32 s6, 2621440
  s_mov_b32 s7, 0x00020000
  s_mov_b32 s8, s52
  s_and_b32 s9, s53, 0xffff
  s_mov_b32 s10, 2457600
  s_mov_b32 s11, 0x00020000
  s_mov_b32 s12, s60
  s_and_b32 s13, s61, 0xffff
  s_mov_b32 s14, 268435456
  s_mov_b32 s15, 0x00020000
  s_add_u32 m0, s27, 0
  s_add_u32 s25, s65, 0
  buffer_load_dwordx4 v2, s[4:7], s25 offen  lds
  s_add_u32 m0, s27, 1024
  s_add_u32 s25, s65, 10240
  buffer_load_dwordx4 v3, s[4:7], s25 offen  lds
  s_add_u32 m0, s27, 2048
  s_add_u32 s25, s65, 20480
  buffer_load_dwordx4 v2, s[4:7], s25 offen  lds
  s_add_u32 m0, s27, 3072
  s_add_u32 s25, s65, 30720
  buffer_load_dwordx4 v3, s[4:7], s25 offen  lds
  s_add_u32 s65, s65, 128
  s_cmp_eq_u32 s65, 1280
  s_cselect_b32 s65, 0, s65
  s_add_u32 m0, s28, 32768
  s_add_u32 s25, s66, 0
  buffer_load_dwordx4 v4, s[8:11], s25 offen  lds
  s_add_u32 m0, s28, 33792
  s_add_u32 s25, s66, 15360
  buffer_load_dwordx4 v4, s[8:11], s25 offen  lds
  s_add_u32 s66, s66, 245760
  s_cmp_eq_u32 s66, 2457600
  s_cselect_b32 s66, 0, s66
  s_lshl_b32 s62, s31, 1
  s_lshr_b32 s25, s21, 1
  s_add_u32 s62, s62, s25
  s_and_b32 s63, s21, 1
  s_mul_i32 s25, s30, 52
  s_lshr_b32 s25, s25, 8
  s_mul_i32 s26, s25, 5
  s_sub_u32 s26, s30, s26
  v_lshrrev_b32 v6, 2, v1
  v_mul_u32_u24 v6, 5, v6
  v_and_b32 v7, 2, v1
  v_add_u32 v6, v6, v7
  v_and_b32 v7, 1, v1
  v_lshl_add_u32 v6, v7, 1, v6
  v_lshrrev_b32 v6, 4, v6
  v_cmp_eq_u32 s[74:75], s26, v6
  v_lshrrev_b32 v6, 1, v1
  v_lshlrev_b32 v6, 8, v6
  v_lshl_add_u32 v6, v7, 5, v6
  s_lshl_b32 s25, s25, 6
  s_lshl_b32 s26, s31, 2
  s_add_u32 s25, s25, s26
  s_add_u32 s25, s25, 15769600
  v_add_u32 v165, s25, v6
  v_mov_b32 v164, 0
  s_cmp_ge_u32 s30, 10
  s_cbranch_scc1 L_qkv_v
  v_and_b32 v6, 31, v1
  v_lshrrev_b32 v9, 5, v1
  v_mov_b32 v7, v6
  v_bfe_u32 v8, v7, 1, 3
  v_xor_b32 v8, v8, v9
  v_lshlrev_b32 v8, 4, v8
  v_lshl_add_u32 v8, v7, 7, v8
  s_mul_i32 s25, s21, 8192
  v_add_u32 v8, s25, v8
  v_xor_b32 v9, 32, v8
  v_xor_b32 v10, 64, v8
  v_xor_b32 v11, 96, v8
  v_add_u32 v12, 0x10000, v8
  v_add_u32 v13, 0x10000, v9
  v_add_u32 v14, 0x10000, v10
  v_add_u32 v15, 0x10000, v11
  v_add_u32 v16, 0x20000, v8
  v_add_u32 v17, 0x20000, v9
  v_add_u32 v18, 0x20000, v10
  v_add_u32 v19, 0x20000, v11
  v_bfe_u32 v6, v1, 2, 2
  v_lshrrev_b32 v7, 5, v1
  v_lshl_add_u32 v7, v7, 3, v6
  v_lshlrev_b32 v7, 8, v7
  v_bfe_u32 v20, v1, 4, 1
  v_lshl_add_u32 v7, v20, 5, v7
  v_and_b32 v20, 1, v1
  v_lshl_add_u32 v7, v20, 4, v7
  v_bfe_u32 v20, v1, 1, 1
  v_lshl_add_u32 v7, v20, 3, v7
  v_lshlrev_b32 v6, 2, v6
  s_mul_i32 s25, s22, 8
  v_xor_b32 v20, s25, v6
  v_lshl_add_u32 v20, v20, 4, v7
  s_add_u32 s25, s25, 4
  v_xor_b32 v21, s25, v6
  v_lshl_add_u32 v21, v21, 4, v7
  v_add_u32 v24, 0x10000, v20
  v_add_u32 v25, 0x10000, v21
  v_add_u32 v28, 0x20000, v20
  v_add_u32 v29, 0x20000, v21
  s_cmp_ge_u32 s30, 5
  s_cselect_b32 s67, 0, 2621440
  s_cselect_b32 s25, 5, 0
  s_sub_u32 s25, s30, s25
  s_lshl_b32 s25, s25, 15
  s_add_u32 s67, s67, s25
  s_lshl_b32 s25, s22, 14
  s_add_u32 s67, s67, s25
  s_lshl_b32 s25, s63, 10
  s_add_u32 s67, s67, s25
  s_mul_i32 s25, s62, 163840
  s_add_u32 s67, s67, s25
  v_and_b32 v128, 31, v1
  v_lshlrev_b32 v128, 4, v128
  v_lshrrev_b32 v6, 5, v1
  v_lshl_add_u32 v128, v6, 11, v128
  s_cmp_ge_u32 s30, 5
  s_cselect_b32 s72, 1.0, 0x3ea52b5c
  s_waitcnt vmcnt(0)
  s_barrier
  ds_read_b128 v[32:35], v8 offset:0
  ds_read_b128 v[36:39], v8 offset:4096
  ds_read_b64_tr_b16 v[40:41], v20 offset:32768
  ds_read_b64_tr_b16 v[42:43], v20 offset:33792
  ds_read_b64_tr_b16 v[44:45], v21 offset:32768
  ds_read_b64_tr_b16 v[46:47], v21 offset:33792
  ds_read_b128 v[48:51], v9 offset:0
  ds_read_b128 v[52:55], v9 offset:4096
  ds_read_b64_tr_b16 v[56:57], v20 offset:36864
  ds_read_b64_tr_b16 v[58:59], v20 offset:37888
  ds_read_b64_tr_b16 v[60:61], v21 offset:36864
  ds_read_b64_tr_b16 v[62:63], v21 offset:37888
  s_waitcnt lgkmcnt(6)
  v_mfma_f32_32x32x16_bf16 v[64:79], v[40:43], v[32:35], 0
  ds_read_b128 v[144:147], v10 offset:0
  ds_read_b128 v[148:151], v10 offset:4096
  ds_read_b64_tr_b16 v[152:153], v20 offset:40960
  v_mfma_f32_32x32x16_bf16 v[80:95], v[44:47], v[32:35], 0
  ds_read_b64_tr_b16 v[154:155], v20 offset:41984
  ds_read_b64_tr_b16 v[156:157], v21 offset:40960
  ds_read_b64_tr_b16 v[158:159], v21 offset:41984
  v_mfma_f32_32x32x16_bf16 v[96:111], v[40:43], v[36:39], 0
  s_add_u32 m0, s27, 49152
  s_add_u32 s25, s65, 0
  buffer_load_dwordx4 v2, s[4:7], s25 offen  lds
  v_mfma_f32_32x32x16_bf16 v[112:127], v[44:47], v[36:39], 0
  s_add_u32 m0, s27, 50176
  s_add_u32 s25, s65, 10240
  buffer_load_dwordx4 v3, s[4:7], s25 offen  lds
  s_waitcnt lgkmcnt(6)
  v_mfma_f32_32x32x16_bf16 v[64:79], v[56:59], v[48:51], v[64:79]
  ds_read_b128 v[32:35], v11 offset:0
  ds_read_b128 v[36:39], v11 offset:4096
  ds_read_b64_tr_b16 v[40:41], v20 offset:45056
  v_mfma_f32_32x32x16_bf16 v[80:95], v[60:63], v[48:51], v[80:95]
  ds_read_b64_tr_b16 v[42:43], v20 offset:46080
  ds_read_b64_tr_b16 v[44:45], v21 offset:45056
  ds_read_b64_tr_b16 v[46:47], v21 offset:46080
  v_mfma_f32_32x32x16_bf16 v[96:111], v[56:59], v[52:55], v[96:111]
  s_add_u32 m0, s27, 51200
  s_add_u32 s25, s65, 20480
  buffer_load_dwordx4 v2, s[4:7], s25 offen  lds
  v_mfma_f32_32x32x16_bf16 v[112:127], v[60:63], v[52:55], v[112:127]
  s_add_u32 m0, s27, 52224
  s_add_u32 s25, s65, 30720
  buffer_load_dwordx4 v3, s[4:7], s25 offen  lds
  s_add_u32 s65, s65, 128
  s_cmp_eq_u32 s65, 1280
  s_cselect_b32 s65, 0, s65
  s_add_u32 m0, s28, 81920
  s_add_u32 s25, s66, 0
  buffer_load_dwordx4 v4, s[8:11], s25 offen  lds
  s_add_u32 m0, s28, 82944
  s_add_u32 s25, s66, 15360
  buffer_load_dwordx4 v4, s[8:11], s25 offen  lds
  s_add_u32 s66, s66, 245760
  s_cmp_eq_u32 s66, 2457600
  s_cselect_b32 s66, 0, s66
  s_waitcnt vmcnt(0) lgkmcnt(0)
  s_barrier
  v_mfma_f32_32x32x16_bf16 v[64:79], v[152:155], v[144:147], v[64:79]
  ds_read_b128 v[48:51], v8 offset:49152
  ds_read_b128 v[52:55], v8 offset:53248
  ds_read_b64_tr_b16 v[56:57], v24 offset:16384
  v_mfma_f32_32x32x16_bf16 v[80:95], v[156:159], v[144:147], v[80:95]
  ds_read_b64_tr_b16 v[58:59], v24 offset:17408
  ds_read_b64_tr_b16 v[60:61], v25 offset:16384
  ds_read_b64_tr_b16 v[62:63], v25 offset:17408
  v_mfma_f32_32x32x16_bf16 v[96:111], v[152:155], v[148:151], v[96:111]
  s_add_u32 m0, s27, 98304
  s_add_u32 s25, s65, 0
  buffer_load_dwordx4 v2, s[4:7], s25 offen  lds
  v_mfma_f32_32x32x16_bf16 v[112:127], v[156:159], v[148:151], v[112:127]
  s_add_u32 m0, s27, 99328
  s_add_u32 s25, s65, 10240
  buffer_load_dwordx4 v3, s[4:7], s25 offen  lds
  s_waitcnt lgkmcnt(6)
  v_mfma_f32_32x32x16_bf16 v[64:79], v[40:43], v[32:35], v[64:79]
  ds_read_b128 v[144:147], v9 offset:49152
  ds_read_b128 v[148:151], v9 offset:53248
  ds_read_b64_tr_b16 v[152:153], v24 offset:20480
  v_mfma_f32_32x32x16_bf16 v[80:95], v[44:47], v[32:35], v[80:95]
  ds_read_b64_tr_b16 v[154:155], v24 offset:21504
  ds_read_b64_tr_b16 v[156:157], v25 offset:20480
  ds_read_b64_tr_b16 v[158:159], v25 offset:21504
  v_mfma_f32_32x32x16_bf16 v[96:111], v[40:43], v[36:39], v[96:111]
  s_add_u32 m0, s27, 100352
  s_add_u32 s25, s65, 20480
  buffer_load_dwordx4 v2, s[4:7], s25 offen  lds
  v_mfma_f32_32x32x16_bf16 v[112:127], v[44:47], v[36:39], v[112:127]
  s_add_u32 m0, s27, 101376
  s_add_u32 s25, s65, 30720
  buffer_load_dwordx4 v3, s[4:7], s25 offen  lds
  s_add_u32 s65, s65, 128
  s_cmp_eq_u32 s65, 1280
  s_cselect_b32 s65, 0, s65
  s_waitcnt lgkmcnt(6)
  v_mfma_f32_32x32x16_bf16 v[64:79], v[56:59], v[48:51], v[64:79]
  ds_read_b128 v[32:35], v10 offset:49152
  ds_read_b128 v[36:39], v10 offset:53248
  ds_read_b64_tr_b16 v[40:41], v24 offset:24576
  v_mfma_f32_32x32x16_bf16 v[80:95], v[60:63], v[48:51], v[80:95]
  ds_read_b64_tr_b16 v[42:43], v24 offset:25600
  ds_read_b64_tr_b16 v[44:45], v25 offset:24576
  ds_read_b64_tr_b16 v[46:47], v25 offset:25600
  v_mfma_f32_32x32x16_bf16 v[96:111], v[56:59], v[52:55], v[96:111]
  s_add_u32 m0, s28, 131072
  s_add_u32 s25, s66, 0
  buffer_load_dwordx4 v4, s[8:11], s25 offen  lds
  v_mfma_f32_32x32x16_bf16 v[112:127], v[60:63], v[52:55], v[112:127]
  s_add_u32 m0, s28, 132096
  s_add_u32 s25, s66, 15360
  buffer_load_dwordx4 v4, s[8:11], s25 offen  lds
  s_add_u32 s66, s66, 245760
  s_cmp_eq_u32 s66, 2457600
  s_cselect_b32 s66, 0, s66
  s_waitcnt lgkmcnt(6)
  v_mfma_f32_32x32x16_bf16 v[64:79], v[152:155], v[144:147], v[64:79]
  ds_read_b128 v[48:51], v11 offset:49152
  ds_read_b128 v[52:55], v11 offset:53248
  ds_read_b64_tr_b16 v[56:57], v24 offset:28672
  v_mfma_f32_32x32x16_bf16 v[80:95], v[156:159], v[144:147], v[80:95]
  ds_read_b64_tr_b16 v[58:59], v24 offset:29696
  ds_read_b64_tr_b16 v[60:61], v25 offset:28672
  ds_read_b64_tr_b16 v[62:63], v25 offset:29696
  v_mfma_f32_32x32x16_bf16 v[96:111], v[152:155], v[148:151], v[96:111]
  s_add_u32 m0, s27, 0
  s_add_u32 s25, s65, 0
  buffer_load_dwordx4 v2, s[4:7], s25 offen  lds
  v_mfma_f32_32x32x16_bf16 v[112:127], v[156:159], v[148:151], v[112:127]
  s_add_u32 m0, s27, 1024
  s_add_u32 s25, s65, 10240
  buffer_load_dwordx4 v3, s[4:7], s25 offen  lds
  s_waitcnt vmcnt(2) lgkmcnt(0)
  s_barrier
  v_mfma_f32_32x32x16_bf16 v[64:79], v[40:43], v[32:35], v[64:79]
  ds_read_b128 v[144:147], v12 offset:32768
  ds_read_b128 v[148:151], v12 offset:36864
  ds_read_b64_tr_b16 v[152:153], v28 offset:0
  v_mfma_f32_32x32x16_bf16 v[80:95], v[44:47], v[32:35], v[80:95]
  ds_read_b64_tr_b16 v[154:155], v28 offset:1024
  ds_read_b64_tr_b16 v[156:157], v29 offset:0
  ds_read_b64_tr_b16 v[158:159], v29 offset:1024
  v_mfma_f32_32x32x16_bf16 v[96:111], v[40:43], v[36:39], v[96:111]
  s_add_u32 m0, s27, 2048
  s_add_u32 s25, s65, 20480
  buffer_load_dwordx4 v2, s[4:7], s25 offen  lds
  v_mfma_f32_32x32x16_bf16 v[112:127], v[44:47], v[36:39], v[112:127]
  s_add_u32 m0, s27, 3072
  s_add_u32 s25, s65, 30720
  buffer_load_dwordx4 v3, s[4:7], s25 offen  lds
  s_add_u32 s65, s65, 128
  s_cmp_eq_u32 s65, 1280
  s_cselect_b32 s65, 0, s65
  s_waitcnt lgkmcnt(6)
  v_mfma_f32_32x32x16_bf16 v[64:79], v[56:59], v[48:51], v[64:79]
  ds_read_b128 v[32:35], v13 offset:32768
  ds_read_b128 v[36:39], v13 offset:36864
  ds_read_b64_tr_b16 v[40:41], v28 offset:4096
  v_mfma_f32_32x32x16_bf16 v[80:95], v[60:63], v[48:51], v[80:95]
  ds_read_b64_tr_b16 v[42:43], v28 offset:5120
  ds_read_b64_tr_b16 v[44:45], v29 offset:4096
  ds_read_b64_tr_b16 v[46:47], v29 offset:5120
  v_mfma_f32_32x32x16_bf16 v[96:111], v[56:59], v[52:55], v[96:111]
  s_add_u32 m0, s28, 32768
  s_add_u32 s25, s66, 0
  buffer_load_dwordx4 v4, s[8:11], s25 offen  lds
  v_mfma_f32_32x32x16_bf16 v[112:127], v[60:63], v[52:55], v[112:127]
  s_add_u32 m0, s28, 33792
  s_add_u32 s25, s66, 15360
  buffer_load_dwordx4 v4, s[8:11], s25 offen  lds
  s_add_u32 s66, s66, 245760
  s_cmp_eq_u32 s66, 2457600
  s_cselect_b32 s66, 0, s66
  s_waitcnt lgkmcnt(6)
  v_mfma_f32_32x32x16_bf16 v[64:79], v[152:155], v[144:147], v[64:79]
  ds_read_b128 v[48:51], v14 offset:32768
  ds_read_b128 v[52:55], v14 offset:36864
  ds_read_b64_tr_b16 v[56:57], v28 offset:8192
  v_mfma_f32_32x32x16_bf16 v[80:95], v[156:159], v[144:147], v[80:95]
  ds_read_b64_tr_b16 v[58:59], v28 offset:9216
  ds_read_b64_tr_b16 v[60:61], v29 offset:8192
  ds_read_b64_tr_b16 v[62:63], v29 offset:9216
  v_mfma_f32_32x32x16_bf16 v[96:111], v[152:155], v[148:151], v[96:111]
  s_add_u32 m0, s27, 49152
  s_add_u32 s25, s65, 0
  buffer_load_dwordx4 v2, s[4:7], s25 offen  lds
  v_mfma_f32_32x32x16_bf16 v[112:127], v[156:159], v[148:151], v[112:127]
  s_add_u32 m0, s27, 50176
  s_add_u32 s25, s65, 10240
  buffer_load_dwordx4 v3, s[4:7], s25 offen  lds
  s_waitcnt lgkmcnt(6)
  v_mfma_f32_32x32x16_bf16 v[64:79], v[40:43], v[32:35], v[64:79]
  ds_read_b128 v[144:147], v15 offset:32768
  ds_read_b128 v[148:151], v15 offset:36864
  ds_read_b64_tr_b16 v[152:153], v28 offset:12288
  v_mfma_f32_32x32x16_bf16 v[80:95], v[44:47], v[32:35], v[80:95]
  ds_read_b64_tr_b16 v[154:155], v28 offset:13312
  ds_read_b64_tr_b16 v[156:157], v29 offset:12288
  ds_read_b64_tr_b16 v[158:159], v29 offset:13312
  v_mfma_f32_32x32x16_bf16 v[96:111], v[40:43], v[36:39], v[96:111]
  s_add_u32 m0, s27, 51200
  s_add_u32 s25, s65, 20480
  buffer_load_dwordx4 v2, s[4:7], s25 offen  lds
  v_mfma_f32_32x32x16_bf16 v[112:127], v[44:47], v[36:39], v[112:127]
  s_add_u32 m0, s27, 52224
  s_add_u32 s25, s65, 30720
  buffer_load_dwordx4 v3, s[4:7], s25 offen  lds
  s_add_u32 s65, s65, 128
  s_cmp_eq_u32 s65, 1280
  s_cselect_b32 s65, 0, s65
  s_waitcnt vmcnt(4) lgkmcnt(0)
  s_barrier
  v_mfma_f32_32x32x16_bf16 v[64:79], v[56:59], v[48:51], v[64:79]
  ds_read_b128 v[32:35], v8 offset:0
  ds_read_b128 v[36:39], v8 offset:4096
  ds_read_b64_tr_b16 v[40:41], v20 offset:32768
  v_mfma_f32_32x32x16_bf16 v[80:95], v[60:63], v[48:51], v[80:95]
  ds_read_b64_tr_b16 v[42:43], v20 offset:33792
  ds_read_b64_tr_b16 v[44:45], v21 offset:32768
  ds_read_b64_tr_b16 v[46:47], v21 offset:33792
  v_mfma_f32_32x32x16_bf16 v[96:111], v[56:59], v[52:55], v[96:111]
  s_add_u32 m0, s28, 81920
  s_add_u32 s25, s66, 0
  buffer_load_dwordx4 v4, s[8:11], s25 offen  lds
  v_mfma_f32_32x32x16_bf16 v[112:127], v[60:63], v[52:55], v[112:127]
  s_add_u32 m0, s28, 82944
  s_add_u32 s25, s66, 15360
  buffer_load_dwordx4 v4, s[8:11], s25 offen  lds
  s_add_u32 s66, s66, 245760
  s_cmp_eq_u32 s66, 2457600
  s_cselect_b32 s66, 0, s66
  s_waitcnt lgkmcnt(6)
  v_mfma_f32_32x32x16_bf16 v[64:79], v[152:155], v[144:147], v[64:79]
  ds_read_b128 v[48:51], v9 offset:0
  ds_read_b128 v[52:55], v9 offset:4096
  ds_read_b64_tr_b16 v[56:57], v20 offset:36864
  v_mfma_f32_32x32x16_bf16 v[80:95], v[156:159], v[144:147], v[80:95]
  ds_read_b64_tr_b16 v[58:59], v20 offset:37888
  ds_read_b64_tr_b16 v[60:61], v21 offset:36864
  ds_read_b64_tr_b16 v[62:63], v21 offset:37888
  v_mfma_f32_32x32x16_bf16 v[96:111], v[152:155], v[148:151], v[96:111]
  s_add_u32 m0, s27, 98304
  s_add_u32 s25, s65, 0
  buffer_load_dwordx4 v2, s[4:7], s25 offen  lds
  v_mfma_f32_32x32x16_bf16 v[112:127], v[156:159], v[148:151], v[112:127]
  s_add_u32 m0, s27, 99328
  s_add_u32 s25, s65, 10240
  buffer_load_dwordx4 v3, s[4:7], s25 offen  lds
  s_waitcnt lgkmcnt(6)
  v_mfma_f32_32x32x16_bf16 v[64:79], v[40:43], v[32:35], v[64:79]
  ds_read_b128 v[144:147], v10 offset:0
  ds_read_b128 v[148:151], v10 offset:4096
  ds_read_b64_tr_b16 v[152:153], v20 offset:40960
  v_mfma_f32_32x32x16_bf16 v[80:95], v[44:47], v[32:35], v[80:95]
  ds_read_b64_tr_b16 v[154:155], v20 offset:41984
  ds_read_b64_tr_b16 v[156:157], v21 offset:40960
  ds_read_b64_tr_b16 v[158:159], v21 offset:41984
  v_mfma_f32_32x32x16_bf16 v[96:111], v[40:43], v[36:39], v[96:111]
  s_add_u32 m0, s27, 100352
  s_add_u32 s25, s65, 20480
  buffer_load_dwordx4 v2, s[4:7], s25 offen  lds
  v_mfma_f32_32x32x16_bf16 v[112:127], v[44:47], v[36:39], v[112:127]
  s_add_u32 m0, s27, 101376
  s_add_u32 s25, s65, 30720
  buffer_load_dwordx4 v3, s[4:7], s25 offen  lds
  s_add_u32 s65, s65, 128
  s_cmp_eq_u32 s65, 1280
  s_cselect_b32 s65, 0, s65
  s_waitcnt lgkmcnt(6)
  v_mfma_f32_32x32x16_bf16 v[64:79], v[56:59], v[48:51], v[64:79]
  ds_read_b128 v[32:35], v11 offset:0
  ds_read_b128 v[36:39], v11 offset:4096
  ds_read_b64_tr_b16 v[40:41], v20 offset:45056
  v_mfma_f32_32x32x16_bf16 v[80:95], v[60:63], v[48:51], v[80:95]
  ds_read_b64_tr_b16 v[42:43], v20 offset:46080
  ds_read_b64_tr_b16 v[44:45], v21 offset:45056
  ds_read_b64_tr_b16 v[46:47], v21 offset:46080
  v_mfma_f32_32x32x16_bf16 v[96:111], v[56:59], v[52:55], v[96:111]
  s_add_u32 m0, s28, 131072
  s_add_u32 s25, s66, 0
  buffer_load_dwordx4 v4, s[8:11], s25 offen  lds
  v_mfma_f32_32x32x16_bf16 v[112:127], v[60:63], v[52:55], v[112:127]
  s_add_u32 m0, s28, 132096
  s_add_u32 s25, s66, 15360
  buffer_load_dwordx4 v4, s[8:11], s25 offen  lds
  s_add_u32 s66, s66, 245760
  s_cmp_eq_u32 s66, 2457600
  s_cselect_b32 s66, 0, s66
  s_waitcnt vmcnt(6) lgkmcnt(0)
  s_barrier
  v_mfma_f32_32x32x16_bf16 v[64:79], v[152:155], v[144:147], v[64:79]
  ds_read_b128 v[48:51], v8 offset:49152
  ds_read_b128 v[52:55], v8 offset:53248
  ds_read_b64_tr_b16 v[56:57], v24 offset:16384
  v_mfma_f32_32x32x16_bf16 v[80:95], v[156:159], v[144:147], v[80:95]
  ds_read_b64_tr_b16 v[58:59], v24 offset:17408
  ds_read_b64_tr_b16 v[60:61], v25 offset:16384
  ds_read_b64_tr_b16 v[62:63], v25 offset:17408
  v_mfma_f32_32x32x16_bf16 v[96:111], v[152:155], v[148:151], v[96:111]
  s_add_u32 m0, s27, 0
  s_add_u32 s25, s65, 0
  buffer_load_dwordx4 v2, s[4:7], s25 offen  lds
  v_mfma_f32_32x32x16_bf16 v[112:127], v[156:159], v[148:151], v[112:127]
  s_add_u32 m0, s27, 1024
  s_add_u32 s25, s65, 10240
  buffer_load_dwordx4 v3, s[4:7], s25 offen  lds
  s_waitcnt lgkmcnt(6)
  v_mfma_f32_32x32x16_bf16 v[64:79], v[40:43], v[32:35], v[64:79]
  ds_read_b128 v[144:147], v9 offset:49152
  ds_read_b128 v[148:151], v9 offset:53248
  ds_read_b64_tr_b16 v[152:153], v24 offset:20480
  v_mfma_f32_32x32x16_bf16 v[80:95], v[44:47], v[32:35], v[80:95]
  ds_read_b64_tr_b16 v[154:155], v24 offset:21504
  ds_read_b64_tr_b16 v[156:157], v25 offset:20480
  ds_read_b64_tr_b16 v[158:159], v25 offset:21504
  v_mfma_f32_32x32x16_bf16 v[96:111], v[40:43], v[36:39], v[96:111]
  s_add_u32 m0, s27, 2048
  s_add_u32 s25, s65, 20480
  buffer_load_dwordx4 v2, s[4:7], s25 offen  lds
  v_mfma_f32_32x32x16_bf16 v[112:127], v[44:47], v[36:39], v[112:127]
  s_add_u32 m0, s27, 3072
  s_add_u32 s25, s65, 30720
  buffer_load_dwordx4 v3, s[4:7], s25 offen  lds
  s_add_u32 s65, s65, 128
  s_cmp_eq_u32 s65, 1280
  s_cselect_b32 s65, 0, s65
  s_waitcnt lgkmcnt(6)
  v_mfma_f32_32x32x16_bf16 v[64:79], v[56:59], v[48:51], v[64:79]
  ds_read_b128 v[32:35], v10 offset:49152
  ds_read_b128 v[36:39], v10 offset:53248
  ds_read_b64_tr_b16 v[40:41], v24 offset:24576
  v_mfma_f32_32x32x16_bf16 v[80:95], v[60:63], v[48:51], v[80:95]
  ds_read_b64_tr_b16 v[42:43], v24 offset:25600
  ds_read_b64_tr_b16 v[44:45], v25 offset:24576
  ds_read_b64_tr_b16 v[46:47], v25 offset:25600
  v_mfma_f32_32x32x16_bf16 v[96:111], v[56:59], v[52:55], v[96:111]
  s_add_u32 m0, s28, 32768
  s_add_u32 s25, s66, 0
  buffer_load_dwordx4 v4, s[8:11], s25 offen  lds
  v_mfma_f32_32x32x16_bf16 v[112:127], v[60:63], v[52:55], v[112:127]
  s_add_u32 m0, s28, 33792
  s_add_u32 s25, s66, 15360
  buffer_load_dwordx4 v4, s[8:11], s25 offen  lds
  s_add_u32 s66, s66, 245760
  s_cmp_eq_u32 s66, 2457600
  s_cselect_b32 s66, 0, s66
  s_waitcnt lgkmcnt(6)
  v_mfma_f32_32x32x16_bf16 v[64:79], v[152:155], v[144:147], v[64:79]
  ds_read_b128 v[48:51], v11 offset:49152
  ds_read_b128 v[52:55], v11 offset:53248
  ds_read_b64_tr_b16 v[56:57], v24 offset:28672
  v_mfma_f32_32x32x16_bf16 v[80:95], v[156:159], v[144:147], v[80:95]
  ds_read_b64_tr_b16 v[58:59], v24 offset:29696
  ds_read_b64_tr_b16 v[60:61], v25 offset:28672
  ds_read_b64_tr_b16 v[62:63], v25 offset:29696
  v_mfma_f32_32x32x16_bf16 v[96:111], v[152:155], v[148:151], v[96:111]
  v_mfma_f32_32x32x16_bf16 v[112:127], v[156:159], v[148:151], v[112:127]
  s_waitcnt vmcnt(6) lgkmcnt(0)
  s_barrier
  v_mfma_f32_32x32x16_bf16 v[64:79], v[40:43], v[32:35], v[64:79]
  ds_read_b128 v[144:147], v12 offset:32768
  ds_read_b128 v[148:151], v12 offset:36864
  ds_read_b64_tr_b16 v[152:153], v28 offset:0
  v_mfma_f32_32x32x16_bf16 v[80:95], v[44:47], v[32:35], v[80:95]
  ds_read_b64_tr_b16 v[154:155], v28 offset:1024
  ds_read_b64_tr_b16 v[156:157], v29 offset:0
  ds_read_b64_tr_b16 v[158:159], v29 offset:1024
  v_mfma_f32_32x32x16_bf16 v[96:111], v[40:43], v[36:39], v[96:111]
  s_add_u32 m0, s27, 49152
  s_add_u32 s25, s65, 0
  buffer_load_dwordx4 v2, s[4:7], s25 offen  lds
  v_mfma_f32_32x32x16_bf16 v[112:127], v[44:47], v[36:39], v[112:127]
  s_add_u32 m0, s27, 50176
  s_add_u32 s25, s65, 10240
  buffer_load_dwordx4 v3, s[4:7], s25 offen  lds
  s_waitcnt lgkmcnt(6)
  v_mfma_f32_32x32x16_bf16 v[64:79], v[56:59], v[48:51], v[64:79]
  ds_read_b128 v[32:35], v13 offset:32768
  ds_read_b128 v[36:39], v13 offset:36864
  ds_read_b64_tr_b16 v[40:41], v28 offset:4096
  v_mfma_f32_32x32x16_bf16 v[80:95], v[60:63], v[48:51], v[80:95]
  ds_read_b64_tr_b16 v[42:43], v28 offset:5120
  ds_read_b64_tr_b16 v[44:45], v29 offset:4096
  ds_read_b64_tr_b16 v[46:47], v29 offset:5120
  v_mfma_f32_32x32x16_bf16 v[96:111], v[56:59], v[52:55], v[96:111]
  s_add_u32 m0, s27, 51200
  s_add_u32 s25, s65, 20480
  buffer_load_dwordx4 v2, s[4:7], s25 offen  lds
  v_mfma_f32_32x32x16_bf16 v[112:127], v[60:63], v[52:55], v[112:127]
  s_add_u32 m0, s27, 52224
  s_add_u32 s25, s65, 30720
  buffer_load_dwordx4 v3, s[4:7], s25 offen  lds
  s_add_u32 s65, s65, 128
  s_cmp_eq_u32 s65, 1280
  s_cselect_b32 s65, 0, s65
  s_waitcnt lgkmcnt(6)
  v_mfma_f32_32x32x16_bf16 v[64:79], v[152:155], v[144:147], v[64:79]
  ds_read_b128 v[48:51], v14 offset:32768
  ds_read_b128 v[52:55], v14 offset:36864
  ds_read_b64_tr_b16 v[56:57], v28 offset:8192
  v_mfma_f32_32x32x16_bf16 v[80:95], v[156:159], v[144:147], v[80:95]
  ds_read_b64_tr_b16 v[58:59], v28 offset:9216
  ds_read_b64_tr_b16 v[60:61], v29 offset:8192
  ds_read_b64_tr_b16 v[62:63], v29 offset:9216
  v_mfma_f32_32x32x16_bf16 v[96:111], v[152:155], v[148:151], v[96:111]
  s_add_u32 m0, s28, 81920
  s_add_u32 s25, s66, 0
  buffer_load_dwordx4 v4, s[8:11], s25 offen  lds
  v_mfma_f32_32x32x16_bf16 v[112:127], v[156:159], v[148:151], v[112:127]
  s_add_u32 m0, s28, 82944
  s_add_u32 s25, s66, 15360
  buffer_load_dwordx4 v4, s[8:11], s25 offen  lds
  s_add_u32 s66, s66, 245760
  s_cmp_eq_u32 s66, 2457600
  s_cselect_b32 s66, 0, s66
  s_waitcnt lgkmcnt(6)
  v_mfma_f32_32x32x16_bf16 v[64:79], v[40:43], v[32:35], v[64:79]
  ds_read_b128 v[144:147], v15 offset:32768
  ds_read_b128 v[148:151], v15 offset:36864
  ds_read_b64_tr_b16 v[152:153], v28 offset:12288
  v_mfma_f32_32x32x16_bf16 v[80:95], v[44:47], v[32:35], v[80:95]
  ds_read_b64_tr_b16 v[154:155], v28 offset:13312
  ds_read_b64_tr_b16 v[156:157], v29 offset:12288
  ds_read_b64_tr_b16 v[158:159], v29 offset:13312
  v_mfma_f32_32x32x16_bf16 v[96:111], v[40:43], v[36:39], v[96:111]
  v_mfma_f32_32x32x16_bf16 v[112:127], v[44:47], v[36:39], v[112:127]
  s_waitcnt vmcnt(6) lgkmcnt(0)
  s_barrier
  v_mfma_f32_32x32x16_bf16 v[64:79], v[56:59], v[48:51], v[64:79]
  ds_read_b128 v[32:35], v8 offset:0
  ds_read_b128 v[36:39], v8 offset:4096
  ds_read_b64_tr_b16 v[40:41], v20 offset:32768
  v_mfma_f32_32x32x16_bf16 v[80:95], v[60:63], v[48:51], v[80:95]
  ds_read_b64_tr_b16 v[42:43], v20 offset:33792
  ds_read_b64_tr_b16 v[44:45], v21 offset:32768
  ds_read_b64_tr_b16 v[46:47], v21 offset:33792
  v_mfma_f32_32x32x16_bf16 v[96:111], v[56:59], v[52:55], v[96:111]
  s_add_u32 m0, s27, 98304
  s_add_u32 s25, s65, 0
  buffer_load_dwordx4 v2, s[4:7], s25 offen  lds
  v_mfma_f32_32x32x16_bf16 v[112:127], v[60:63], v[52:55], v[112:127]
  s_add_u32 m0, s27, 99328
  s_add_u32 s25, s65, 10240
  buffer_load_dwordx4 v3, s[4:7], s25 offen  lds
  s_waitcnt lgkmcnt(6)
  v_mfma_f32_32x32x16_bf16 v[64:79], v[152:155], v[144:147], v[64:79]
  ds_read_b128 v[48:51], v9 offset:0
  ds_read_b128 v[52:55], v9 offset:4096
  ds_read_b64_tr_b16 v[56:57], v20 offset:36864
  v_mfma_f32_32x32x16_bf16 v[80:95], v[156:159], v[144:147], v[80:95]
  ds_read_b64_tr_b16 v[58:59], v20 offset:37888
  ds_read_b64_tr_b16 v[60:61], v21 offset:36864
  ds_read_b64_tr_b16 v[62:63], v21 offset:37888
  v_mfma_f32_32x32x16_bf16 v[96:111], v[152:155], v[148:151], v[96:111]
  s_add_u32 m0, s27, 100352
  s_add_u32 s25, s65, 20480
  buffer_load_dwordx4 v2, s[4:7], s25 offen  lds
  v_mfma_f32_32x32x16_bf16 v[112:127], v[156:159], v[148:151], v[112:127]
  s_add_u32 m0, s27, 101376
  s_add_u32 s25, s65, 30720
  buffer_load_dwordx4 v3, s[4:7], s25 offen  lds
  s_add_u32 s65, s65, 128
  s_cmp_eq_u32 s65, 1280
  s_cselect_b32 s65, 0, s65
  s_waitcnt lgkmcnt(6)
  v_mfma_f32_32x32x16_bf16 v[64:79], v[40:43], v[32:35], v[64:79]
  ds_read_b128 v[144:147], v10 offset:0
  ds_read_b128 v[148:151], v10 offset:4096
  ds_read_b64_tr_b16 v[152:153], v20 offset:40960
  v_mfma_f32_32x32x16_bf16 v[80:95], v[44:47], v[32:35], v[80:95]
  ds_read_b64_tr_b16 v[154:155], v20 offset:41984
  ds_read_b64_tr_b16 v[156:157], v21 offset:40960
  ds_read_b64_tr_b16 v[158:159], v21 offset:41984
  v_mfma_f32_32x32x16_bf16 v[96:111], v[40:43], v[36:39], v[96:111]
  s_add_u32 m0, s28, 131072
  s_add_u32 s25, s66, 0
  buffer_load_dwordx4 v4, s[8:11], s25 offen  lds
  v_mfma_f32_32x32x16_bf16 v[112:127], v[44:47], v[36:39], v[112:127]
  s_add_u32 m0, s28, 132096
  s_add_u32 s25, s66, 15360
  buffer_load_dwordx4 v4, s[8:11], s25 offen  lds
  s_add_u32 s66, s66, 245760
  s_cmp_eq_u32 s66, 2457600
  s_cselect_b32 s66, 0, s66
  s_waitcnt lgkmcnt(6)
  v_mfma_f32_32x32x16_bf16 v[64:79], v[56:59], v[48:51], v[64:79]
  ds_read_b128 v[32:35], v11 offset:0
  ds_read_b128 v[36:39], v11 offset:4096
  ds_read_b64_tr_b16 v[40:41], v20 offset:45056
  v_mfma_f32_32x32x16_bf16 v[80:95], v[60:63], v[48:51], v[80:95]
  ds_read_b64_tr_b16 v[42:43], v20 offset:46080
  ds_read_b64_tr_b16 v[44:45], v21 offset:45056
  ds_read_b64_tr_b16 v[46:47], v21 offset:46080
  v_mfma_f32_32x32x16_bf16 v[96:111], v[56:59], v[52:55], v[96:111]
  v_mfma_f32_32x32x16_bf16 v[112:127], v[60:63], v[52:55], v[112:127]
  s_waitcnt vmcnt(6) lgkmcnt(0)
  s_barrier
  v_mfma_f32_32x32x16_bf16 v[64:79], v[152:155], v[144:147], v[64:79]
  ds_read_b128 v[48:51], v8 offset:49152
  ds_read_b64_tr_b16 v[56:57], v24 offset:16384
  ds_read_b64_tr_b16 v[58:59], v24 offset:17408
  v_mfma_f32_32x32x16_bf16 v[80:95], v[156:159], v[144:147], v[80:95]
  ds_read_b64_tr_b16 v[60:61], v25 offset:16384
  ds_read_b64_tr_b16 v[62:63], v25 offset:17408
  v_mfma_f32_32x32x16_bf16 v[96:111], v[152:155], v[148:151], v[96:111]
  s_add_u32 m0, s27, 0
  s_add_u32 s25, s65, 0
  buffer_load_dwordx4 v2, s[4:7], s25 offen  lds
  v_mfma_f32_32x32x16_bf16 v[112:127], v[156:159], v[148:151], v[112:127]
  s_add_u32 m0, s27, 1024
  s_add_u32 s25, s65, 10240
  buffer_load_dwordx4 v3, s[4:7], s25 offen  lds
  s_waitcnt lgkmcnt(5)
  v_mfma_f32_32x32x16_bf16 v[64:79], v[40:43], v[32:35], v[64:79]
  ds_read_b128 v[144:147], v9 offset:49152
  ds_read_b64_tr_b16 v[152:153], v24 offset:20480
  ds_read_b64_tr_b16 v[154:155], v24 offset:21504
  v_mfma_f32_32x32x16_bf16 v[80:95], v[44:47], v[32:35], v[80:95]
  ds_read_b64_tr_b16 v[156:157], v25 offset:20480
  ds_read_b64_tr_b16 v[158:159], v25 offset:21504
  v_mfma_f32_32x32x16_bf16 v[96:111], v[40:43], v[36:39], v[96:111]
  s_add_u32 m0, s27, 2048
  s_add_u32 s25, s65, 20480
  buffer_load_dwordx4 v2, s[4:7], s25 offen  lds
  v_mfma_f32_32x32x16_bf16 v[112:127], v[44:47], v[36:39], v[112:127]
  s_add_u32 m0, s27, 3072
  s_add_u32 s25, s65, 30720
  buffer_load_dwordx4 v3, s[4:7], s25 offen  lds
  s_waitcnt lgkmcnt(5)
  v_mfma_f32_32x32x16_bf16 v[64:79], v[56:59], v[48:51], v[64:79]
  ds_read_b128 v[32:35], v10 offset:49152
  ds_read_b64_tr_b16 v[40:41], v24 offset:24576
  ds_read_b64_tr_b16 v[42:43], v24 offset:25600
  ds_read_b64_tr_b16 v[44:45], v25 offset:24576
  ds_read_b64_tr_b16 v[46:47], v25 offset:25600
  v_mfma_f32_32x32x16_bf16 v[80:95], v[60:63], v[48:51], v[80:95]
  s_add_u32 m0, s28, 32768
  s_add_u32 s25, s66, 0
  buffer_load_dwordx4 v4, s[8:11], s25 offen  lds
  s_add_u32 m0, s28, 33792
  s_add_u32 s25, s66, 15360
  buffer_load_dwordx4 v4, s[8:11], s25 offen  lds
  s_waitcnt lgkmcnt(5)
  v_mfma_f32_32x32x16_bf16 v[64:79], v[152:155], v[144:147], v[64:79]
  ds_read_b128 v[48:51], v11 offset:49152
  ds_read_b64_tr_b16 v[56:57], v24 offset:28672
  ds_read_b64_tr_b16 v[58:59], v24 offset:29696
  ds_read_b64_tr_b16 v[60:61], v25 offset:28672
  ds_read_b64_tr_b16 v[62:63], v25 offset:29696
  v_mfma_f32_32x32x16_bf16 v[80:95], v[156:159], v[144:147], v[80:95]
  s_waitcnt vmcnt(6) lgkmcnt(0)
  s_barrier
  v_mfma_f32_32x32x16_bf16 v[64:79], v[40:43], v[32:35], v[64:79]
  ds_read_b128 v[144:147], v12 offset:32768
  ds_read_b64_tr_b16 v[152:153], v28 offset:0
  ds_read_b64_tr_b16 v[154:155], v28 offset:1024
  ds_read_b64_tr_b16 v[156:157], v29 offset:0
  ds_read_b64_tr_b16 v[158:159], v29 offset:1024
  v_mfma_f32_32x32x16_bf16 v[80:95], v[44:47], v[32:35], v[80:95]
  s_mov_b32 s68, s58
  s_and_b32 s69, s59, 0xffff
  s_mov_b32 s70, 256
  s_mov_b32 s71, 0x00020000
  v_mov_b32 v130, 0
  buffer_load_dword v130, v130, s[68:71], 0 offen sc1
  s_waitcnt lgkmcnt(5)
  v_mfma_f32_32x32x16_bf16 v[64:79], v[56:59], v[48:51], v[64:79]
  ds_read_b128 v[32:35], v13 offset:32768
  ds_read_b64_tr_b16 v[40:41], v28 offset:4096
  ds_read_b64_tr_b16 v[42:43], v28 offset:5120
  ds_read_b64_tr_b16 v[44:45], v29 offset:4096
  ds_read_b64_tr_b16 v[46:47], v29 offset:5120
  v_mfma_f32_32x32x16_bf16 v[80:95], v[60:63], v[48:51], v[80:95]
  s_waitcnt lgkmcnt(5)
  v_mfma_f32_32x32x16_bf16 v[64:79], v[152:155], v[144:147], v[64:79]
  ds_read_b128 v[48:51], v14 offset:32768
  ds_read_b64_tr_b16 v[56:57], v28 offset:8192
  ds_read_b64_tr_b16 v[58:59], v28 offset:9216
  ds_read_b64_tr_b16 v[60:61], v29 offset:8192
  ds_read_b64_tr_b16 v[62:63], v29 offset:9216
  v_mfma_f32_32x32x16_bf16 v[80:95], v[156:159], v[144:147], v[80:95]
  s_waitcnt lgkmcnt(5)
  v_mfma_f32_32x32x16_bf16 v[64:79], v[40:43], v[32:35], v[64:79]
  ds_read_b128 v[144:147], v15 offset:32768
  ds_read_b64_tr_b16 v[152:153], v28 offset:12288
  ds_read_b64_tr_b16 v[154:155], v28 offset:13312
  ds_read_b64_tr_b16 v[156:157], v29 offset:12288
  ds_read_b64_tr_b16 v[158:159], v29 offset:13312
  v_mfma_f32_32x32x16_bf16 v[80:95], v[44:47], v[32:35], v[80:95]
  s_waitcnt vmcnt(1) lgkmcnt(0)
  s_barrier
  v_mfma_f32_32x32x16_bf16 v[64:79], v[56:59], v[48:51], v[64:79]
  ds_read_b128 v[32:35], v8 offset:0
  ds_read_b64_tr_b16 v[40:41], v20 offset:32768
  ds_read_b64_tr_b16 v[42:43], v20 offset:33792
  ds_read_b64_tr_b16 v[44:45], v21 offset:32768
  ds_read_b64_tr_b16 v[46:47], v21 offset:33792
  v_mfma_f32_32x32x16_bf16 v[80:95], v[60:63], v[48:51], v[80:95]
  s_waitcnt lgkmcnt(5)
  v_mfma_f32_32x32x16_bf16 v[64:79], v[152:155], v[144:147], v[64:79]
  ds_read_b128 v[48:51], v9 offset:0
  ds_read_b64_tr_b16 v[56:57], v20 offset:36864
  ds_read_b64_tr_b16 v[58:59], v20 offset:37888
  ds_read_b64_tr_b16 v[60:61], v21 offset:36864
  ds_read_b64_tr_b16 v[62:63], v21 offset:37888
  v_mfma_f32_32x32x16_bf16 v[80:95], v[156:159], v[144:147], v[80:95]
  s_waitcnt lgkmcnt(5)
  v_mfma_f32_32x32x16_bf16 v[64:79], v[40:43], v[32:35], v[64:79]
  ds_read_b128 v[144:147], v10 offset:0
  ds_read_b64_tr_b16 v[152:153], v20 offset:40960
  ds_read_b64_tr_b16 v[154:155], v20 offset:41984
  ds_read_b64_tr_b16 v[156:157], v21 offset:40960
  ds_read_b64_tr_b16 v[158:159], v21 offset:41984
  v_mfma_f32_32x32x16_bf16 v[80:95], v[44:47], v[32:35], v[80:95]
  s_waitcnt lgkmcnt(5)
  v_mfma_f32_32x32x16_bf16 v[64:79], v[56:59], v[48:51], v[64:79]
  ds_read_b128 v[32:35], v11 offset:0
  ds_read_b64_tr_b16 v[40:41], v20 offset:45056
  ds_read_b64_tr_b16 v[42:43], v20 offset:46080
  ds_read_b64_tr_b16 v[44:45], v21 offset:45056
  ds_read_b64_tr_b16 v[46:47], v21 offset:46080
  v_mfma_f32_32x32x16_bf16 v[80:95], v[60:63], v[48:51], v[80:95]
  s_waitcnt lgkmcnt(5)
  v_mfma_f32_32x32x16_bf16 v[64:79], v[152:155], v[144:147], v[64:79]
  ds_read_b128 v[52:55], v8 offset:53248
  ds_read_b64_tr_b16 v[56:57], v24 offset:16384
  ds_read_b64_tr_b16 v[58:59], v24 offset:17408
  v_mfma_f32_32x32x16_bf16 v[80:95], v[156:159], v[144:147], v[80:95]
  s_waitcnt lgkmcnt(3)
  v_mfma_f32_32x32x16_bf16 v[64:79], v[40:43], v[32:35], v[64:79]
  ds_read_b128 v[148:151], v9 offset:53248
  ds_read_b64_tr_b16 v[152:153], v24 offset:20480
  ds_read_b64_tr_b16 v[154:155], v24 offset:21504
  v_mfma_f32_32x32x16_bf16 v[80:95], v[44:47], v[32:35], v[80:95]
  s_waitcnt lgkmcnt(3)
  v_mfma_f32_32x32x16_bf16 v[96:111], v[56:59], v[52:55], v[96:111]
  ds_read_b128 v[36:39], v10 offset:53248
  ds_read_b64_tr_b16 v[40:41], v24 offset:24576
  ds_read_b64_tr_b16 v[42:43], v24 offset:25600
  s_waitcnt lgkmcnt(3)
  v_mfma_f32_32x32x16_bf16 v[96:111], v[152:155], v[148:151], v[96:111]
  ds_read_b128 v[52:55], v11 offset:53248
  ds_read_b64_tr_b16 v[56:57], v24 offset:28672
  ds_read_b64_tr_b16 v[58:59], v24 offset:29696
  v_mul_f32 v64, s72, v64
  v_mul_f32 v65, s72, v65
  v_mul_f32 v66, s72, v66
  v_mul_f32 v67, s72, v67
  v_mul_f32 v68, s72, v68
  v_mul_f32 v69, s72, v69
  v_mul_f32 v70, s72, v70
  v_mul_f32 v71, s72, v71
  s_add_u32 s73, s67, 0
  v_cvt_pk_bf16_f32 v168, v64, v65
  v_cvt_pk_bf16_f32 v169, v66, v67
  v_cvt_pk_bf16_f32 v170, v68, v69
  v_cvt_pk_bf16_f32 v171, v70, v71
  buffer_store_dwordx4 v[168:171], v128, s[12:15], s73 offen offset:0 sc1
  s_waitcnt lgkmcnt(3)
  v_mfma_f32_32x32x16_bf16 v[96:111], v[40:43], v[36:39], v[96:111]
  ds_read_b128 v[148:151], v12 offset:36864
  ds_read_b64_tr_b16 v[152:153], v28 offset:0
  ds_read_b64_tr_b16 v[154:155], v28 offset:1024
  v_mul_f32 v72, s72, v72
  v_mul_f32 v73, s72, v73
  v_mul_f32 v74, s72, v74
  v_mul_f32 v75, s72, v75
  v_mul_f32 v76, s72, v76
  v_mul_f32 v77, s72, v77
  v_mul_f32 v78, s72, v78
  v_mul_f32 v79, s72, v79
  s_add_u32 s73, s67, 4096
  v_cvt_pk_bf16_f32 v172, v72, v73
  v_cvt_pk_bf16_f32 v173, v74, v75
  v_cvt_pk_bf16_f32 v174, v76, v77
  v_cvt_pk_bf16_f32 v175, v78, v79
  buffer_store_dwordx4 v[172:175], v128, s[12:15], s73 offen offset:0 sc1
  s_waitcnt lgkmcnt(3)
  v_mfma_f32_32x32x16_bf16 v[96:111], v[56:59], v[52:55], v[96:111]
  ds_read_b128 v[36:39], v13 offset:36864
  ds_read_b64_tr_b16 v[40:41], v28 offset:4096
  ds_read_b64_tr_b16 v[42:43], v28 offset:5120
  v_mul_f32 v80, s72, v80
  v_mul_f32 v81, s72, v81
  v_mul_f32 v82, s72, v82
  v_mul_f32 v83, s72, v83
  v_mul_f32 v84, s72, v84
  v_mul_f32 v85, s72, v85
  v_mul_f32 v86, s72, v86
  v_mul_f32 v87, s72, v87
  s_add_u32 s73, s67, 8192
  v_cvt_pk_bf16_f32 v176, v80, v81
  v_cvt_pk_bf16_f32 v177, v82, v83
  v_cvt_pk_bf16_f32 v178, v84, v85
  v_cvt_pk_bf16_f32 v179, v86, v87
  buffer_store_dwordx4 v[176:179], v128, s[12:15], s73 offen offset:0 sc1
  s_waitcnt lgkmcnt(3)
  v_mfma_f32_32x32x16_bf16 v[96:111], v[152:155], v[148:151], v[96:111]
  ds_read_b128 v[52:55], v14 offset:36864
  ds_read_b64_tr_b16 v[56:57], v28 offset:8192
  ds_read_b64_tr_b16 v[58:59], v28 offset:9216
  v_mul_f32 v88, s72, v88
  v_mul_f32 v89, s72, v89
  v_mul_f32 v90, s72, v90
  v_mul_f32 v91, s72, v91
  v_mul_f32 v92, s72, v92
  v_mul_f32 v93, s72, v93
  v_mul_f32 v94, s72, v94
  v_mul_f32 v95, s72, v95
  s_add_u32 s73, s67, 12288
  v_cvt_pk_bf16_f32 v180, v88, v89
  v_cvt_pk_bf16_f32 v181, v90, v91
  v_cvt_pk_bf16_f32 v182, v92, v93
  v_cvt_pk_bf16_f32 v183, v94, v95
  buffer_store_dwordx4 v[180:183], v128, s[12:15], s73 offen offset:0 sc1
  s_waitcnt lgkmcnt(3)
  v_mfma_f32_32x32x16_bf16 v[96:111], v[40:43], v[36:39], v[96:111]
  ds_read_b128 v[148:151], v15 offset:36864
  ds_read_b64_tr_b16 v[152:153], v28 offset:12288
  ds_read_b64_tr_b16 v[154:155], v28 offset:13312
  s_waitcnt lgkmcnt(3)
  v_mfma_f32_32x32x16_bf16 v[96:111], v[56:59], v[52:55], v[96:111]
  ds_read_b128 v[36:39], v8 offset:4096
  ds_read_b64_tr_b16 v[40:41], v20 offset:32768
  ds_read_b64_tr_b16 v[42:43], v20 offset:33792
  s_waitcnt lgkmcnt(3)
  v_mfma_f32_32x32x16_bf16 v[96:111], v[152:155], v[148:151], v[96:111]
  ds_read_b128 v[52:55], v9 offset:4096
  ds_read_b64_tr_b16 v[56:57], v20 offset:36864
  ds_read_b64_tr_b16 v[58:59], v20 offset:37888
  s_waitcnt lgkmcnt(3)
  v_mfma_f32_32x32x16_bf16 v[96:111], v[40:43], v[36:39], v[96:111]
  ds_read_b128 v[148:151], v10 offset:4096
  ds_read_b64_tr_b16 v[152:153], v20 offset:40960
  ds_read_b64_tr_b16 v[154:155], v20 offset:41984
  s_waitcnt lgkmcnt(3)
  v_mfma_f32_32x32x16_bf16 v[96:111], v[56:59], v[52:55], v[96:111]
  ds_read_b128 v[36:39], v11 offset:4096
  ds_read_b64_tr_b16 v[40:41], v20 offset:45056
  ds_read_b64_tr_b16 v[42:43], v20 offset:46080
  s_waitcnt lgkmcnt(3)
  v_mfma_f32_32x32x16_bf16 v[96:111], v[152:155], v[148:151], v[96:111]
  ds_read_b128 v[52:55], v8 offset:53248
  ds_read_b64_tr_b16 v[60:61], v25 offset:16384
  ds_read_b64_tr_b16 v[62:63], v25 offset:17408
  s_waitcnt lgkmcnt(3)
  v_mfma_f32_32x32x16_bf16 v[96:111], v[40:43], v[36:39], v[96:111]
  ds_read_b128 v[148:151], v9 offset:53248
  ds_read_b64_tr_b16 v[156:157], v25 offset:20480
  ds_read_b64_tr_b16 v[158:159], v25 offset:21504
  s_waitcnt lgkmcnt(3)
  v_mfma_f32_32x32x16_bf16 v[112:127], v[60:63], v[52:55], v[112:127]
  ds_read_b128 v[36:39], v10 offset:53248
  ds_read_b64_tr_b16 v[44:45], v25 offset:24576
  ds_read_b64_tr_b16 v[46:47], v25 offset:25600
  s_waitcnt lgkmcnt(3)
  v_mfma_f32_32x32x16_bf16 v[112:127], v[156:159], v[148:151], v[112:127]
  ds_read_b128 v[52:55], v11 offset:53248
  ds_read_b64_tr_b16 v[60:61], v25 offset:28672
  ds_read_b64_tr_b16 v[62:63], v25 offset:29696
  s_waitcnt lgkmcnt(3)
  v_mfma_f32_32x32x16_bf16 v[112:127], v[44:47], v[36:39], v[112:127]
  ds_read_b128 v[148:151], v12 offset:36864
  ds_read_b64_tr_b16 v[156:157], v29 offset:0
  ds_read_b64_tr_b16 v[158:159], v29 offset:1024
  v_mul_f32 v96, s72, v96
  v_mul_f32 v97, s72, v97
  v_mul_f32 v98, s72, v98
  v_mul_f32 v99, s72, v99
  v_mul_f32 v100, s72, v100
  v_mul_f32 v101, s72, v101
  v_mul_f32 v102, s72, v102
  v_mul_f32 v103, s72, v103
  s_add_u32 s73, s67, 0
  v_cvt_pk_bf16_f32 v184, v96, v97
  v_cvt_pk_bf16_f32 v185, v98, v99
  v_cvt_pk_bf16_f32 v186, v100, v101
  v_cvt_pk_bf16_f32 v187, v102, v103
  buffer_store_dwordx4 v[184:187], v128, s[12:15], s73 offen offset:512 sc1
  s_waitcnt lgkmcnt(3)
  v_mfma_f32_32x32x16_bf16 v[112:127], v[60:63], v[52:55], v[112:127]
  ds_read_b128 v[36:39], v13 offset:36864
  ds_read_b64_tr_b16 v[44:45], v29 offset:4096
  ds_read_b64_tr_b16 v[46:47], v29 offset:5120
  v_mul_f32 v104, s72, v104
  v_mul_f32 v105, s72, v105
  v_mul_f32 v106, s72, v106
  v_mul_f32 v107, s72, v107
  v_mul_f32 v108, s72, v108
  v_mul_f32 v109, s72, v109
  v_mul_f32 v110, s72, v110
  v_mul_f32 v111, s72, v111
  s_add_u32 s73, s67, 4096
  v_cvt_pk_bf16_f32 v188, v104, v105
  v_cvt_pk_bf16_f32 v189, v106, v107
  v_cvt_pk_bf16_f32 v190, v108, v109
  v_cvt_pk_bf16_f32 v191, v110, v111
  buffer_store_dwordx4 v[188:191], v128, s[12:15], s73 offen offset:512 sc1
  s_waitcnt lgkmcnt(3)
  v_mfma_f32_32x32x16_bf16 v[112:127], v[156:159], v[148:151], v[112:127]
  ds_read_b128 v[52:55], v14 offset:36864
  ds_read_b64_tr_b16 v[60:61], v29 offset:8192
  ds_read_b64_tr_b16 v[62:63], v29 offset:9216
  s_waitcnt lgkmcnt(3)
  v_mfma_f32_32x32x16_bf16 v[112:127], v[44:47], v[36:39], v[112:127]
  ds_read_b128 v[148:151], v15 offset:36864
  ds_read_b64_tr_b16 v[156:157], v29 offset:12288
  ds_read_b64_tr_b16 v[158:159], v29 offset:13312
  s_waitcnt lgkmcnt(3)
  v_mfma_f32_32x32x16_bf16 v[112:127], v[60:63], v[52:55], v[112:127]
  ds_read_b128 v[36:39], v8 offset:4096
  ds_read_b64_tr_b16 v[44:45], v21 offset:32768
  ds_read_b64_tr_b16 v[46:47], v21 offset:33792
  s_waitcnt lgkmcnt(3)
  v_mfma_f32_32x32x16_bf16 v[112:127], v[156:159], v[148:151], v[112:127]
  ds_read_b128 v[52:55], v9 offset:4096
  ds_read_b64_tr_b16 v[60:61], v21 offset:36864
  ds_read_b64_tr_b16 v[62:63], v21 offset:37888
  s_waitcnt lgkmcnt(3)
  v_mfma_f32_32x32x16_bf16 v[112:127], v[44:47], v[36:39], v[112:127]
  ds_read_b128 v[148:151], v10 offset:4096
  ds_read_b64_tr_b16 v[156:157], v21 offset:40960
  ds_read_b64_tr_b16 v[158:159], v21 offset:41984
  s_waitcnt lgkmcnt(3)
  v_mfma_f32_32x32x16_bf16 v[112:127], v[60:63], v[52:55], v[112:127]
  ds_read_b128 v[36:39], v11 offset:4096
  ds_read_b64_tr_b16 v[44:45], v21 offset:45056
  ds_read_b64_tr_b16 v[46:47], v21 offset:46080
  s_waitcnt lgkmcnt(3)
  v_mfma_f32_32x32x16_bf16 v[112:127], v[156:159], v[148:151], v[112:127]
  s_waitcnt lgkmcnt(0)
  v_mfma_f32_32x32x16_bf16 v[112:127], v[44:47], v[36:39], v[112:127]
  s_nop 11
  v_mul_f32 v112, s72, v112
  v_mul_f32 v113, s72, v113
  v_mul_f32 v114, s72, v114
  v_mul_f32 v115, s72, v115
  v_mul_f32 v116, s72, v116
  v_mul_f32 v117, s72, v117
  v_mul_f32 v118, s72, v118
  v_mul_f32 v119, s72, v119
  s_add_u32 s73, s67, 8192
  v_cvt_pk_bf16_f32 v192, v112, v113
  v_cvt_pk_bf16_f32 v193, v114, v115
  v_cvt_pk_bf16_f32 v194, v116, v117
  v_cvt_pk_bf16_f32 v195, v118, v119
  buffer_store_dwordx4 v[192:195], v128, s[12:15], s73 offen offset:512 sc1
  v_mul_f32 v120, s72, v120
  v_mul_f32 v121, s72, v121
  v_mul_f32 v122, s72, v122
  v_mul_f32 v123, s72, v123
  v_mul_f32 v124, s72, v124
  v_mul_f32 v125, s72, v125
  v_mul_f32 v126, s72, v126
  v_mul_f32 v127, s72, v127
  s_add_u32 s73, s67, 12288
  v_cvt_pk_bf16_f32 v196, v120, v121
  v_cvt_pk_bf16_f32 v197, v122, v123
  v_cvt_pk_bf16_f32 v198, v124, v125
  v_cvt_pk_bf16_f32 v199, v126, v127
  buffer_store_dwordx4 v[196:199], v128, s[12:15], s73 offen offset:512 sc1
  s_branch L_qkv_pub
L_qkv_v:
  v_and_b32 v6, 31, v1
  v_lshrrev_b32 v9, 5, v1
  v_mov_b32 v7, v6
  v_bfe_u32 v8, v7, 1, 3
  v_xor_b32 v8, v8, v9
  v_lshlrev_b32 v8, 4, v8
  v_lshl_add_u32 v8, v7, 7, v8
  s_mul_i32 s25, s21, 8192
  v_add_u32 v8, s25, v8
  v_xor_b32 v9, 32, v8
  v_xor_b32 v10, 64, v8
  v_xor_b32 v11, 96, v8
  v_add_u32 v12, 0x10000, v8
  v_add_u32 v13, 0x10000, v9
  v_add_u32 v14, 0x10000, v10
  v_add_u32 v15, 0x10000, v11
  v_add_u32 v16, 0x20000, v8
  v_add_u32 v17, 0x20000, v9
  v_add_u32 v18, 0x20000, v10
  v_add_u32 v19, 0x20000, v11
  v_bfe_u32 v6, v1, 2, 2
  v_lshrrev_b32 v7, 5, v1
  v_lshl_add_u32 v7, v7, 3, v6
  v_lshlrev_b32 v7, 8, v7
  v_bfe_u32 v20, v1, 4, 1
  v_lshl_add_u32 v7, v20, 5, v7
  v_and_b32 v20, 3, v1
  v_lshl_add_u32 v7, v20, 3, v7
  v_lshlrev_b32 v6, 2, v6
  s_mul_i32 s25, s22, 8
  v_xor_b32 v20, s25, v6
  v_lshl_add_u32 v20, v20, 4, v7
  s_add_u32 s25, s25, 4
  v_xor_b32 v21, s25, v6
  v_lshl_add_u32 v21, v21, 4, v7
  v_add_u32 v24, 0x10000, v20
  v_add_u32 v25, 0x10000, v21
  v_add_u32 v28, 0x20000, v20
  v_add_u32 v29, 0x20000, v21
  s_sub_u32 s25, s30, 10
  s_lshl_b32 s25, s25, 7
  s_lshl_b32 s26, s22, 6
  s_add_u32 s25, s25, s26
  s_mul_i32 s67, s62, 5120
  s_mul_i32 s26, s63, 2560
  s_add_u32 s67, s67, s26
  s_add_u32 s67, s67, 5242880
  v_and_b32 v6, 31, v1
  v_add_u32 v6, s25, v6
  v_lshrrev_b32 v7, 5, v1
  v_mul_u32_u24 v7, 320, v7
  s_mov_b32 s72, 52429
  v_add_u32 v130, 0, v6
  v_mul_u32_u24 v131, s72, v130
  v_lshrrev_b32 v131, 20, v131
  v_mul_u32_u24 v132, 20, v131
  v_sub_u32 v132, v130, v132
  v_mul_u32_u24 v131, 81920, v131
  v_add_u32 v131, v131, v7
  v_lshl_add_u32 v128, v132, 4, v131
  v_add_u32 v130, 32, v6
  v_mul_u32_u24 v131, s72, v130
  v_lshrrev_b32 v131, 20, v131
  v_mul_u32_u24 v132, 20, v131
  v_sub_u32 v132, v130, v132
  v_mul_u32_u24 v131, 81920, v131
  v_add_u32 v131, v131, v7
  v_lshl_add_u32 v129, v132, 4, v131
  s_waitcnt vmcnt(0)
  s_barrier
  ds_read_b128 v[32:35], v8 offset:0
  ds_read_b128 v[36:39], v8 offset:4096
  ds_read_b64_tr_b16 v[40:41], v20 offset:32768
  ds_read_b64_tr_b16 v[42:43], v20 offset:33792
  ds_read_b64_tr_b16 v[44:45], v21 offset:32768
  ds_read_b64_tr_b16 v[46:47], v21 offset:33792
  ds_read_b128 v[48:51], v9 offset:0
  ds_read_b128 v[52:55], v9 offset:4096
  ds_read_b64_tr_b16 v[56:57], v20 offset:36864
  ds_read_b64_tr_b16 v[58:59], v20 offset:37888
  ds_read_b64_tr_b16 v[60:61], v21 offset:36864
  ds_read_b64_tr_b16 v[62:63], v21 offset:37888
  s_waitcnt lgkmcnt(6)
  v_mfma_f32_32x32x16_bf16 v[64:79], v[32:35], v[40:43], 0
  ds_read_b128 v[144:147], v10 offset:0
  ds_read_b128 v[148:151], v10 offset:4096
  ds_read_b64_tr_b16 v[152:153], v20 offset:40960
  v_mfma_f32_32x32x16_bf16 v[80:95], v[32:35], v[44:47], 0
  ds_read_b64_tr_b16 v[154:155], v20 offset:41984
  ds_read_b64_tr_b16 v[156:157], v21 offset:40960
  ds_read_b64_tr_b16 v[158:159], v21 offset:41984
  v_mfma_f32_32x32x16_bf16 v[96:111], v[36:39], v[40:43], 0
  s_add_u32 m0, s27, 49152
  s_add_u32 s25, s65, 0
  buffer_load_dwordx4 v2, s[4:7], s25 offen  lds
  v_mfma_f32_32x32x16_bf16 v[112:127], v[36:39], v[44:47], 0
  s_add_u32 m0, s27, 50176
  s_add_u32 s25, s65, 10240
  buffer_load_dwordx4 v3, s[4:7], s25 offen  lds
  s_waitcnt lgkmcnt(6)
  v_mfma_f32_32x32x16_bf16 v[64:79], v[48:51], v[56:59], v[64:79]
  ds_read_b128 v[32:35], v11 offset:0
  ds_read_b128 v[36:39], v11 offset:4096
  ds_read_b64_tr_b16 v[40:41], v20 offset:45056
  v_mfma_f32_32x32x16_bf16 v[80:95], v[48:51], v[60:63], v[80:95]
  ds_read_b64_tr_b16 v[42:43], v20 offset:46080
  ds_read_b64_tr_b16 v[44:45], v21 offset:45056
  ds_read_b64_tr_b16 v[46:47], v21 offset:46080
  v_mfma_f32_32x32x16_bf16 v[96:111], v[52:55], v[56:59], v[96:111]
  s_add_u32 m0, s27, 51200
  s_add_u32 s25, s65, 20480
  buffer_load_dwordx4 v2, s[4:7], s25 offen  lds
  v_mfma_f32_32x32x16_bf16 v[112:127], v[52:55], v[60:63], v[112:127]
  s_add_u32 m0, s27, 52224
  s_add_u32 s25, s65, 30720
  buffer_load_dwordx4 v3, s[4:7], s25 offen  lds
  s_add_u32 s65, s65, 128
  s_cmp_eq_u32 s65, 1280
  s_cselect_b32 s65, 0, s65
  s_add_u32 m0, s28, 81920
  s_add_u32 s25, s66, 0
  buffer_load_dwordx4 v4, s[8:11], s25 offen  lds
  s_add_u32 m0, s28, 82944
  s_add_u32 s25, s66, 15360
  buffer_load_dwordx4 v4, s[8:11], s25 offen  lds
  s_add_u32 s66, s66, 245760
  s_cmp_eq_u32 s66, 2457600
  s_cselect_b32 s66, 0, s66
  s_waitcnt vmcnt(0) lgkmcnt(0)
  s_barrier
  v_mfma_f32_32x32x16_bf16 v[64:79], v[144:147], v[152:155], v[64:79]
  ds_read_b128 v[48:51], v8 offset:49152
  ds_read_b128 v[52:55], v8 offset:53248
  ds_read_b64_tr_b16 v[56:57], v24 offset:16384
  v_mfma_f32_32x32x16_bf16 v[80:95], v[144:147], v[156:159], v[80:95]
  ds_read_b64_tr_b16 v[58:59], v24 offset:17408
  ds_read_b64_tr_b16 v[60:61], v25 offset:16384
  ds_read_b64_tr_b16 v[62:63], v25 offset:17408
  v_mfma_f32_32x32x16_bf16 v[96:111], v[148:151], v[152:155], v[96:111]
  s_add_u32 m0, s27, 98304
  s_add_u32 s25, s65, 0
  buffer_load_dwordx4 v2, s[4:7], s25 offen  lds
  v_mfma_f32_32x32x16_bf16 v[112:127], v[148:151], v[156:159], v[112:127]
  s_add_u32 m0, s27, 99328
  s_add_u32 s25, s65, 10240
  buffer_load_dwordx4 v3, s[4:7], s25 offen  lds
  s_waitcnt lgkmcnt(6)
  v_mfma_f32_32x32x16_bf16 v[64:79], v[32:35], v[40:43], v[64:79]
  ds_read_b128 v[144:147], v9 offset:49152
  ds_read_b128 v[148:151], v9 offset:53248
  ds_read_b64_tr_b16 v[152:153], v24 offset:20480
  v_mfma_f32_32x32x16_bf16 v[80:95], v[32:35], v[44:47], v[80:95]
  ds_read_b64_tr_b16 v[154:155], v24 offset:21504
  ds_read_b64_tr_b16 v[156:157], v25 offset:20480
  ds_read_b64_tr_b16 v[158:159], v25 offset:21504
  v_mfma_f32_32x32x16_bf16 v[96:111], v[36:39], v[40:43], v[96:111]
  s_add_u32 m0, s27, 100352
  s_add_u32 s25, s65, 20480
  buffer_load_dwordx4 v2, s[4:7], s25 offen  lds
  v_mfma_f32_32x32x16_bf16 v[112:127], v[36:39], v[44:47], v[112:127]
  s_add_u32 m0, s27, 101376
  s_add_u32 s25, s65, 30720
  buffer_load_dwordx4 v3, s[4:7], s25 offen  lds
  s_add_u32 s65, s65, 128
  s_cmp_eq_u32 s65, 1280
  s_cselect_b32 s65, 0, s65
  s_waitcnt lgkmcnt(6)
  v_mfma_f32_32x32x16_bf16 v[64:79], v[48:51], v[56:59], v[64:79]
  ds_read_b128 v[32:35], v10 offset:49152
  ds_read_b128 v[36:39], v10 offset:53248
  ds_read_b64_tr_b16 v[40:41], v24 offset:24576
  v_mfma_f32_32x32x16_bf16 v[80:95], v[48:51], v[60:63], v[80:95]
  ds_read_b64_tr_b16 v[42:43], v24 offset:25600
  ds_read_b64_tr_b16 v[44:45], v25 offset:24576
  ds_read_b64_tr_b16 v[46:47], v25 offset:25600
  v_mfma_f32_32x32x16_bf16 v[96:111], v[52:55], v[56:59], v[96:111]
  s_add_u32 m0, s28, 131072
  s_add_u32 s25, s66, 0
  buffer_load_dwordx4 v4, s[8:11], s25 offen  lds
  v_mfma_f32_32x32x16_bf16 v[112:127], v[52:55], v[60:63], v[112:127]
  s_add_u32 m0, s28, 132096
  s_add_u32 s25, s66, 15360
  buffer_load_dwordx4 v4, s[8:11], s25 offen  lds
  s_add_u32 s66, s66, 245760
  s_cmp_eq_u32 s66, 2457600
  s_cselect_b32 s66, 0, s66
  s_waitcnt lgkmcnt(6)
  v_mfma_f32_32x32x16_bf16 v[64:79], v[144:147], v[152:155], v[64:79]
  ds_read_b128 v[48:51], v11 offset:49152
  ds_read_b128 v[52:55], v11 offset:53248
  ds_read_b64_tr_b16 v[56:57], v24 offset:28672
  v_mfma_f32_32x32x16_bf16 v[80:95], v[144:147], v[156:159], v[80:95]
  ds_read_b64_tr_b16 v[58:59], v24 offset:29696
  ds_read_b64_tr_b16 v[60:61], v25 offset:28672
  ds_read_b64_tr_b16 v[62:63], v25 offset:29696
  v_mfma_f32_32x32x16_bf16 v[96:111], v[148:151], v[152:155], v[96:111]
  s_add_u32 m0, s27, 0
  s_add_u32 s25, s65, 0
  buffer_load_dwordx4 v2, s[4:7], s25 offen  lds
  v_mfma_f32_32x32x16_bf16 v[112:127], v[148:151], v[156:159], v[112:127]
  s_add_u32 m0, s27, 1024
  s_add_u32 s25, s65, 10240
  buffer_load_dwordx4 v3, s[4:7], s25 offen  lds
  s_waitcnt vmcnt(2) lgkmcnt(0)
  s_barrier
  v_mfma_f32_32x32x16_bf16 v[64:79], v[32:35], v[40:43], v[64:79]
  ds_read_b128 v[144:147], v12 offset:32768
  ds_read_b128 v[148:151], v12 offset:36864
  ds_read_b64_tr_b16 v[152:153], v28 offset:0
  v_mfma_f32_32x32x16_bf16 v[80:95], v[32:35], v[44:47], v[80:95]
  ds_read_b64_tr_b16 v[154:155], v28 offset:1024
  ds_read_b64_tr_b16 v[156:157], v29 offset:0
  ds_read_b64_tr_b16 v[158:159], v29 offset:1024
  v_mfma_f32_32x32x16_bf16 v[96:111], v[36:39], v[40:43], v[96:111]
  s_add_u32 m0, s27, 2048
  s_add_u32 s25, s65, 20480
  buffer_load_dwordx4 v2, s[4:7], s25 offen  lds
  v_mfma_f32_32x32x16_bf16 v[112:127], v[36:39], v[44:47], v[112:127]
  s_add_u32 m0, s27, 3072
  s_add_u32 s25, s65, 30720
  buffer_load_dwordx4 v3, s[4:7], s25 offen  lds
  s_add_u32 s65, s65, 128
  s_cmp_eq_u32 s65, 1280
  s_cselect_b32 s65, 0, s65
  s_waitcnt lgkmcnt(6)
  v_mfma_f32_32x32x16_bf16 v[64:79], v[48:51], v[56:59], v[64:79]
  ds_read_b128 v[32:35], v13 offset:32768
  ds_read_b128 v[36:39], v13 offset:36864
  ds_read_b64_tr_b16 v[40:41], v28 offset:4096
  v_mfma_f32_32x32x16_bf16 v[80:95], v[48:51], v[60:63], v[80:95]
  ds_read_b64_tr_b16 v[42:43], v28 offset:5120
  ds_read_b64_tr_b16 v[44:45], v29 offset:4096
  ds_read_b64_tr_b16 v[46:47], v29 offset:5120
  v_mfma_f32_32x32x16_bf16 v[96:111], v[52:55], v[56:59], v[96:111]
  s_add_u32 m0, s28, 32768
  s_add_u32 s25, s66, 0
  buffer_load_dwordx4 v4, s[8:11], s25 offen  lds
  v_mfma_f32_32x32x16_bf16 v[112:127], v[52:55], v[60:63], v[112:127]
  s_add_u32 m0, s28, 33792
  s_add_u32 s25, s66, 15360
  buffer_load_dwordx4 v4, s[8:11], s25 offen  lds
  s_add_u32 s66, s66, 245760
  s_cmp_eq_u32 s66, 2457600
  s_cselect_b32 s66, 0, s66
  s_waitcnt lgkmcnt(6)
  v_mfma_f32_32x32x16_bf16 v[64:79], v[144:147], v[152:155], v[64:79]
  ds_read_b128 v[48:51], v14 offset:32768
  ds_read_b128 v[52:55], v14 offset:36864
  ds_read_b64_tr_b16 v[56:57], v28 offset:8192
  v_mfma_f32_32x32x16_bf16 v[80:95], v[144:147], v[156:159], v[80:95]
  ds_read_b64_tr_b16 v[58:59], v28 offset:9216
  ds_read_b64_tr_b16 v[60:61], v29 offset:8192
  ds_read_b64_tr_b16 v[62:63], v29 offset:9216
  v_mfma_f32_32x32x16_bf16 v[96:111], v[148:151], v[152:155], v[96:111]
  s_add_u32 m0, s27, 49152
  s_add_u32 s25, s65, 0
  buffer_load_dwordx4 v2, s[4:7], s25 offen  lds
  v_mfma_f32_32x32x16_bf16 v[112:127], v[148:151], v[156:159], v[112:127]
  s_add_u32 m0, s27, 50176
  s_add_u32 s25, s65, 10240
  buffer_load_dwordx4 v3, s[4:7], s25 offen  lds
  s_waitcnt lgkmcnt(6)
  v_mfma_f32_32x32x16_bf16 v[64:79], v[32:35], v[40:43], v[64:79]
  ds_read_b128 v[144:147], v15 offset:32768
  ds_read_b128 v[148:151], v15 offset:36864
  ds_read_b64_tr_b16 v[152:153], v28 offset:12288
  v_mfma_f32_32x32x16_bf16 v[80:95], v[32:35], v[44:47], v[80:95]
  ds_read_b64_tr_b16 v[154:155], v28 offset:13312
  ds_read_b64_tr_b16 v[156:157], v29 offset:12288
  ds_read_b64_tr_b16 v[158:159], v29 offset:13312
  v_mfma_f32_32x32x16_bf16 v[96:111], v[36:39], v[40:43], v[96:111]
  s_add_u32 m0, s27, 51200
  s_add_u32 s25, s65, 20480
  buffer_load_dwordx4 v2, s[4:7], s25 offen  lds
  v_mfma_f32_32x32x16_bf16 v[112:127], v[36:39], v[44:47], v[112:127]
  s_add_u32 m0, s27, 52224
  s_add_u32 s25, s65, 30720
  buffer_load_dwordx4 v3, s[4:7], s25 offen  lds
  s_add_u32 s65, s65, 128
  s_cmp_eq_u32 s65, 1280
  s_cselect_b32 s65, 0, s65
  s_waitcnt vmcnt(4) lgkmcnt(0)
  s_barrier
  v_mfma_f32_32x32x16_bf16 v[64:79], v[48:51], v[56:59], v[64:79]
  ds_read_b128 v[32:35], v8 offset:0
  ds_read_b128 v[36:39], v8 offset:4096
  ds_read_b64_tr_b16 v[40:41], v20 offset:32768
  v_mfma_f32_32x32x16_bf16 v[80:95], v[48:51], v[60:63], v[80:95]
  ds_read_b64_tr_b16 v[42:43], v20 offset:33792
  ds_read_b64_tr_b16 v[44:45], v21 offset:32768
  ds_read_b64_tr_b16 v[46:47], v21 offset:33792
  v_mfma_f32_32x32x16_bf16 v[96:111], v[52:55], v[56:59], v[96:111]
  s_add_u32 m0, s28, 81920
  s_add_u32 s25, s66, 0
  buffer_load_dwordx4 v4, s[8:11], s25 offen  lds
  v_mfma_f32_32x32x16_bf16 v[112:127], v[52:55], v[60:63], v[112:127]
  s_add_u32 m0, s28, 82944
  s_add_u32 s25, s66, 15360
  buffer_load_dwordx4 v4, s[8:11], s25 offen  lds
  s_add_u32 s66, s66, 245760
  s_cmp_eq_u32 s66, 2457600
  s_cselect_b32 s66, 0, s66
  s_waitcnt lgkmcnt(6)
  v_mfma_f32_32x32x16_bf16 v[64:79], v[144:147], v[152:155], v[64:79]
  ds_read_b128 v[48:51], v9 offset:0
  ds_read_b128 v[52:55], v9 offset:4096
  ds_read_b64_tr_b16 v[56:57], v20 offset:36864
  v_mfma_f32_32x32x16_bf16 v[80:95], v[144:147], v[156:159], v[80:95]
  ds_read_b64_tr_b16 v[58:59], v20 offset:37888
  ds_read_b64_tr_b16 v[60:61], v21 offset:36864
  ds_read_b64_tr_b16 v[62:63], v21 offset:37888
  v_mfma_f32_32x32x16_bf16 v[96:111], v[148:151], v[152:155], v[96:111]
  s_add_u32 m0, s27, 98304
  s_add_u32 s25, s65, 0
  buffer_load_dwordx4 v2, s[4:7], s25 offen  lds
  v_mfma_f32_32x32x16_bf16 v[112:127], v[148:151], v[156:159], v[112:127]
  s_add_u32 m0, s27, 99328
  s_add_u32 s25, s65, 10240
  buffer_load_dwordx4 v3, s[4:7], s25 offen  lds
  s_waitcnt lgkmcnt(6)
  v_mfma_f32_32x32x16_bf16 v[64:79], v[32:35], v[40:43], v[64:79]
  ds_read_b128 v[144:147], v10 offset:0
  ds_read_b128 v[148:151], v10 offset:4096
  ds_read_b64_tr_b16 v[152:153], v20 offset:40960
  v_mfma_f32_32x32x16_bf16 v[80:95], v[32:35], v[44:47], v[80:95]
  ds_read_b64_tr_b16 v[154:155], v20 offset:41984
  ds_read_b64_tr_b16 v[156:157], v21 offset:40960
  ds_read_b64_tr_b16 v[158:159], v21 offset:41984
  v_mfma_f32_32x32x16_bf16 v[96:111], v[36:39], v[40:43], v[96:111]
  s_add_u32 m0, s27, 100352
  s_add_u32 s25, s65, 20480
  buffer_load_dwordx4 v2, s[4:7], s25 offen  lds
  v_mfma_f32_32x32x16_bf16 v[112:127], v[36:39], v[44:47], v[112:127]
  s_add_u32 m0, s27, 101376
  s_add_u32 s25, s65, 30720
  buffer_load_dwordx4 v3, s[4:7], s25 offen  lds
  s_add_u32 s65, s65, 128
  s_cmp_eq_u32 s65, 1280
  s_cselect_b32 s65, 0, s65
  s_waitcnt lgkmcnt(6)
  v_mfma_f32_32x32x16_bf16 v[64:79], v[48:51], v[56:59], v[64:79]
  ds_read_b128 v[32:35], v11 offset:0
  ds_read_b128 v[36:39], v11 offset:4096
  ds_read_b64_tr_b16 v[40:41], v20 offset:45056
  v_mfma_f32_32x32x16_bf16 v[80:95], v[48:51], v[60:63], v[80:95]
  ds_read_b64_tr_b16 v[42:43], v20 offset:46080
  ds_read_b64_tr_b16 v[44:45], v21 offset:45056
  ds_read_b64_tr_b16 v[46:47], v21 offset:46080
  v_mfma_f32_32x32x16_bf16 v[96:111], v[52:55], v[56:59], v[96:111]
  s_add_u32 m0, s28, 131072
  s_add_u32 s25, s66, 0
  buffer_load_dwordx4 v4, s[8:11], s25 offen  lds
  v_mfma_f32_32x32x16_bf16 v[112:127], v[52:55], v[60:63], v[112:127]
  s_add_u32 m0, s28, 132096
  s_add_u32 s25, s66, 15360
  buffer_load_dwordx4 v4, s[8:11], s25 offen  lds
  s_add_u32 s66, s66, 245760
  s_cmp_eq_u32 s66, 2457600
  s_cselect_b32 s66, 0, s66
  s_waitcnt vmcnt(6) lgkmcnt(0)
  s_barrier
  v_mfma_f32_32x32x16_bf16 v[64:79], v[144:147], v[152:155], v[64:79]
  ds_read_b128 v[48:51], v8 offset:49152
  ds_read_b128 v[52:55], v8 offset:53248
  ds_read_b64_tr_b16 v[56:57], v24 offset:16384
  v_mfma_f32_32x32x16_bf16 v[80:95], v[144:147], v[156:159], v[80:95]
  ds_read_b64_tr_b16 v[58:59], v24 offset:17408
  ds_read_b64_tr_b16 v[60:61], v25 offset:16384
  ds_read_b64_tr_b16 v[62:63], v25 offset:17408
  v_mfma_f32_32x32x16_bf16 v[96:111], v[148:151], v[152:155], v[96:111]
  s_add_u32 m0, s27, 0
  s_add_u32 s25, s65, 0
  buffer_load_dwordx4 v2, s[4:7], s25 offen  lds
  v_mfma_f32_32x32x16_bf16 v[112:127], v[148:151], v[156:159], v[112:127]
  s_add_u32 m0, s27, 1024
  s_add_u32 s25, s65, 10240
  buffer_load_dwordx4 v3, s[4:7], s25 offen  lds
  s_waitcnt lgkmcnt(6)
  v_mfma_f32_32x32x16_bf16 v[64:79], v[32:35], v[40:43], v[64:79]
  ds_read_b128 v[144:147], v9 offset:49152
  ds_read_b128 v[148:151], v9 offset:53248
  ds_read_b64_tr_b16 v[152:153], v24 offset:20480
  v_mfma_f32_32x32x16_bf16 v[80:95], v[32:35], v[44:47], v[80:95]
  ds_read_b64_tr_b16 v[154:155], v24 offset:21504
  ds_read_b64_tr_b16 v[156:157], v25 offset:20480
  ds_read_b64_tr_b16 v[158:159], v25 offset:21504
  v_mfma_f32_32x32x16_bf16 v[96:111], v[36:39], v[40:43], v[96:111]
  s_add_u32 m0, s27, 2048
  s_add_u32 s25, s65, 20480
  buffer_load_dwordx4 v2, s[4:7], s25 offen  lds
  v_mfma_f32_32x32x16_bf16 v[112:127], v[36:39], v[44:47], v[112:127]
  s_add_u32 m0, s27, 3072
  s_add_u32 s25, s65, 30720
  buffer_load_dwordx4 v3, s[4:7], s25 offen  lds
  s_add_u32 s65, s65, 128
  s_cmp_eq_u32 s65, 1280
  s_cselect_b32 s65, 0, s65
  s_waitcnt lgkmcnt(6)
  v_mfma_f32_32x32x16_bf16 v[64:79], v[48:51], v[56:59], v[64:79]
  ds_read_b128 v[32:35], v10 offset:49152
  ds_read_b128 v[36:39], v10 offset:53248
  ds_read_b64_tr_b16 v[40:41], v24 offset:24576
  v_mfma_f32_32x32x16_bf16 v[80:95], v[48:51], v[60:63], v[80:95]
  ds_read_b64_tr_b16 v[42:43], v24 offset:25600
  ds_read_b64_tr_b16 v[44:45], v25 offset:24576
  ds_read_b64_tr_b16 v[46:47], v25 offset:25600
  v_mfma_f32_32x32x16_bf16 v[96:111], v[52:55], v[56:59], v[96:111]
  s_add_u32 m0, s28, 32768
  s_add_u32 s25, s66, 0
  buffer_load_dwordx4 v4, s[8:11], s25 offen  lds
  v_mfma_f32_32x32x16_bf16 v[112:127], v[52:55], v[60:63], v[112:127]
  s_add_u32 m0, s28, 33792
  s_add_u32 s25, s66, 15360
  buffer_load_dwordx4 v4, s[8:11], s25 offen  lds
  s_add_u32 s66, s66, 245760
  s_cmp_eq_u32 s66, 2457600
  s_cselect_b32 s66, 0, s66
  s_waitcnt lgkmcnt(6)
  v_mfma_f32_32x32x16_bf16 v[64:79], v[144:147], v[152:155], v[64:79]
  ds_read_b128 v[48:51], v11 offset:49152
  ds_read_b128 v[52:55], v11 offset:53248
  ds_read_b64_tr_b16 v[56:57], v24 offset:28672
  v_mfma_f32_32x32x16_bf16 v[80:95], v[144:147], v[156:159], v[80:95]
  ds_read_b64_tr_b16 v[58:59], v24 offset:29696
  ds_read_b64_tr_b16 v[60:61], v25 offset:28672
  ds_read_b64_tr_b16 v[62:63], v25 offset:29696
  v_mfma_f32_32x32x16_bf16 v[96:111], v[148:151], v[152:155], v[96:111]
  v_mfma_f32_32x32x16_bf16 v[112:127], v[148:151], v[156:159], v[112:127]
  s_waitcnt vmcnt(6) lgkmcnt(0)
  s_barrier
  v_mfma_f32_32x32x16_bf16 v[64:79], v[32:35], v[40:43], v[64:79]
  ds_read_b128 v[144:147], v12 offset:32768
  ds_read_b128 v[148:151], v12 offset:36864
  ds_read_b64_tr_b16 v[152:153], v28 offset:0
  v_mfma_f32_32x32x16_bf16 v[80:95], v[32:35], v[44:47], v[80:95]
  ds_read_b64_tr_b16 v[154:155], v28 offset:1024
  ds_read_b64_tr_b16 v[156:157], v29 offset:0
  ds_read_b64_tr_b16 v[158:159], v29 offset:1024
  v_mfma_f32_32x32x16_bf16 v[96:111], v[36:39], v[40:43], v[96:111]
  s_add_u32 m0, s27, 49152
  s_add_u32 s25, s65, 0
  buffer_load_dwordx4 v2, s[4:7], s25 offen  lds
  v_mfma_f32_32x32x16_bf16 v[112:127], v[36:39], v[44:47], v[112:127]
  s_add_u32 m0, s27, 50176
  s_add_u32 s25, s65, 10240
  buffer_load_dwordx4 v3, s[4:7], s25 offen  lds
  s_waitcnt lgkmcnt(6)
  v_mfma_f32_32x32x16_bf16 v[64:79], v[48:51], v[56:59], v[64:79]
  ds_read_b128 v[32:35], v13 offset:32768
  ds_read_b128 v[36:39], v13 offset:36864
  ds_read_b64_tr_b16 v[40:41], v28 offset:4096
  v_mfma_f32_32x32x16_bf16 v[80:95], v[48:51], v[60:63], v[80:95]
  ds_read_b64_tr_b16 v[42:43], v28 offset:5120
  ds_read_b64_tr_b16 v[44:45], v29 offset:4096
  ds_read_b64_tr_b16 v[46:47], v29 offset:5120
  v_mfma_f32_32x32x16_bf16 v[96:111], v[52:55], v[56:59], v[96:111]
  s_add_u32 m0, s27, 51200
  s_add_u32 s25, s65, 20480
  buffer_load_dwordx4 v2, s[4:7], s25 offen  lds
  v_mfma_f32_32x32x16_bf16 v[112:127], v[52:55], v[60:63], v[112:127]
  s_add_u32 m0, s27, 52224
  s_add_u32 s25, s65, 30720
  buffer_load_dwordx4 v3, s[4:7], s25 offen  lds
  s_add_u32 s65, s65, 128
  s_cmp_eq_u32 s65, 1280
  s_cselect_b32 s65, 0, s65
  s_waitcnt lgkmcnt(6)
  v_mfma_f32_32x32x16_bf16 v[64:79], v[144:147], v[152:155], v[64:79]
  ds_read_b128 v[48:51], v14 offset:32768
  ds_read_b128 v[52:55], v14 offset:36864
  ds_read_b64_tr_b16 v[56:57], v28 offset:8192
  v_mfma_f32_32x32x16_bf16 v[80:95], v[144:147], v[156:159], v[80:95]
  ds_read_b64_tr_b16 v[58:59], v28 offset:9216
  ds_read_b64_tr_b16 v[60:61], v29 offset:8192
  ds_read_b64_tr_b16 v[62:63], v29 offset:9216
  v_mfma_f32_32x32x16_bf16 v[96:111], v[148:151], v[152:155], v[96:111]
  s_add_u32 m0, s28, 81920
  s_add_u32 s25, s66, 0
  buffer_load_dwordx4 v4, s[8:11], s25 offen  lds
  v_mfma_f32_32x32x16_bf16 v[112:127], v[148:151], v[156:159], v[112:127]
  s_add_u32 m0, s28, 82944
  s_add_u32 s25, s66, 15360
  buffer_load_dwordx4 v4, s[8:11], s25 offen  lds
  s_add_u32 s66, s66, 245760
  s_cmp_eq_u32 s66, 2457600
  s_cselect_b32 s66, 0, s66
  s_waitcnt lgkmcnt(6)
  v_mfma_f32_32x32x16_bf16 v[64:79], v[32:35], v[40:43], v[64:79]
  ds_read_b128 v[144:147], v15 offset:32768
  ds_read_b128 v[148:151], v15 offset:36864
  ds_read_b64_tr_b16 v[152:153], v28 offset:12288
  v_mfma_f32_32x32x16_bf16 v[80:95], v[32:35], v[44:47], v[80:95]
  ds_read_b64_tr_b16 v[154:155], v28 offset:13312
  ds_read_b64_tr_b16 v[156:157], v29 offset:12288
  ds_read_b64_tr_b16 v[158:159], v29 offset:13312
  v_mfma_f32_32x32x16_bf16 v[96:111], v[36:39], v[40:43], v[96:111]
  v_mfma_f32_32x32x16_bf16 v[112:127], v[36:39], v[44:47], v[112:127]
  s_waitcnt vmcnt(6) lgkmcnt(0)
  s_barrier
  v_mfma_f32_32x32x16_bf16 v[64:79], v[48:51], v[56:59], v[64:79]
  ds_read_b128 v[32:35], v8 offset:0
  ds_read_b128 v[36:39], v8 offset:4096
  ds_read_b64_tr_b16 v[40:41], v20 offset:32768
  v_mfma_f32_32x32x16_bf16 v[80:95], v[48:51], v[60:63], v[80:95]
  ds_read_b64_tr_b16 v[42:43], v20 offset:33792
  ds_read_b64_tr_b16 v[44:45], v21 offset:32768
  ds_read_b64_tr_b16 v[46:47], v21 offset:33792
  v_mfma_f32_32x32x16_bf16 v[96:111], v[52:55], v[56:59], v[96:111]
  s_add_u32 m0, s27, 98304
  s_add_u32 s25, s65, 0
  buffer_load_dwordx4 v2, s[4:7], s25 offen  lds
  v_mfma_f32_32x32x16_bf16 v[112:127], v[52:55], v[60:63], v[112:127]
  s_add_u32 m0, s27, 99328
  s_add_u32 s25, s65, 10240
  buffer_load_dwordx4 v3, s[4:7], s25 offen  lds
  s_waitcnt lgkmcnt(6)
  v_mfma_f32_32x32x16_bf16 v[64:79], v[144:147], v[152:155], v[64:79]
  ds_read_b128 v[48:51], v9 offset:0
  ds_read_b128 v[52:55], v9 offset:4096
  ds_read_b64_tr_b16 v[56:57], v20 offset:36864
  v_mfma_f32_32x32x16_bf16 v[80:95], v[144:147], v[156:159], v[80:95]
  ds_read_b64_tr_b16 v[58:59], v20 offset:37888
  ds_read_b64_tr_b16 v[60:61], v21 offset:36864
  ds_read_b64_tr_b16 v[62:63], v21 offset:37888
  v_mfma_f32_32x32x16_bf16 v[96:111], v[148:151], v[152:155], v[96:111]
  s_add_u32 m0, s27, 100352
  s_add_u32 s25, s65, 20480
  buffer_load_dwordx4 v2, s[4:7], s25 offen  lds
  v_mfma_f32_32x32x16_bf16 v[112:127], v[148:151], v[156:159], v[112:127]
  s_add_u32 m0, s27, 101376
  s_add_u32 s25, s65, 30720
  buffer_load_dwordx4 v3, s[4:7], s25 offen  lds
  s_add_u32 s65, s65, 128
  s_cmp_eq_u32 s65, 1280
  s_cselect_b32 s65, 0, s65
  s_waitcnt lgkmcnt(6)
  v_mfma_f32_32x32x16_bf16 v[64:79], v[32:35], v[40:43], v[64:79]
  ds_read_b128 v[144:147], v10 offset:0
  ds_read_b128 v[148:151], v10 offset:4096
  ds_read_b64_tr_b16 v[152:153], v20 offset:40960
  v_mfma_f32_32x32x16_bf16 v[80:95], v[32:35], v[44:47], v[80:95]
  ds_read_b64_tr_b16 v[154:155], v20 offset:41984
  ds_read_b64_tr_b16 v[156:157], v21 offset:40960
  ds_read_b64_tr_b16 v[158:159], v21 offset:41984
  v_mfma_f32_32x32x16_bf16 v[96:111], v[36:39], v[40:43], v[96:111]
  s_add_u32 m0, s28, 131072
  s_add_u32 s25, s66, 0
  buffer_load_dwordx4 v4, s[8:11], s25 offen  lds
  v_mfma_f32_32x32x16_bf16 v[112:127], v[36:39], v[44:47], v[112:127]
  s_add_u32 m0, s28, 132096
  s_add_u32 s25, s66, 15360
  buffer_load_dwordx4 v4, s[8:11], s25 offen  lds
  s_add_u32 s66, s66, 245760
  s_cmp_eq_u32 s66, 2457600
  s_cselect_b32 s66, 0, s66
  s_waitcnt lgkmcnt(6)
  v_mfma_f32_32x32x16_bf16 v[64:79], v[48:51], v[56:59], v[64:79]
  ds_read_b128 v[32:35], v11 offset:0
  ds_read_b128 v[36:39], v11 offset:4096
  ds_read_b64_tr_b16 v[40:41], v20 offset:45056
  v_mfma_f32_32x32x16_bf16 v[80:95], v[48:51], v[60:63], v[80:95]
  ds_read_b64_tr_b16 v[42:43], v20 offset:46080
  ds_read_b64_tr_b16 v[44:45], v21 offset:45056
  ds_read_b64_tr_b16 v[46:47], v21 offset:46080
  v_mfma_f32_32x32x16_bf16 v[96:111], v[52:55], v[56:59], v[96:111]
  v_mfma_f32_32x32x16_bf16 v[112:127], v[52:55], v[60:63], v[112:127]
  s_waitcnt vmcnt(6) lgkmcnt(0)
  s_barrier
  v_mfma_f32_32x32x16_bf16 v[64:79], v[144:147], v[152:155], v[64:79]
  ds_read_b128 v[48:51], v8 offset:49152
  ds_read_b64_tr_b16 v[56:57], v24 offset:16384
  ds_read_b64_tr_b16 v[58:59], v24 offset:17408
  v_mfma_f32_32x32x16_bf16 v[80:95], v[144:147], v[156:159], v[80:95]
  ds_read_b64_tr_b16 v[60:61], v25 offset:16384
  ds_read_b64_tr_b16 v[62:63], v25 offset:17408
  v_mfma_f32_32x32x16_bf16 v[96:111], v[148:151], v[152:155], v[96:111]
  s_add_u32 m0, s27, 0
  s_add_u32 s25, s65, 0
  buffer_load_dwordx4 v2, s[4:7], s25 offen  lds
  v_mfma_f32_32x32x16_bf16 v[112:127], v[148:151], v[156:159], v[112:127]
  s_add_u32 m0, s27, 1024
  s_add_u32 s25, s65, 10240
  buffer_load_dwordx4 v3, s[4:7], s25 offen  lds
  s_waitcnt lgkmcnt(5)
  v_mfma_f32_32x32x16_bf16 v[64:79], v[32:35], v[40:43], v[64:79]
  ds_read_b128 v[144:147], v9 offset:49152
  ds_read_b64_tr_b16 v[152:153], v24 offset:20480
  ds_read_b64_tr_b16 v[154:155], v24 offset:21504
  v_mfma_f32_32x32x16_bf16 v[80:95], v[32:35], v[44:47], v[80:95]
  ds_read_b64_tr_b16 v[156:157], v25 offset:20480
  ds_read_b64_tr_b16 v[158:159], v25 offset:21504
  v_mfma_f32_32x32x16_bf16 v[96:111], v[36:39], v[40:43], v[96:111]
  s_add_u32 m0, s27, 2048
  s_add_u32 s25, s65, 20480
  buffer_load_dwordx4 v2, s[4:7], s25 offen  lds
  v_mfma_f32_32x32x16_bf16 v[112:127], v[36:39], v[44:47], v[112:127]
  s_add_u32 m0, s27, 3072
  s_add_u32 s25, s65, 30720
  buffer_load_dwordx4 v3, s[4:7], s25 offen  lds
  s_waitcnt lgkmcnt(5)
  v_mfma_f32_32x32x16_bf16 v[64:79], v[48:51], v[56:59], v[64:79]
  ds_read_b128 v[32:35], v10 offset:49152
  ds_read_b64_tr_b16 v[40:41], v24 offset:24576
  ds_read_b64_tr_b16 v[42:43], v24 offset:25600
  ds_read_b64_tr_b16 v[44:45], v25 offset:24576
  ds_read_b64_tr_b16 v[46:47], v25 offset:25600
  v_mfma_f32_32x32x16_bf16 v[80:95], v[48:51], v[60:63], v[80:95]
  s_add_u32 m0, s28, 32768
  s_add_u32 s25, s66, 0
  buffer_load_dwordx4 v4, s[8:11], s25 offen  lds
  s_add_u32 m0, s28, 33792
  s_add_u32 s25, s66, 15360
  buffer_load_dwordx4 v4, s[8:11], s25 offen  lds
  s_waitcnt lgkmcnt(5)
  v_mfma_f32_32x32x16_bf16 v[64:79], v[144:147], v[152:155], v[64:79]
  ds_read_b128 v[48:51], v11 offset:49152
  ds_read_b64_tr_b16 v[56:57], v24 offset:28672
  ds_read_b64_tr_b16 v[58:59], v24 offset:29696
  ds_read_b64_tr_b16 v[60:61], v25 offset:28672
  ds_read_b64_tr_b16 v[62:63], v25 offset:29696
  v_mfma_f32_32x32x16_bf16 v[80:95], v[144:147], v[156:159], v[80:95]
  s_waitcnt vmcnt(6) lgkmcnt(0)
  s_barrier
  v_mfma_f32_32x32x16_bf16 v[64:79], v[32:35], v[40:43], v[64:79]
  ds_read_b128 v[144:147], v12 offset:32768
  ds_read_b64_tr_b16 v[152:153], v28 offset:0
  ds_read_b64_tr_b16 v[154:155], v28 offset:1024
  ds_read_b64_tr_b16 v[156:157], v29 offset:0
  ds_read_b64_tr_b16 v[158:159], v29 offset:1024
  v_mfma_f32_32x32x16_bf16 v[80:95], v[32:35], v[44:47], v[80:95]
  s_mov_b32 s68, s58
  s_and_b32 s69, s59, 0xffff
  s_mov_b32 s70, 256
  s_mov_b32 s71, 0x00020000
  v_mov_b32 v130, 0
  buffer_load_dword v130, v130, s[68:71], 0 offen sc1
  s_waitcnt lgkmcnt(5)
  v_mfma_f32_32x32x16_bf16 v[64:79], v[48:51], v[56:59], v[64:79]
  ds_read_b128 v[32:35], v13 offset:32768
  ds_read_b64_tr_b16 v[40:41], v28 offset:4096
  ds_read_b64_tr_b16 v[42:43], v28 offset:5120
  ds_read_b64_tr_b16 v[44:45], v29 offset:4096
  ds_read_b64_tr_b16 v[46:47], v29 offset:5120
  v_mfma_f32_32x32x16_bf16 v[80:95], v[48:51], v[60:63], v[80:95]
  s_waitcnt lgkmcnt(5)
  v_mfma_f32_32x32x16_bf16 v[64:79], v[144:147], v[152:155], v[64:79]
  ds_read_b128 v[48:51], v14 offset:32768
  ds_read_b64_tr_b16 v[56:57], v28 offset:8192
  ds_read_b64_tr_b16 v[58:59], v28 offset:9216
  ds_read_b64_tr_b16 v[60:61], v29 offset:8192
  ds_read_b64_tr_b16 v[62:63], v29 offset:9216
  v_mfma_f32_32x32x16_bf16 v[80:95], v[144:147], v[156:159], v[80:95]
  s_waitcnt lgkmcnt(5)
  v_mfma_f32_32x32x16_bf16 v[64:79], v[32:35], v[40:43], v[64:79]
  ds_read_b128 v[144:147], v15 offset:32768
  ds_read_b64_tr_b16 v[152:153], v28 offset:12288
  ds_read_b64_tr_b16 v[154:155], v28 offset:13312
  ds_read_b64_tr_b16 v[156:157], v29 offset:12288
  ds_read_b64_tr_b16 v[158:159], v29 offset:13312
  v_mfma_f32_32x32x16_bf16 v[80:95], v[32:35], v[44:47], v[80:95]
  s_waitcnt vmcnt(1) lgkmcnt(0)
  s_barrier
  v_mfma_f32_32x32x16_bf16 v[64:79], v[48:51], v[56:59], v[64:79]
  ds_read_b128 v[32:35], v8 offset:0
  ds_read_b64_tr_b16 v[40:41], v20 offset:32768
  ds_read_b64_tr_b16 v[42:43], v20 offset:33792
  ds_read_b64_tr_b16 v[44:45], v21 offset:32768
  ds_read_b64_tr_b16 v[46:47], v21 offset:33792
  v_mfma_f32_32x32x16_bf16 v[80:95], v[48:51], v[60:63], v[80:95]
  s_waitcnt lgkmcnt(5)
  v_mfma_f32_32x32x16_bf16 v[64:79], v[144:147], v[152:155], v[64:79]
  ds_read_b128 v[48:51], v9 offset:0
  ds_read_b64_tr_b16 v[56:57], v20 offset:36864
  ds_read_b64_tr_b16 v[58:59], v20 offset:37888
  ds_read_b64_tr_b16 v[60:61], v21 offset:36864
  ds_read_b64_tr_b16 v[62:63], v21 offset:37888
  v_mfma_f32_32x32x16_bf16 v[80:95], v[144:147], v[156:159], v[80:95]
  s_waitcnt lgkmcnt(5)
  v_mfma_f32_32x32x16_bf16 v[64:79], v[32:35], v[40:43], v[64:79]
  ds_read_b128 v[144:147], v10 offset:0
  ds_read_b64_tr_b16 v[152:153], v20 offset:40960
  ds_read_b64_tr_b16 v[154:155], v20 offset:41984
  ds_read_b64_tr_b16 v[156:157], v21 offset:40960
  ds_read_b64_tr_b16 v[158:159], v21 offset:41984
  v_mfma_f32_32x32x16_bf16 v[80:95], v[32:35], v[44:47], v[80:95]
  s_waitcnt lgkmcnt(5)
  v_mfma_f32_32x32x16_bf16 v[64:79], v[48:51], v[56:59], v[64:79]
  ds_read_b128 v[32:35], v11 offset:0
  ds_read_b64_tr_b16 v[40:41], v20 offset:45056
  ds_read_b64_tr_b16 v[42:43], v20 offset:46080
  ds_read_b64_tr_b16 v[44:45], v21 offset:45056
  ds_read_b64_tr_b16 v[46:47], v21 offset:46080
  v_mfma_f32_32x32x16_bf16 v[80:95], v[48:51], v[60:63], v[80:95]
  s_waitcnt lgkmcnt(5)
  v_mfma_f32_32x32x16_bf16 v[64:79], v[144:147], v[152:155], v[64:79]
  ds_read_b128 v[52:55], v8 offset:53248
  ds_read_b64_tr_b16 v[56:57], v24 offset:16384
  ds_read_b64_tr_b16 v[58:59], v24 offset:17408
  v_mfma_f32_32x32x16_bf16 v[80:95], v[144:147], v[156:159], v[80:95]
  s_waitcnt lgkmcnt(3)
  v_mfma_f32_32x32x16_bf16 v[64:79], v[32:35], v[40:43], v[64:79]
  ds_read_b128 v[148:151], v9 offset:53248
  ds_read_b64_tr_b16 v[152:153], v24 offset:20480
  ds_read_b64_tr_b16 v[154:155], v24 offset:21504
  v_mfma_f32_32x32x16_bf16 v[80:95], v[32:35], v[44:47], v[80:95]
  s_waitcnt lgkmcnt(3)
  v_mfma_f32_32x32x16_bf16 v[96:111], v[52:55], v[56:59], v[96:111]
  ds_read_b128 v[36:39], v10 offset:53248
  ds_read_b64_tr_b16 v[40:41], v24 offset:24576
  ds_read_b64_tr_b16 v[42:43], v24 offset:25600
  s_waitcnt lgkmcnt(3)
  v_mfma_f32_32x32x16_bf16 v[96:111], v[148:151], v[152:155], v[96:111]
  ds_read_b128 v[52:55], v11 offset:53248
  ds_read_b64_tr_b16 v[56:57], v24 offset:28672
  ds_read_b64_tr_b16 v[58:59], v24 offset:29696
  v_cvt_pk_bf16_f32 v168, v64, v65
  v_cvt_pk_bf16_f32 v169, v66, v67
  v_cvt_pk_bf16_f32 v170, v68, v69
  v_cvt_pk_bf16_f32 v171, v70, v71
  buffer_store_dwordx4 v[168:171], v128, s[12:15], s67 offen offset:0 sc1
  s_waitcnt lgkmcnt(3)
  v_mfma_f32_32x32x16_bf16 v[96:111], v[36:39], v[40:43], v[96:111]
  ds_read_b128 v[148:151], v12 offset:36864
  ds_read_b64_tr_b16 v[152:153], v28 offset:0
  ds_read_b64_tr_b16 v[154:155], v28 offset:1024
  v_cvt_pk_bf16_f32 v172, v72, v73
  v_cvt_pk_bf16_f32 v173, v74, v75
  v_cvt_pk_bf16_f32 v174, v76, v77
  v_cvt_pk_bf16_f32 v175, v78, v79
  buffer_store_dwordx4 v[172:175], v128, s[12:15], s67 offen offset:640 sc1
  s_waitcnt lgkmcnt(3)
  v_mfma_f32_32x32x16_bf16 v[96:111], v[52:55], v[56:59], v[96:111]
  ds_read_b128 v[36:39], v13 offset:36864
  ds_read_b64_tr_b16 v[40:41], v28 offset:4096
  ds_read_b64_tr_b16 v[42:43], v28 offset:5120
  v_cvt_pk_bf16_f32 v176, v80, v81
  v_cvt_pk_bf16_f32 v177, v82, v83
  v_cvt_pk_bf16_f32 v178, v84, v85
  v_cvt_pk_bf16_f32 v179, v86, v87
  buffer_store_dwordx4 v[176:179], v129, s[12:15], s67 offen offset:0 sc1
  s_waitcnt lgkmcnt(3)
  v_mfma_f32_32x32x16_bf16 v[96:111], v[148:151], v[152:155], v[96:111]
  ds_read_b128 v[52:55], v14 offset:36864
  ds_read_b64_tr_b16 v[56:57], v28 offset:8192
  ds_read_b64_tr_b16 v[58:59], v28 offset:9216
  v_cvt_pk_bf16_f32 v180, v88, v89
  v_cvt_pk_bf16_f32 v181, v90, v91
  v_cvt_pk_bf16_f32 v182, v92, v93
  v_cvt_pk_bf16_f32 v183, v94, v95
  buffer_store_dwordx4 v[180:183], v129, s[12:15], s67 offen offset:640 sc1
  s_waitcnt lgkmcnt(3)
  v_mfma_f32_32x32x16_bf16 v[96:111], v[36:39], v[40:43], v[96:111]
  ds_read_b128 v[148:151], v15 offset:36864
  ds_read_b64_tr_b16 v[152:153], v28 offset:12288
  ds_read_b64_tr_b16 v[154:155], v28 offset:13312
  s_waitcnt lgkmcnt(3)
  v_mfma_f32_32x32x16_bf16 v[96:111], v[52:55], v[56:59], v[96:111]
  ds_read_b128 v[36:39], v8 offset:4096
  ds_read_b64_tr_b16 v[40:41], v20 offset:32768
  ds_read_b64_tr_b16 v[42:43], v20 offset:33792
  s_waitcnt lgkmcnt(3)
  v_mfma_f32_32x32x16_bf16 v[96:111], v[148:151], v[152:155], v[96:111]
  ds_read_b128 v[52:55], v9 offset:4096
  ds_read_b64_tr_b16 v[56:57], v20 offset:36864
  ds_read_b64_tr_b16 v[58:59], v20 offset:37888
  s_waitcnt lgkmcnt(3)
  v_mfma_f32_32x32x16_bf16 v[96:111], v[36:39], v[40:43], v[96:111]
  ds_read_b128 v[148:151], v10 offset:4096
  ds_read_b64_tr_b16 v[152:153], v20 offset:40960
  ds_read_b64_tr_b16 v[154:155], v20 offset:41984
  s_waitcnt lgkmcnt(3)
  v_mfma_f32_32x32x16_bf16 v[96:111], v[52:55], v[56:59], v[96:111]
  ds_read_b128 v[36:39], v11 offset:4096
  ds_read_b64_tr_b16 v[40:41], v20 offset:45056
  ds_read_b64_tr_b16 v[42:43], v20 offset:46080
  s_waitcnt lgkmcnt(3)
  v_mfma_f32_32x32x16_bf16 v[96:111], v[148:151], v[152:155], v[96:111]
  ds_read_b128 v[52:55], v8 offset:53248
  ds_read_b64_tr_b16 v[60:61], v25 offset:16384
  ds_read_b64_tr_b16 v[62:63], v25 offset:17408
  s_waitcnt lgkmcnt(3)
  v_mfma_f32_32x32x16_bf16 v[96:111], v[36:39], v[40:43], v[96:111]
  ds_read_b128 v[148:151], v9 offset:53248
  ds_read_b64_tr_b16 v[156:157], v25 offset:20480
  ds_read_b64_tr_b16 v[158:159], v25 offset:21504
  s_waitcnt lgkmcnt(3)
  v_mfma_f32_32x32x16_bf16 v[112:127], v[52:55], v[60:63], v[112:127]
  ds_read_b128 v[36:39], v10 offset:53248
  ds_read_b64_tr_b16 v[44:45], v25 offset:24576
  ds_read_b64_tr_b16 v[46:47], v25 offset:25600
  s_waitcnt lgkmcnt(3)
  v_mfma_f32_32x32x16_bf16 v[112:127], v[148:151], v[156:159], v[112:127]
  ds_read_b128 v[52:55], v11 offset:53248
  ds_read_b64_tr_b16 v[60:61], v25 offset:28672
  ds_read_b64_tr_b16 v[62:63], v25 offset:29696
  s_waitcnt lgkmcnt(3)
  v_mfma_f32_32x32x16_bf16 v[112:127], v[36:39], v[44:47], v[112:127]
  ds_read_b128 v[148:151], v12 offset:36864
  ds_read_b64_tr_b16 v[156:157], v29 offset:0
  ds_read_b64_tr_b16 v[158:159], v29 offset:1024
  v_cvt_pk_bf16_f32 v184, v96, v97
  v_cvt_pk_bf16_f32 v185, v98, v99
  v_cvt_pk_bf16_f32 v186, v100, v101
  v_cvt_pk_bf16_f32 v187, v102, v103
  buffer_store_dwordx4 v[184:187], v128, s[12:15], s67 offen offset:1280 sc1
  s_waitcnt lgkmcnt(3)
  v_mfma_f32_32x32x16_bf16 v[112:127], v[52:55], v[60:63], v[112:127]
  ds_read_b128 v[36:39], v13 offset:36864
  ds_read_b64_tr_b16 v[44:45], v29 offset:4096
  ds_read_b64_tr_b16 v[46:47], v29 offset:5120
  v_cvt_pk_bf16_f32 v188, v104, v105
  v_cvt_pk_bf16_f32 v189, v106, v107
  v_cvt_pk_bf16_f32 v190, v108, v109
  v_cvt_pk_bf16_f32 v191, v110, v111
  buffer_store_dwordx4 v[188:191], v128, s[12:15], s67 offen offset:1920 sc1
  s_waitcnt lgkmcnt(3)
  v_mfma_f32_32x32x16_bf16 v[112:127], v[148:151], v[156:159], v[112:127]
  ds_read_b128 v[52:55], v14 offset:36864
  ds_read_b64_tr_b16 v[60:61], v29 offset:8192
  ds_read_b64_tr_b16 v[62:63], v29 offset:9216
  s_waitcnt lgkmcnt(3)
  v_mfma_f32_32x32x16_bf16 v[112:127], v[36:39], v[44:47], v[112:127]
  ds_read_b128 v[148:151], v15 offset:36864
  ds_read_b64_tr_b16 v[156:157], v29 offset:12288
  ds_read_b64_tr_b16 v[158:159], v29 offset:13312
  s_waitcnt lgkmcnt(3)
  v_mfma_f32_32x32x16_bf16 v[112:127], v[52:55], v[60:63], v[112:127]
  ds_read_b128 v[36:39], v8 offset:4096
  ds_read_b64_tr_b16 v[44:45], v21 offset:32768
  ds_read_b64_tr_b16 v[46:47], v21 offset:33792
  s_waitcnt lgkmcnt(3)
  v_mfma_f32_32x32x16_bf16 v[112:127], v[148:151], v[156:159], v[112:127]
  ds_read_b128 v[52:55], v9 offset:4096
  ds_read_b64_tr_b16 v[60:61], v21 offset:36864
  ds_read_b64_tr_b16 v[62:63], v21 offset:37888
  s_waitcnt lgkmcnt(3)
  v_mfma_f32_32x32x16_bf16 v[112:127], v[36:39], v[44:47], v[112:127]
  ds_read_b128 v[148:151], v10 offset:4096
  ds_read_b64_tr_b16 v[156:157], v21 offset:40960
  ds_read_b64_tr_b16 v[158:159], v21 offset:41984
  s_waitcnt lgkmcnt(3)
  v_mfma_f32_32x32x16_bf16 v[112:127], v[52:55], v[60:63], v[112:127]
  ds_read_b128 v[36:39], v11 offset:4096
  ds_read_b64_tr_b16 v[44:45], v21 offset:45056
  ds_read_b64_tr_b16 v[46:47], v21 offset:46080
  s_waitcnt lgkmcnt(3)
  v_mfma_f32_32x32x16_bf16 v[112:127], v[148:151], v[156:159], v[112:127]
  s_waitcnt lgkmcnt(0)
  v_mfma_f32_32x32x16_bf16 v[112:127], v[36:39], v[44:47], v[112:127]
  s_nop 11
  v_cvt_pk_bf16_f32 v192, v112, v113
  v_cvt_pk_bf16_f32 v193, v114, v115
  v_cvt_pk_bf16_f32 v194, v116, v117
  v_cvt_pk_bf16_f32 v195, v118, v119
  buffer_store_dwordx4 v[192:195], v129, s[12:15], s67 offen offset:1280 sc1
  v_cvt_pk_bf16_f32 v196, v120, v121
  v_cvt_pk_bf16_f32 v197, v122, v123
  v_cvt_pk_bf16_f32 v198, v124, v125
  v_cvt_pk_bf16_f32 v199, v126, v127
  buffer_store_dwordx4 v[196:199], v129, s[12:15], s67 offen offset:1920 sc1
L_qkv_pub:
  s_waitcnt vmcnt(0)
L_ci1:
  v_readfirstlane_b32 s25, v130
  s_nop 0
  s_cmp_eq_u32 s25, 8
  s_cbranch_scc1 L_cj1
  s_sleep 4
  v_mov_b32 v130, 0
  buffer_load_dword v130, v130, s[68:71], 0 offen sc1
  s_waitcnt vmcnt(0)
  s_branch L_ci1
L_cj1:
  s_barrier
  s_cmp_lg_u32 s20, 0
  s_cbranch_scc1 L_qkv_np
  s_and_saveexec_b64 s[66:67], s[74:75]
  buffer_store_dword v164, v165, s[12:15], 0 offen sc1
  s_mov_b64 exec, -1
L_qkv_np:
  s_mov_b32 s10, 0
  s_branch L_attn
L_idle:
  s_mov_b32 s10, 0
  s_waitcnt lgkmcnt(0)
  s_mov_b32 s12, s60
  s_and_b32 s13, s61, 0xffff
  s_mov_b32 s14, 268435456
  s_mov_b32 s15, 0x00020000
  s_mov_b32 s68, s58
  s_and_b32 s69, s59, 0xffff
  s_mov_b32 s70, 256
  s_mov_b32 s71, 0x00020000
  s_cmp_lt_u32 s29, 13
  s_cbranch_scc1 L_idle_nt
  s_cmp_lg_u32 s20, 1
  s_cbranch_scc1 L_idle_nt
  s_mov_b32 s16, s50
  s_and_b32 s17, s51, 0xffff
  s_mov_b32 s18, 2621440
  s_mov_b32 s19, 0x00020000
  s_mov_b32 s72, s52
  s_and_b32 s73, s53, 0xffff
  s_mov_b32 s74, 2457600
  s_mov_b32 s75, 0x00020000
  s_bfe_u32 s25, s2, 0x20001
  s_lshl_b32 s25, s25, 9
  v_add_u32 v164, s25, v1
  v_mul_u32_u24 v164, 1280, v164
  v_lshrrev_b32 v165, 4, v1
  v_mul_u32_u24 v165, 3840, v165
  v_and_b32 v166, 15, v1
  v_lshl_add_u32 v165, v166, 7, v165
  s_and_b32 s25, s2, 1
  s_mul_i32 s25, s25, 1792
  v_add_u32 v165, s25, v165
  s_lshr_b32 s62, s2, 3
  s_sub_u32 s62, s62, 26
  s_add_u32 s62, s62, 48
L_tl1:

  s_cmp_ge_u32 s62, 240
  s_cbranch_scc1 L_te1
  s_mul_i32 s25, s62, 2731
  s_lshr_b32 s25, s25, 16
  s_mul_i32 s26, s25, 24
  s_sub_u32 s26, s62, s26
  s_add_u32 s62, s62, 6
  s_cmp_ge_u32 s26, 8
  s_cbranch_scc1 L_tw1
  s_lshl_b32 s25, s25, 7
  s_mul_i32 s26, s26, 81920
  s_add_u32 s25, s25, s26
  buffer_load_dword v167, v164, s[16:19], s25 offen
  s_branch L_tl1
L_tw1:
  s_lshl_b32 s25, s25, 4
  s_add_u32 s25, s25, s26
  s_sub_u32 s25, s25, 8
  s_mul_i32 s25, s25, 15360
  buffer_load_dword v167, v165, s[72:75], s25 offen
  s_branch L_tl1
L_te1:
L_idle_nt:
  s_cmp_lt_u32 s29, 13
  s_cbranch_scc1 L_idle_nc
  s_cmp_lg_u32 s20, 2
  s_cbranch_scc1 L_idle_nc
  s_getpc_b64 s[16:17]
L_pc:
  s_sub_u32 s16, s16, L_pc-concat_heads__ssm_conv_s5__softmax_full_mha__prompt_kernel
  s_subb_u32 s17, s17, 0
  s_lshr_b32 s25, s2, 3
  s_sub_u32 s25, s25, 26
  s_lshl_b32 s25, s25, 13
  v_lshlrev_b32 v6, 7, v1
  v_add_u32 v6, s25, v6
  v_add_u32 v7, 49152, v6
  v_min_u32 v6, L_exit-concat_heads__ssm_conv_s5__softmax_full_mha__prompt_kernel, v6
  v_min_u32 v7, L_exit-concat_heads__ssm_conv_s5__softmax_full_mha__prompt_kernel, v7
  v_mov_b32 v9, s17
  v_mov_b32 v11, s17
  v_add_co_u32 v8, vcc, s16, v6
  s_nop 1
  v_addc_co_u32 v9, vcc, 0, v9, vcc
  v_add_co_u32 v10, vcc, s16, v7
  s_nop 1
  v_addc_co_u32 v11, vcc, 0, v11, vcc
  global_load_dword v6, v[8:9], off
  global_load_dword v7, v[10:11], off
L_idle_nc:
  s_cmp_lg_u32 s29, 7
  s_cbranch_scc1 L_idle_w
  v_mov_b32 v8, -1
  v_mov_b32 v9, -1
  v_mov_b32 v10, -1
  v_mov_b32 v11, -1
  v_lshlrev_b32 v12, 4, v0
  s_lshl_b32 s25, s31, 13
  s_add_u32 s25, s25, 15728640
  buffer_store_dwordx4 v[8:11], v12, s[12:15], s25 offen sc1
  s_waitcnt vmcnt(0)
  s_barrier
  s_cmp_lg_u32 s20, 0
  s_cbranch_scc1 L_idle_w
  v_mov_b32 v6, 1
  v_mov_b32 v7, 0
  s_mov_b64 exec, 1
  buffer_atomic_add v6, v7, s[68:71], 0 offen sc1
  s_mov_b64 exec, -1
L_idle_w:
  s_cmp_lg_u32 s20, 0
  s_cbranch_scc1 L_attn
  v_mov_b32 v6, 0
L_ci2:
  s_nop 0
  v_readfirstlane_b32 s25, v6
  s_nop 0
  s_cmp_eq_u32 s25, 8
  s_cbranch_scc1 L_cj2
  s_sleep 4
  v_mov_b32 v6, 0
  buffer_load_dword v6, v6, s[68:71], 0 offen sc1
  s_waitcnt vmcnt(0)
  s_branch L_ci2
L_cj2:
L_attn:
  s_and_b32 s25, s2, 7
  s_lshr_b32 s26, s2, 6
  s_lshl_b32 s26, s26, 3
  s_add_u32 s30, s25, s26
  s_bfe_u32 s31, s2, 0x30003
  s_and_b32 s22, s20, 3
  s_lshr_b32 s23, s20, 2
  v_lshlrev_b32 v38, 4, v1
  s_lshr_b32 s25, s30, 1
  s_mul_i32 s25, s25, 5
  s_and_b32 s62, s30, 1
  s_lshl_b32 s26, s62, 1
  s_add_u32 s25, s25, s26
  s_lshl_b32 s21, s25, 11
  s_mul_i32 s72, s23, 1310720
  s_add_u32 s72, s72, s21
  s_mul_i32 s73, s30, 81920
  s_mul_i32 s25, s23, 40960
  s_add_u32 s73, s73, s25
  s_add_u32 s73, s73, 5242880
  s_lshl_b32 s25, s22, 10
  s_add_u32 s74, s72, s25
  s_add_u32 s75, s74, 4096
  s_add_u32 s76, s73, s25
  s_add_u32 s26, s76, -2048
  s_add_u32 s76, s76, 2048
  s_cmp_ge_u32 s22, 2
  s_cselect_b32 s75, s26, s75
  s_mov_b32 s77, 163840
  s_cselect_b32 s77, 5120, s77
  s_mul_i32 s24, s23, 33792
  s_add_u32 s24, s24, 96256
  s_add_u32 s28, s24, s25
  s_lshl_b32 s63, s62, 11
  s_xor_b32 s64, s62, 1
  s_lshl_b32 s64, s64, 12
  s_lshl_b32 s25, s62, 3
  s_add_u32 s64, s64, s25
  v_and_b32 v2, 31, v1
  v_lshrrev_b32 v3, 5, v1
  v_lshlrev_b32 v39, 4, v2
  v_lshl_add_u32 v45, v3, 11, v39
  v_lshl_add_u32 v43, v3, 9, v39
  v_mul_u32_u24 v40, 320, v3
  v_add_u32 v40, v40, v39
  s_add_u32 s25, s24, 6144
  v_add_u32 v40, s25, v40
  s_add_u32 s25, s24, s64
  v_add_u32 v39, s25, v39
  s_add_u32 s25, s24, s63
  v_add_u32 v44, s25, v45
  s_mov_b32 s66, 0x000fffff
  s_mov_b32 s67, 0x000fffff
  v_and_b32 v3, 27, v1
  v_cmp_eq_u32 vcc, 24, v3
  v_mov_b32 v3, 0x3f803f80
  s_nop 0
  v_cndmask_b32 v12, 0, v3, vcc
  v_mov_b32 v13, v12
  v_mov_b32 v14, v12
  v_mov_b32 v15, v12
  v_mov_b32 v16, v12
  v_mov_b32 v17, v12
  v_mov_b32 v18, v12
  v_mov_b32 v19, v12
  v_mov_b32 v20, v12
  v_mov_b32 v21, v12
  v_mov_b32 v22, v12
  v_mov_b32 v23, v12
  v_mov_b32 v24, v12
  v_mov_b32 v25, v12
  v_mov_b32 v26, v12
  v_mov_b32 v27, v12
  s_cmp_lg_u32 s20, 0
  s_cbranch_scc1 L_at_rdy
  v_and_b32 v2, 56, v1
  v_add_u32 v2, s31, v2
  v_cmp_gt_u32 vcc, 16, v1
  s_nop 1
  v_cndmask_b32 v2, v1, v2, vcc
  v_lshlrev_b32 v2, 2, v2
  s_lshl_b32 s25, s30, 8
  s_add_u32 s25, s25, 15769600
  s_mov_b32 exec_hi, 0xffff
L_at_poll:
  buffer_load_dword v3, v2, s[12:15], s25 offen sc1
  s_waitcnt vmcnt(0)
  v_cmp_eq_u32 vcc, -1, v3
  s_nop 1
  s_cbranch_vccz L_at_go
  s_sleep 2
  s_branch L_at_poll
L_at_go:
  s_mov_b64 exec, -1
L_at_rdy:
  s_lshl_b32 s25, s31, 1
  s_lshr_b32 s26, s22, 1
  s_add_u32 s25, s25, s26
  s_mul_i32 s26, s25, 163840
  s_add_u32 s26, s26, s21
  s_and_b32 s25, s22, 1
  s_lshl_b32 s25, s25, 10
  s_add_u32 s26, s26, s25
  s_add_u32 s26, s26, 2621440
  s_add_u32 s27, s26, s63
  s_add_u32 s26, s26, s64
  s_barrier
  s_add_u32 m0, s28, 0
  s_nop 0
  buffer_load_dwordx4 v38, s[12:15], s74 offen sc1 lds
  s_add_u32 m0, s28, 4096
  s_add_u32 s74, s74, 163840
  buffer_load_dwordx4 v38, s[12:15], s75 offen sc1 lds
  s_add_u32 m0, s28, 8192
  s_add_u32 s75, s75, s77
  s_cmp_eq_u32 s22, 3
  s_cbranch_scc1 L_at_d0
  buffer_load_dwordx4 v38, s[12:15], s76 offen sc1 lds
  s_add_u32 s76, s76, 5120
L_at_d0:
  buffer_load_dwordx4 v[28:31], v45, s[12:15], s27 offen sc1
  buffer_load_dwordx4 v[32:35], v45, s[12:15], s27 offen offset:512 sc1
  buffer_load_dwordx2 v[36:37], v43, s[12:15], s26 offen sc1
  s_cmp_eq_u32 s10, 0
  s_cbranch_scc1 L_se_done
  v_pk_mul_f32 v[248:249], v[200:201], v[246:247]
  v_pk_mul_f32 v[200:201], v[200:201], v[244:245]
  v_pk_fma_f32 v[200:201], v[216:217], v[246:247], v[200:201] neg_lo:[1,0,0] neg_hi:[1,0,0]
  v_pk_fma_f32 v[216:217], v[216:217], v[244:245], v[248:249]
  v_pk_mul_f32 v[248:249], v[202:203], v[246:247]
  v_pk_mul_f32 v[202:203], v[202:203], v[244:245]
  v_pk_fma_f32 v[202:203], v[218:219], v[246:247], v[202:203] neg_lo:[1,0,0] neg_hi:[1,0,0]
  v_pk_fma_f32 v[218:219], v[218:219], v[244:245], v[248:249]
  v_fma_f32 v142, v232, v132, v200
  v_fma_f32 v143, v232, v133, v216
  v_fma_f32 v142, -v233, v133, v142
  v_fma_f32 v143, v233, v132, v143
  v_fma_f32 v140, v232, v142, v201
  v_fma_f32 v141, v232, v143, v217
  v_fma_f32 v140, -v233, v143, v140
  v_fma_f32 v141, v233, v142, v141
  v_pk_mul_f32 v[248:249], v[204:205], v[246:247]
  v_pk_mul_f32 v[204:205], v[204:205], v[244:245]
  v_pk_fma_f32 v[204:205], v[220:221], v[246:247], v[204:205] neg_lo:[1,0,0] neg_hi:[1,0,0]
  v_pk_fma_f32 v[220:221], v[220:221], v[244:245], v[248:249]
  v_fma_f32 v142, v232, v140, v202
  v_fma_f32 v143, v232, v141, v218
  v_fma_f32 v142, -v233, v141, v142
  v_fma_f32 v143, v233, v140, v143
  v_fma_f32 v140, v232, v142, v203
  v_fma_f32 v141, v232, v143, v219
  v_fma_f32 v140, -v233, v143, v140
  v_fma_f32 v141, v233, v142, v141
  v_pk_mul_f32 v[248:249], v[206:207], v[246:247]
  v_pk_mul_f32 v[206:207], v[206:207], v[244:245]
  v_pk_fma_f32 v[206:207], v[222:223], v[246:247], v[206:207] neg_lo:[1,0,0] neg_hi:[1,0,0]
  v_pk_fma_f32 v[222:223], v[222:223], v[244:245], v[248:249]
  v_fma_f32 v142, v232, v140, v204
  v_fma_f32 v143, v232, v141, v220
  v_fma_f32 v142, -v233, v141, v142
  v_fma_f32 v143, v233, v140, v143
  v_fma_f32 v140, v232, v142, v205
  v_fma_f32 v141, v232, v143, v221
  v_fma_f32 v140, -v233, v143, v140
  v_fma_f32 v141, v233, v142, v141
  v_pk_mul_f32 v[248:249], v[208:209], v[246:247]
  v_pk_mul_f32 v[208:209], v[208:209], v[244:245]
  v_pk_fma_f32 v[208:209], v[224:225], v[246:247], v[208:209] neg_lo:[1,0,0] neg_hi:[1,0,0]
  v_pk_fma_f32 v[224:225], v[224:225], v[244:245], v[248:249]
  v_fma_f32 v142, v232, v140, v206
  v_fma_f32 v143, v232, v141, v222
  v_fma_f32 v142, -v233, v141, v142
  v_fma_f32 v143, v233, v140, v143
  v_fma_f32 v140, v232, v142, v207
  v_fma_f32 v141, v232, v143, v223
  v_fma_f32 v140, -v233, v143, v140
  v_fma_f32 v141, v233, v142, v141
  v_pk_mul_f32 v[248:249], v[210:211], v[246:247]
  v_pk_mul_f32 v[210:211], v[210:211], v[244:245]
  v_pk_fma_f32 v[210:211], v[226:227], v[246:247], v[210:211] neg_lo:[1,0,0] neg_hi:[1,0,0]
  v_pk_fma_f32 v[226:227], v[226:227], v[244:245], v[248:249]
  v_fma_f32 v142, v232, v140, v208
  v_fma_f32 v143, v232, v141, v224
  v_fma_f32 v142, -v233, v141, v142
  v_fma_f32 v143, v233, v140, v143
  v_fma_f32 v140, v232, v142, v209
  v_fma_f32 v141, v232, v143, v225
  v_fma_f32 v140, -v233, v143, v140
  v_fma_f32 v141, v233, v142, v141
  v_pk_mul_f32 v[248:249], v[212:213], v[246:247]
  v_pk_mul_f32 v[212:213], v[212:213], v[244:245]
  v_pk_fma_f32 v[212:213], v[228:229], v[246:247], v[212:213] neg_lo:[1,0,0] neg_hi:[1,0,0]
  v_pk_fma_f32 v[228:229], v[228:229], v[244:245], v[248:249]
  v_fma_f32 v142, v232, v140, v210
  v_fma_f32 v143, v232, v141, v226
  v_fma_f32 v142, -v233, v141, v142
  v_fma_f32 v143, v233, v140, v143
  v_fma_f32 v140, v232, v142, v211
  v_fma_f32 v141, v232, v143, v227
  v_fma_f32 v140, -v233, v143, v140
  v_fma_f32 v141, v233, v142, v141
  v_pk_mul_f32 v[248:249], v[214:215], v[246:247]
  v_pk_mul_f32 v[214:215], v[214:215], v[244:245]
  v_pk_fma_f32 v[214:215], v[230:231], v[246:247], v[214:215] neg_lo:[1,0,0] neg_hi:[1,0,0]
  v_pk_fma_f32 v[230:231], v[230:231], v[244:245], v[248:249]
  v_fma_f32 v142, v232, v140, v212
  v_fma_f32 v143, v232, v141, v228
  v_fma_f32 v142, -v233, v141, v142
  v_fma_f32 v143, v233, v140, v143
  v_fma_f32 v140, v232, v142, v213
  v_fma_f32 v141, v232, v143, v229
  v_fma_f32 v140, -v233, v143, v140
  v_fma_f32 v141, v233, v142, v141
  v_fma_f32 v142, v232, v140, v214
  v_fma_f32 v143, v232, v141, v230
  v_fma_f32 v142, -v233, v141, v142
  v_fma_f32 v143, v233, v140, v143
  v_fma_f32 v140, v232, v142, v215
  v_fma_f32 v141, v232, v143, v231
  v_fma_f32 v140, -v233, v143, v140
  v_fma_f32 v141, v233, v142, v141
  v_lshrrev_b32 v6, 5, v1
  s_lshl_b32 s25, s3, 1
  v_add_u32 v6, s25, v6
  v_and_b32 v7, 63, v128
  v_lshlrev_b32 v7, 3, v7
  v_lshl_add_u32 v6, v6, 9, v7
  ds_write_b64 v6, v[140:141]
  s_lshl_b32 s25, s3, 10
  v_add_u32 v6, s25, v7
  v_lshlrev_b32 v242, 3, v128
  v_lshrrev_b32 v243, 5, v1
  v_mul_u32_u24 v243, 81920, v243
  v_lshl_add_u32 v243, v128, 4, v243
  v_mov_b32 v238, 0
  v_mov_b32 v239, 0
  v_mov_b32 v240, 1.0
  v_mov_b32 v241, 0
  s_waitcnt lgkmcnt(0)
  s_barrier
  ds_read_b64 v[64:65], v7 offset:0
  ds_read_b64 v[66:67], v7 offset:512
  ds_read_b64 v[68:69], v7 offset:1024
  ds_read_b64 v[70:71], v7 offset:1536
  ds_read_b64 v[72:73], v7 offset:2048
  ds_read_b64 v[74:75], v7 offset:2560
  ds_read_b64 v[76:77], v7 offset:3072
  ds_read_b64 v[78:79], v7 offset:3584
  ds_read_b64 v[142:143], v6
  v_mov_b32 v160, 0
  v_mov_b32 v161, 0
  v_mov_b32 v162, 0
  v_mov_b32 v163, 0
  v_mov_b32 v164, 0
  v_mov_b32 v165, 0
  v_mov_b32 v166, 0
  v_mov_b32 v167, 0
  v_mov_b32 v244, 0
  v_mov_b32 v245, 0
  v_mov_b32 v246, 0
  v_mov_b32 v247, 0
  v_mov_b32 v248, 0
  v_mov_b32 v249, 0
  s_waitcnt lgkmcnt(0)
  s_cmp_lg_u32 s3, 0
  s_cbranch_scc1 L_ch_nopub
  v_fma_f32 v6, v64, v136, v66
  v_fma_f32 v6, -v65, v137, v6
  v_fma_f32 v7, v64, v137, v67
  v_fma_f32 v151, v65, v136, v7
  v_mov_b32 v150, v6
  v_fma_f32 v6, v150, v136, v68
  v_fma_f32 v6, -v151, v137, v6
  v_fma_f32 v7, v150, v137, v69
  v_fma_f32 v151, v151, v136, v7
  v_mov_b32 v150, v6
  v_fma_f32 v6, v150, v136, v70
  v_fma_f32 v6, -v151, v137, v6
  v_fma_f32 v7, v150, v137, v71
  v_fma_f32 v151, v151, v136, v7
  v_mov_b32 v150, v6
  v_fma_f32 v6, v150, v136, v72
  v_fma_f32 v6, -v151, v137, v6
  v_fma_f32 v7, v150, v137, v73
  v_fma_f32 v151, v151, v136, v7
  v_mov_b32 v150, v6
  v_fma_f32 v6, v150, v136, v74
  v_fma_f32 v6, -v151, v137, v6
  v_fma_f32 v7, v150, v137, v75
  v_fma_f32 v151, v151, v136, v7
  v_mov_b32 v150, v6
  v_fma_f32 v6, v150, v136, v76
  v_fma_f32 v6, -v151, v137, v6
  v_fma_f32 v7, v150, v137, v77
  v_fma_f32 v151, v151, v136, v7
  v_mov_b32 v150, v6
  v_fma_f32 v6, v150, v136, v78
  v_fma_f32 v6, -v151, v137, v6
  v_fma_f32 v7, v150, v137, v79
  v_fma_f32 v151, v151, v136, v7
  v_mov_b32 v150, v6
  v_min_u32 v150, -2, v150
  v_min_u32 v151, -2, v151
  s_mul_i32 s25, s8, 5120
  s_add_u32 s25, s25, 15728640
  s_mov_b32 exec_hi, 0
  s_waitcnt vmcnt(0)
  buffer_store_dwordx2 v[150:151], v242, s[12:15], s25 offen sc1
  s_mov_b64 exec, -1
L_ch_nopub:
  s_cmp_le_u32 s3, 0
  s_cbranch_scc1 L_ch_c0
  v_fma_f32 v6, v238, v136, v64
  v_fma_f32 v6, -v239, v137, v6
  v_fma_f32 v7, v238, v137, v65
  v_fma_f32 v239, v239, v136, v7
  v_mov_b32 v238, v6
  v_mul_f32 v4, v240, v136
  v_fma_f32 v4, -v241, v137, v4
  v_mul_f32 v5, v240, v137
  v_fma_f32 v241, v241, v136, v5
  v_mov_b32 v240, v4
  v_fma_f32 v6, v238, v136, v66
  v_fma_f32 v6, -v239, v137, v6
  v_fma_f32 v7, v238, v137, v67
  v_fma_f32 v239, v239, v136, v7
  v_mov_b32 v238, v6
  v_mul_f32 v4, v240, v136
  v_fma_f32 v4, -v241, v137, v4
  v_mul_f32 v5, v240, v137
  v_fma_f32 v241, v241, v136, v5
  v_mov_b32 v240, v4
  s_cmp_le_u32 s3, 1
  s_cbranch_scc1 L_ch_c0
  v_fma_f32 v6, v238, v136, v68
  v_fma_f32 v6, -v239, v137, v6
  v_fma_f32 v7, v238, v137, v69
  v_fma_f32 v239, v239, v136, v7
  v_mov_b32 v238, v6
  v_mul_f32 v4, v240, v136
  v_fma_f32 v4, -v241, v137, v4
  v_mul_f32 v5, v240, v137
  v_fma_f32 v241, v241, v136, v5
  v_mov_b32 v240, v4
  v_fma_f32 v6, v238, v136, v70
  v_fma_f32 v6, -v239, v137, v6
  v_fma_f32 v7, v238, v137, v71
  v_fma_f32 v239, v239, v136, v7
  v_mov_b32 v238, v6
  v_mul_f32 v4, v240, v136
  v_fma_f32 v4, -v241, v137, v4
  v_mul_f32 v5, v240, v137
  v_fma_f32 v241, v241, v136, v5
  v_mov_b32 v240, v4
  s_cmp_le_u32 s3, 2
  s_cbranch_scc1 L_ch_c0
  v_fma_f32 v6, v238, v136, v72
  v_fma_f32 v6, -v239, v137, v6
  v_fma_f32 v7, v238, v137, v73
  v_fma_f32 v239, v239, v136, v7
  v_mov_b32 v238, v6
  v_mul_f32 v4, v240, v136
  v_fma_f32 v4, -v241, v137, v4
  v_mul_f32 v5, v240, v137
  v_fma_f32 v241, v241, v136, v5
  v_mov_b32 v240, v4
  v_fma_f32 v6, v238, v136, v74
  v_fma_f32 v6, -v239, v137, v6
  v_fma_f32 v7, v238, v137, v75
  v_fma_f32 v239, v239, v136, v7
  v_mov_b32 v238, v6
  v_mul_f32 v4, v240, v136
  v_fma_f32 v4, -v241, v137, v4
  v_mul_f32 v5, v240, v137
  v_fma_f32 v241, v241, v136, v5
  v_mov_b32 v240, v4
L_ch_c0:
  v_fma_f32 v6, v238, v136, v142
  v_fma_f32 v6, -v239, v137, v6
  v_fma_f32 v7, v238, v137, v143
  v_fma_f32 v141, v239, v136, v7
  v_mov_b32 v140, v6
  v_mul_f32 v6, v240, v136
  v_fma_f32 v6, -v241, v137, v6
  v_mul_f32 v7, v240, v137
  v_fma_f32 v143, v241, v136, v7
  v_mov_b32 v142, v6
  v_cmp_gt_u32 vcc, 32, v1
  s_nop 1
  v_cndmask_b32 v238, v140, v238, vcc
  v_cndmask_b32 v239, v141, v239, vcc
  v_cndmask_b32 v240, v142, v240, vcc
  v_cndmask_b32 v241, v143, v241, vcc
  s_cmp_eq_u32 s3, 0
  s_cbranch_scc1 L_at_nw
L_se_done:
  s_waitcnt vmcnt(0)
L_at_nw:
  s_barrier
  ds_read_b128 v[4:7], v44 offset:0
  ds_read2st64_b64 v[8:11], v39 offset0:0 offset1:1
  s_mov_b64 exec, s[66:67]
  ds_read_b128 v[12:15], v40 offset:0
  ds_read_b128 v[16:19], v40 offset:640
  s_mov_b64 exec, -1
  s_add_u32 m0, s28, 11264
  s_nop 0
  buffer_load_dwordx4 v38, s[12:15], s74 offen sc1 lds
  s_add_u32 m0, s28, 15360
  s_add_u32 s74, s74, 163840
  buffer_load_dwordx4 v38, s[12:15], s75 offen sc1 lds
  s_add_u32 m0, s28, 19456
  s_add_u32 s75, s75, s77
  s_cmp_eq_u32 s22, 3
  s_cbranch_scc1 L_at_d1
  buffer_load_dwordx4 v38, s[12:15], s76 offen sc1 lds
  s_add_u32 s76, s76, 5120
L_at_d1:
  s_waitcnt lgkmcnt(2)
  v_mfma_f32_32x32x16_bf16 v[48:63], v[4:7], v[28:31], 0
  v_mfma_f32_32x32x16_bf16 v[64:79], v[4:7], v[32:35], 0
  ds_read_b128 v[4:7], v44 offset:512
  s_nop 8
  v_mfma_f32_32x32x4_2b_bf16 v[48:79], v[8:9], v[36:37], v[48:79]
  s_nop 15
  s_nop 3
  v_max3_f32 v2, v48, v49, v50
  v_max3_f32 v3, v64, v65, v66
  v_max3_f32 v2, v2, v51, v67
  v_max_f32 v2, v2, v3
  v_mov_b32 v3, v2
  s_nop 1
  v_permlane32_swap_b32 v2, v3
  v_max_f32 v41, v2, v3
  v_sub_f32 v112, 0, v41
  v_sub_f32 v113, 0, v41
  v_sub_f32 v114, 0, v41
  v_sub_f32 v115, 0, v41
  v_sub_f32 v116, 0, v41
  v_sub_f32 v117, 0, v41
  v_sub_f32 v118, 0, v41
  v_sub_f32 v119, 0, v41
  v_sub_f32 v120, 0, v41
  v_sub_f32 v121, 0, v41
  v_sub_f32 v122, 0, v41
  v_sub_f32 v123, 0, v41
  v_sub_f32 v124, 0, v41
  v_sub_f32 v125, 0, v41
  v_sub_f32 v126, 0, v41
  v_sub_f32 v127, 0, v41
  v_mov_b32 v42, v41
  s_waitcnt lgkmcnt(0)
  v_mfma_f32_32x32x16_bf16 v[80:95], v[4:7], v[28:31], v[112:127]
  v_sub_f32 v48, v48, v41
  v_sub_f32 v49, v49, v41
  v_sub_f32 v50, v50, v41
  v_sub_f32 v51, v51, v41
  v_sub_f32 v52, v52, v41
  v_sub_f32 v53, v53, v41
  v_sub_f32 v54, v54, v41
  v_sub_f32 v55, v55, v41
  v_sub_f32 v56, v56, v41
  v_sub_f32 v57, v57, v41
  v_sub_f32 v58, v58, v41
  v_sub_f32 v59, v59, v41
  v_sub_f32 v60, v60, v41
  v_sub_f32 v61, v61, v41
  v_sub_f32 v62, v62, v41
  v_sub_f32 v63, v63, v41
  v_sub_f32 v64, v64, v41
  v_sub_f32 v65, v65, v41
  v_sub_f32 v66, v66, v41
  v_sub_f32 v67, v67, v41
  v_sub_f32 v68, v68, v41
  v_sub_f32 v69, v69, v41
  v_sub_f32 v70, v70, v41
  v_sub_f32 v71, v71, v41
  v_sub_f32 v72, v72, v41
  v_sub_f32 v73, v73, v41
  v_sub_f32 v74, v74, v41
  v_sub_f32 v75, v75, v41
  v_sub_f32 v76, v76, v41
  v_sub_f32 v77, v77, v41
  v_sub_f32 v78, v78, v41
  v_sub_f32 v79, v79, v41
  s_setprio 2
  v_exp_f32 v48, v48
  v_exp_f32 v49, v49
  s_mov_b64 exec, s[66:67]
  ds_read_b128 v[20:23], v40 offset:1280
  ds_read_b128 v[24:27], v40 offset:1920
  s_mov_b64 exec, -1
  v_exp_f32 v50, v50
  v_exp_f32 v51, v51
  v_exp_f32 v52, v52
  v_exp_f32 v53, v53
  v_exp_f32 v54, v54
  v_exp_f32 v55, v55
  v_cvt_pk_bf16_f32 v48, v48, v49
  v_cvt_pk_bf16_f32 v49, v50, v51
  v_cvt_pk_bf16_f32 v50, v52, v53
  v_cvt_pk_bf16_f32 v51, v54, v55
  v_mfma_f32_32x32x16_bf16 v[96:111], v[4:7], v[32:35], v[112:127]
  v_exp_f32 v56, v56
  v_exp_f32 v57, v57
  v_exp_f32 v58, v58
  v_exp_f32 v59, v59
  v_exp_f32 v60, v60
  v_mfma_f32_32x32x16_bf16 v[128:143], v[12:15], v[48:51], 0
  v_exp_f32 v61, v61
  v_exp_f32 v62, v62
  v_exp_f32 v63, v63
  v_cvt_pk_bf16_f32 v56, v56, v57
  v_cvt_pk_bf16_f32 v57, v58, v59
  v_cvt_pk_bf16_f32 v58, v60, v61
  v_cvt_pk_bf16_f32 v59, v62, v63
  v_mfma_f32_32x32x4_2b_bf16 v[80:111], v[10:11], v[36:37], v[80:111]
  ds_read_b128 v[4:7], v44 offset:1024
  v_exp_f32 v64, v64
  v_exp_f32 v65, v65
  v_exp_f32 v66, v66
  v_exp_f32 v67, v67
  ds_read2st64_b64 v[8:11], v39 offset0:2 offset1:3
  v_exp_f32 v68, v68
  v_exp_f32 v69, v69
  v_exp_f32 v70, v70
  v_exp_f32 v71, v71
  v_mfma_f32_32x32x16_bf16 v[128:143], v[16:19], v[56:59], v[128:143]
  v_cvt_pk_bf16_f32 v64, v64, v65
  v_cvt_pk_bf16_f32 v65, v66, v67
  v_cvt_pk_bf16_f32 v66, v68, v69
  v_cvt_pk_bf16_f32 v67, v70, v71
  v_exp_f32 v72, v72
  v_exp_f32 v73, v73
  v_exp_f32 v74, v74
  v_mfma_f32_32x32x16_bf16 v[144:159], v[12:15], v[64:67], 0
  v_exp_f32 v75, v75
  v_exp_f32 v76, v76
  v_exp_f32 v77, v77
  v_exp_f32 v78, v78
  v_exp_f32 v79, v79
  v_cvt_pk_bf16_f32 v72, v72, v73
  v_cvt_pk_bf16_f32 v73, v74, v75
  v_cvt_pk_bf16_f32 v74, v76, v77
  v_cvt_pk_bf16_f32 v75, v78, v79
  s_waitcnt lgkmcnt(0)
  s_setprio 1
  v_mfma_f32_32x32x16_bf16 v[144:159], v[16:19], v[72:75], v[144:159]
  v_exp_f32 v80, v80
  v_exp_f32 v81, v81
  s_mov_b64 exec, s[66:67]
  ds_read_b128 v[12:15], v40 offset:2560
  ds_read_b128 v[16:19], v40 offset:3200
  s_mov_b64 exec, -1
  v_exp_f32 v82, v82
  v_exp_f32 v83, v83
  v_exp_f32 v84, v84
  v_mfma_f32_32x32x16_bf16 v[48:63], v[4:7], v[28:31], v[112:127]
  v_exp_f32 v85, v85
  v_exp_f32 v86, v86
  v_exp_f32 v87, v87
  v_cvt_pk_bf16_f32 v80, v80, v81
  v_cvt_pk_bf16_f32 v81, v82, v83
  v_cvt_pk_bf16_f32 v82, v84, v85
  v_cvt_pk_bf16_f32 v83, v86, v87
  v_mfma_f32_32x32x16_bf16 v[64:79], v[4:7], v[32:35], v[112:127]
  v_exp_f32 v88, v88
  v_exp_f32 v89, v89
  v_exp_f32 v90, v90
  v_exp_f32 v91, v91
  v_exp_f32 v92, v92
  v_mfma_f32_32x32x16_bf16 v[128:143], v[20:23], v[80:83], v[128:143]
  v_exp_f32 v93, v93
  v_exp_f32 v94, v94
  v_exp_f32 v95, v95
  v_cvt_pk_bf16_f32 v88, v88, v89
  v_cvt_pk_bf16_f32 v89, v90, v91
  v_cvt_pk_bf16_f32 v90, v92, v93
  v_cvt_pk_bf16_f32 v91, v94, v95
  v_mfma_f32_32x32x4_2b_bf16 v[48:79], v[8:9], v[36:37], v[48:79]
  ds_read_b128 v[4:7], v44 offset:1536
  v_exp_f32 v96, v96
  v_exp_f32 v97, v97
  v_exp_f32 v98, v98
  v_exp_f32 v99, v99
  v_exp_f32 v100, v100
  v_exp_f32 v101, v101
  v_exp_f32 v102, v102
  v_exp_f32 v103, v103
  v_mfma_f32_32x32x16_bf16 v[128:143], v[24:27], v[88:91], v[128:143]
  v_cvt_pk_bf16_f32 v96, v96, v97
  v_cvt_pk_bf16_f32 v97, v98, v99
  v_cvt_pk_bf16_f32 v98, v100, v101
  v_cvt_pk_bf16_f32 v99, v102, v103
  v_exp_f32 v104, v104
  v_exp_f32 v105, v105
  v_exp_f32 v106, v106
  v_mfma_f32_32x32x16_bf16 v[144:159], v[20:23], v[96:99], v[144:159]
  v_exp_f32 v107, v107
  v_exp_f32 v108, v108
  v_exp_f32 v109, v109
  v_exp_f32 v110, v110
  v_exp_f32 v111, v111
  v_cvt_pk_bf16_f32 v104, v104, v105
  v_cvt_pk_bf16_f32 v105, v106, v107
  v_cvt_pk_bf16_f32 v106, v108, v109
  v_cvt_pk_bf16_f32 v107, v110, v111
  s_waitcnt lgkmcnt(0)
  s_setprio 0
  v_mfma_f32_32x32x16_bf16 v[144:159], v[24:27], v[104:107], v[144:159]
  v_exp_f32 v48, v48
  v_exp_f32 v49, v49
  s_mov_b64 exec, s[66:67]
  ds_read_b128 v[20:23], v40 offset:3840
  ds_read_b128 v[24:27], v40 offset:4480
  s_mov_b64 exec, -1
  v_exp_f32 v50, v50
  v_exp_f32 v51, v51
  v_exp_f32 v52, v52
  v_mfma_f32_32x32x16_bf16 v[80:95], v[4:7], v[28:31], v[112:127]
  v_exp_f32 v53, v53
  v_exp_f32 v54, v54
  v_exp_f32 v55, v55
  v_cvt_pk_bf16_f32 v48, v48, v49
  v_cvt_pk_bf16_f32 v49, v50, v51
  v_cvt_pk_bf16_f32 v50, v52, v53
  v_cvt_pk_bf16_f32 v51, v54, v55
  v_mfma_f32_32x32x16_bf16 v[96:111], v[4:7], v[32:35], v[112:127]
  v_exp_f32 v56, v56
  v_exp_f32 v57, v57
  v_exp_f32 v58, v58
  v_exp_f32 v59, v59
  v_exp_f32 v60, v60
  v_mfma_f32_32x32x16_bf16 v[128:143], v[12:15], v[48:51], v[128:143]
  v_exp_f32 v61, v61
  v_exp_f32 v62, v62
  v_exp_f32 v63, v63
  v_cvt_pk_bf16_f32 v56, v56, v57
  v_cvt_pk_bf16_f32 v57, v58, v59
  v_cvt_pk_bf16_f32 v58, v60, v61
  v_cvt_pk_bf16_f32 v59, v62, v63
  v_mfma_f32_32x32x4_2b_bf16 v[80:111], v[10:11], v[36:37], v[80:111]
  s_waitcnt vmcnt(0)
  s_barrier
  s_setprio 3
  ds_read_b128 v[4:7], v44 offset:11264
  v_exp_f32 v64, v64
  v_exp_f32 v65, v65
  v_exp_f32 v66, v66
  v_exp_f32 v67, v67
  s_add_u32 m0, s28, 22528
  s_nop 0
  buffer_load_dwordx4 v38, s[12:15], s74 offen sc1 lds
  s_add_u32 s74, s74, 163840
  ds_read2st64_b64 v[8:11], v39 offset0:22 offset1:23
  v_exp_f32 v68, v68
  v_exp_f32 v69, v69
  v_exp_f32 v70, v70
  v_exp_f32 v71, v71
  v_mfma_f32_32x32x16_bf16 v[128:143], v[16:19], v[56:59], v[128:143]
  v_cvt_pk_bf16_f32 v64, v64, v65
  v_cvt_pk_bf16_f32 v65, v66, v67
  v_cvt_pk_bf16_f32 v66, v68, v69
  v_cvt_pk_bf16_f32 v67, v70, v71
  s_add_u32 m0, s28, 26624
  s_nop 0
  buffer_load_dwordx4 v38, s[12:15], s75 offen sc1 lds
  s_add_u32 s75, s75, s77
  v_exp_f32 v72, v72
  v_exp_f32 v73, v73
  v_exp_f32 v74, v74
  v_mfma_f32_32x32x16_bf16 v[144:159], v[12:15], v[64:67], v[144:159]
  v_exp_f32 v75, v75
  v_exp_f32 v76, v76
  v_exp_f32 v77, v77
  s_add_u32 m0, s28, 30720
  s_cmp_eq_u32 s22, 3
  s_cbranch_scc1 L_at_d4
  buffer_load_dwordx4 v38, s[12:15], s76 offen sc1 lds
  s_add_u32 s76, s76, 5120
L_at_d4:
  v_exp_f32 v78, v78
  v_exp_f32 v79, v79
  v_cvt_pk_bf16_f32 v72, v72, v73
  v_cvt_pk_bf16_f32 v73, v74, v75
  v_cvt_pk_bf16_f32 v74, v76, v77
  v_cvt_pk_bf16_f32 v75, v78, v79
  s_waitcnt lgkmcnt(0)
  s_nop 0
  v_mfma_f32_32x32x16_bf16 v[144:159], v[16:19], v[72:75], v[144:159]
  v_exp_f32 v80, v80
  v_exp_f32 v81, v81
  s_mov_b64 exec, s[66:67]
  ds_read_b128 v[12:15], v40 offset:11264
  ds_read_b128 v[16:19], v40 offset:11904
  s_mov_b64 exec, -1
  v_exp_f32 v82, v82
  v_exp_f32 v83, v83
  v_exp_f32 v84, v84
  v_mfma_f32_32x32x16_bf16 v[48:63], v[4:7], v[28:31], v[112:127]
  v_exp_f32 v85, v85
  v_exp_f32 v86, v86
  v_exp_f32 v87, v87
  v_cvt_pk_bf16_f32 v80, v80, v81
  v_cvt_pk_bf16_f32 v81, v82, v83
  v_cvt_pk_bf16_f32 v82, v84, v85
  v_cvt_pk_bf16_f32 v83, v86, v87
  v_mfma_f32_32x32x16_bf16 v[64:79], v[4:7], v[32:35], v[112:127]
  v_exp_f32 v88, v88
  v_exp_f32 v89, v89
  v_exp_f32 v90, v90
  v_exp_f32 v91, v91
  v_exp_f32 v92, v92
  v_mfma_f32_32x32x16_bf16 v[128:143], v[20:23], v[80:83], v[128:143]
  v_exp_f32 v93, v93
  v_exp_f32 v94, v94
  v_exp_f32 v95, v95
  v_cvt_pk_bf16_f32 v88, v88, v89
  v_cvt_pk_bf16_f32 v89, v90, v91
  v_cvt_pk_bf16_f32 v90, v92, v93
  v_cvt_pk_bf16_f32 v91, v94, v95
  v_mfma_f32_32x32x4_2b_bf16 v[48:79], v[8:9], v[36:37], v[48:79]
  ds_read_b128 v[4:7], v44 offset:11776
  s_cmp_eq_u32 s10, 0
  s_cbranch_scc1 L_hk0
  s_cmp_le_u32 s8, 0
  s_cbranch_scc1 L_el0
  s_mov_b32 s25, 15728640
  buffer_load_dwordx2 v[160:161], v242, s[12:15], s25 offen sc1
  s_cmp_le_u32 s8, 1
  s_cbranch_scc1 L_el0
  s_mov_b32 s25, 15733760
  buffer_load_dwordx2 v[162:163], v242, s[12:15], s25 offen sc1
  s_cmp_le_u32 s8, 2
  s_cbranch_scc1 L_el0
  s_mov_b32 s25, 15738880
  buffer_load_dwordx2 v[164:165], v242, s[12:15], s25 offen sc1
  s_cmp_le_u32 s8, 3
  s_cbranch_scc1 L_el0
  s_mov_b32 s25, 15744000
  buffer_load_dwordx2 v[166:167], v242, s[12:15], s25 offen sc1
  s_cmp_le_u32 s8, 4
  s_cbranch_scc1 L_el0
  s_mov_b32 s25, 15749120
  buffer_load_dwordx2 v[244:245], v242, s[12:15], s25 offen sc1
  s_cmp_le_u32 s8, 5
  s_cbranch_scc1 L_el0
  s_mov_b32 s25, 15754240
  buffer_load_dwordx2 v[246:247], v242, s[12:15], s25 offen sc1
  s_cmp_le_u32 s8, 6
  s_cbranch_scc1 L_el0
  s_mov_b32 s25, 15759360
  buffer_load_dwordx2 v[248:249], v242, s[12:15], s25 offen sc1
L_el0:
L_hk0:
  s_lshr_b32 s25, s2, 3
  s_lshl_b32 s25, s25, 3
  s_add_u32 s25, s25, s20
  v_lshlrev_b32 v2, 7, v1
  s_cmp_lt_u32 s25, 128
  s_cselect_b32 s4, s42, s44
  s_cselect_b32 s5, s43, s45
  s_and_b32 s25, s25, 127
  s_and_b32 s5, s5, 0xffff
  s_mov_b32 s6, 819200
  s_mov_b32 s7, 0x00020000
  s_lshl_b32 s25, s25, 13
  buffer_load_dword v43, v2, s[4:7], s25 offen
  v_exp_f32 v96, v96
  v_exp_f32 v97, v97
  v_exp_f32 v98, v98
  v_exp_f32 v99, v99
  v_exp_f32 v100, v100
  v_exp_f32 v101, v101
  v_exp_f32 v102, v102
  v_exp_f32 v103, v103
  v_mfma_f32_32x32x16_bf16 v[128:143], v[24:27], v[88:91], v[128:143]
  v_cvt_pk_bf16_f32 v96, v96, v97
  v_cvt_pk_bf16_f32 v97, v98, v99
  v_cvt_pk_bf16_f32 v98, v100, v101
  v_cvt_pk_bf16_f32 v99, v102, v103
  v_exp_f32 v104, v104
  v_exp_f32 v105, v105
  v_exp_f32 v106, v106
  v_mfma_f32_32x32x16_bf16 v[144:159], v[20:23], v[96:99], v[144:159]
  v_exp_f32 v107, v107
  v_exp_f32 v108, v108
  v_exp_f32 v109, v109
  v_exp_f32 v110, v110
  v_exp_f32 v111, v111
  v_cvt_pk_bf16_f32 v104, v104, v105
  v_cvt_pk_bf16_f32 v105, v106, v107
  v_cvt_pk_bf16_f32 v106, v108, v109
  v_cvt_pk_bf16_f32 v107, v110, v111
  s_waitcnt lgkmcnt(0)
  s_setprio 2
  v_mfma_f32_32x32x16_bf16 v[144:159], v[24:27], v[104:107], v[144:159]
  v_exp_f32 v48, v48
  v_exp_f32 v49, v49
  s_mov_b64 exec, s[66:67]
  ds_read_b128 v[20:23], v40 offset:12544
  ds_read_b128 v[24:27], v40 offset:13184
  s_mov_b64 exec, -1
  v_exp_f32 v50, v50
  v_exp_f32 v51, v51
  v_exp_f32 v52, v52
  v_mfma_f32_32x32x16_bf16 v[80:95], v[4:7], v[28:31], v[112:127]
  v_exp_f32 v53, v53
  v_exp_f32 v54, v54
  v_exp_f32 v55, v55
  v_cvt_pk_bf16_f32 v48, v48, v49
  v_cvt_pk_bf16_f32 v49, v50, v51
  v_cvt_pk_bf16_f32 v50, v52, v53
  v_cvt_pk_bf16_f32 v51, v54, v55
  v_mfma_f32_32x32x16_bf16 v[96:111], v[4:7], v[32:35], v[112:127]
  v_exp_f32 v56, v56
  v_exp_f32 v57, v57
  v_exp_f32 v58, v58
  v_exp_f32 v59, v59
  v_exp_f32 v60, v60
  v_mfma_f32_32x32x16_bf16 v[128:143], v[12:15], v[48:51], v[128:143]
  v_exp_f32 v61, v61
  v_exp_f32 v62, v62
  v_exp_f32 v63, v63
  v_cvt_pk_bf16_f32 v56, v56, v57
  v_cvt_pk_bf16_f32 v57, v58, v59
  v_cvt_pk_bf16_f32 v58, v60, v61
  v_cvt_pk_bf16_f32 v59, v62, v63
  v_mfma_f32_32x32x4_2b_bf16 v[80:111], v[10:11], v[36:37], v[80:111]
  ds_read_b128 v[4:7], v44 offset:12288
  v_exp_f32 v64, v64
  v_exp_f32 v65, v65
  v_exp_f32 v66, v66
  v_exp_f32 v67, v67
  ds_read2st64_b64 v[8:11], v39 offset0:24 offset1:25
  v_exp_f32 v68, v68
  v_exp_f32 v69, v69
  v_exp_f32 v70, v70
  v_exp_f32 v71, v71
  v_mfma_f32_32x32x16_bf16 v[128:143], v[16:19], v[56:59], v[128:143]
  v_cvt_pk_bf16_f32 v64, v64, v65
  v_cvt_pk_bf16_f32 v65, v66, v67
  v_cvt_pk_bf16_f32 v66, v68, v69
  v_cvt_pk_bf16_f32 v67, v70, v71
  v_exp_f32 v72, v72
  v_exp_f32 v73, v73
  v_exp_f32 v74, v74
  v_mfma_f32_32x32x16_bf16 v[144:159], v[12:15], v[64:67], v[144:159]
  v_exp_f32 v75, v75
  v_exp_f32 v76, v76
  v_exp_f32 v77, v77
  v_exp_f32 v78, v78
  v_exp_f32 v79, v79
  v_cvt_pk_bf16_f32 v72, v72, v73
  v_cvt_pk_bf16_f32 v73, v74, v75
  v_cvt_pk_bf16_f32 v74, v76, v77
  v_cvt_pk_bf16_f32 v75, v78, v79
  s_waitcnt lgkmcnt(0)
  s_setprio 1
  v_mfma_f32_32x32x16_bf16 v[144:159], v[16:19], v[72:75], v[144:159]
  v_exp_f32 v80, v80
  v_exp_f32 v81, v81
  s_mov_b64 exec, s[66:67]
  ds_read_b128 v[12:15], v40 offset:13824
  ds_read_b128 v[16:19], v40 offset:14464
  s_mov_b64 exec, -1
  v_exp_f32 v82, v82
  v_exp_f32 v83, v83
  v_exp_f32 v84, v84
  v_mfma_f32_32x32x16_bf16 v[48:63], v[4:7], v[28:31], v[112:127]
  v_exp_f32 v85, v85
  v_exp_f32 v86, v86
  v_exp_f32 v87, v87
  v_cvt_pk_bf16_f32 v80, v80, v81
  v_cvt_pk_bf16_f32 v81, v82, v83
  v_cvt_pk_bf16_f32 v82, v84, v85
  v_cvt_pk_bf16_f32 v83, v86, v87
  v_mfma_f32_32x32x16_bf16 v[64:79], v[4:7], v[32:35], v[112:127]
  v_exp_f32 v88, v88
  v_exp_f32 v89, v89
  v_exp_f32 v90, v90
  v_exp_f32 v91, v91
  v_exp_f32 v92, v92
  v_mfma_f32_32x32x16_bf16 v[128:143], v[20:23], v[80:83], v[128:143]
  v_exp_f32 v93, v93
  v_exp_f32 v94, v94
  v_exp_f32 v95, v95
  v_cvt_pk_bf16_f32 v88, v88, v89
  v_cvt_pk_bf16_f32 v89, v90, v91
  v_cvt_pk_bf16_f32 v90, v92, v93
  v_cvt_pk_bf16_f32 v91, v94, v95
  v_mfma_f32_32x32x4_2b_bf16 v[48:79], v[8:9], v[36:37], v[48:79]
  ds_read_b128 v[4:7], v44 offset:12800
  v_exp_f32 v96, v96
  v_exp_f32 v97, v97
  v_exp_f32 v98, v98
  v_exp_f32 v99, v99
  v_exp_f32 v100, v100
  v_exp_f32 v101, v101
  v_exp_f32 v102, v102
  v_exp_f32 v103, v103
  v_mfma_f32_32x32x16_bf16 v[128:143], v[24:27], v[88:91], v[128:143]
  v_cvt_pk_bf16_f32 v96, v96, v97
  v_cvt_pk_bf16_f32 v97, v98, v99
  v_cvt_pk_bf16_f32 v98, v100, v101
  v_cvt_pk_bf16_f32 v99, v102, v103
  v_exp_f32 v104, v104
  v_exp_f32 v105, v105
  v_exp_f32 v106, v106
  v_mfma_f32_32x32x16_bf16 v[144:159], v[20:23], v[96:99], v[144:159]
  v_exp_f32 v107, v107
  v_exp_f32 v108, v108
  v_exp_f32 v109, v109
  v_exp_f32 v110, v110
  v_exp_f32 v111, v111
  v_cvt_pk_bf16_f32 v104, v104, v105
  v_cvt_pk_bf16_f32 v105, v106, v107
  v_cvt_pk_bf16_f32 v106, v108, v109
  v_cvt_pk_bf16_f32 v107, v110, v111
  s_waitcnt lgkmcnt(0)
  s_setprio 0
  v_mfma_f32_32x32x16_bf16 v[144:159], v[24:27], v[104:107], v[144:159]
  v_exp_f32 v48, v48
  v_exp_f32 v49, v49
  s_mov_b64 exec, s[66:67]
  ds_read_b128 v[20:23], v40 offset:15104
  ds_read_b128 v[24:27], v40 offset:15744
  s_mov_b64 exec, -1
  v_exp_f32 v50, v50
  v_exp_f32 v51, v51
  v_exp_f32 v52, v52
  v_mfma_f32_32x32x16_bf16 v[80:95], v[4:7], v[28:31], v[112:127]
  v_exp_f32 v53, v53
  v_exp_f32 v54, v54
  v_exp_f32 v55, v55
  v_cvt_pk_bf16_f32 v48, v48, v49
  v_cvt_pk_bf16_f32 v49, v50, v51
  v_cvt_pk_bf16_f32 v50, v52, v53
  v_cvt_pk_bf16_f32 v51, v54, v55
  v_mfma_f32_32x32x16_bf16 v[96:111], v[4:7], v[32:35], v[112:127]
  v_exp_f32 v56, v56
  v_exp_f32 v57, v57
  v_exp_f32 v58, v58
  v_exp_f32 v59, v59
  v_exp_f32 v60, v60
  v_mfma_f32_32x32x16_bf16 v[128:143], v[12:15], v[48:51], v[128:143]
  v_exp_f32 v61, v61
  v_exp_f32 v62, v62
  v_exp_f32 v63, v63
  v_cvt_pk_bf16_f32 v56, v56, v57
  v_cvt_pk_bf16_f32 v57, v58, v59
  v_cvt_pk_bf16_f32 v58, v60, v61
  v_cvt_pk_bf16_f32 v59, v62, v63
  v_mfma_f32_32x32x4_2b_bf16 v[80:111], v[10:11], v[36:37], v[80:111]
  s_waitcnt vmcnt(0)
  s_barrier
  s_setprio 3
  ds_read_b128 v[4:7], v44 offset:22528
  v_exp_f32 v64, v64
  v_exp_f32 v65, v65
  v_exp_f32 v66, v66
  v_exp_f32 v67, v67
  s_add_u32 m0, s28, 0
  s_nop 0
  buffer_load_dwordx4 v38, s[12:15], s74 offen sc1 lds
  s_add_u32 s74, s74, 163840
  ds_read2st64_b64 v[8:11], v39 offset0:44 offset1:45
  v_exp_f32 v68, v68
  v_exp_f32 v69, v69
  v_exp_f32 v70, v70
  v_exp_f32 v71, v71
  v_mfma_f32_32x32x16_bf16 v[128:143], v[16:19], v[56:59], v[128:143]
  v_cvt_pk_bf16_f32 v64, v64, v65
  v_cvt_pk_bf16_f32 v65, v66, v67
  v_cvt_pk_bf16_f32 v66, v68, v69
  v_cvt_pk_bf16_f32 v67, v70, v71
  s_add_u32 m0, s28, 4096
  s_nop 0
  buffer_load_dwordx4 v38, s[12:15], s75 offen sc1 lds
  s_add_u32 s75, s75, s77
  v_exp_f32 v72, v72
  v_exp_f32 v73, v73
  v_exp_f32 v74, v74
  v_mfma_f32_32x32x16_bf16 v[144:159], v[12:15], v[64:67], v[144:159]
  v_exp_f32 v75, v75
  v_exp_f32 v76, v76
  v_exp_f32 v77, v77
  s_add_u32 m0, s28, 8192
  s_cmp_eq_u32 s22, 3
  s_cbranch_scc1 L_at_d7
  buffer_load_dwordx4 v38, s[12:15], s76 offen sc1 lds
  s_add_u32 s76, s76, 5120
L_at_d7:
  v_exp_f32 v78, v78
  v_exp_f32 v79, v79
  v_cvt_pk_bf16_f32 v72, v72, v73
  v_cvt_pk_bf16_f32 v73, v74, v75
  v_cvt_pk_bf16_f32 v74, v76, v77
  v_cvt_pk_bf16_f32 v75, v78, v79
  s_waitcnt lgkmcnt(0)
  s_nop 0
  v_mfma_f32_32x32x16_bf16 v[144:159], v[16:19], v[72:75], v[144:159]
  v_exp_f32 v80, v80
  v_exp_f32 v81, v81
  s_mov_b64 exec, s[66:67]
  ds_read_b128 v[12:15], v40 offset:22528
  ds_read_b128 v[16:19], v40 offset:23168
  s_mov_b64 exec, -1
  v_exp_f32 v82, v82
  v_exp_f32 v83, v83
  v_exp_f32 v84, v84
  v_mfma_f32_32x32x16_bf16 v[48:63], v[4:7], v[28:31], v[112:127]
  v_exp_f32 v85, v85
  v_exp_f32 v86, v86
  v_exp_f32 v87, v87
  v_cvt_pk_bf16_f32 v80, v80, v81
  v_cvt_pk_bf16_f32 v81, v82, v83
  v_cvt_pk_bf16_f32 v82, v84, v85
  v_cvt_pk_bf16_f32 v83, v86, v87
  v_mfma_f32_32x32x16_bf16 v[64:79], v[4:7], v[32:35], v[112:127]
  v_exp_f32 v88, v88
  v_exp_f32 v89, v89
  v_exp_f32 v90, v90
  v_exp_f32 v91, v91
  v_exp_f32 v92, v92
  v_mfma_f32_32x32x16_bf16 v[128:143], v[20:23], v[80:83], v[128:143]
  v_exp_f32 v93, v93
  v_exp_f32 v94, v94
  v_exp_f32 v95, v95
  v_cvt_pk_bf16_f32 v88, v88, v89
  v_cvt_pk_bf16_f32 v89, v90, v91
  v_cvt_pk_bf16_f32 v90, v92, v93
  v_cvt_pk_bf16_f32 v91, v94, v95
  v_mfma_f32_32x32x4_2b_bf16 v[48:79], v[8:9], v[36:37], v[48:79]
  ds_read_b128 v[4:7], v44 offset:23040
  s_cmp_eq_u32 s10, 0
  s_cbranch_scc1 L_hk1
L_rs_chk:
  v_max_u32 v250, v160, v161
  v_max3_u32 v250, v250, v162, v163
  v_max3_u32 v250, v250, v164, v165
  v_max3_u32 v250, v250, v166, v167
  v_max3_u32 v250, v250, v244, v245
  v_max3_u32 v250, v250, v246, v247
  v_max3_u32 v250, v250, v248, v249
  v_cmp_eq_u32 vcc, -1, v250
  s_nop 1
  s_cbranch_vccz L_rs_go
  s_sleep 4
  s_cmp_le_u32 s8, 0
  s_cbranch_scc1 L_el1
  s_mov_b32 s25, 15728640
  buffer_load_dwordx2 v[160:161], v242, s[12:15], s25 offen sc1
  s_cmp_le_u32 s8, 1
  s_cbranch_scc1 L_el1
  s_mov_b32 s25, 15733760
  buffer_load_dwordx2 v[162:163], v242, s[12:15], s25 offen sc1
  s_cmp_le_u32 s8, 2
  s_cbranch_scc1 L_el1
  s_mov_b32 s25, 15738880
  buffer_load_dwordx2 v[164:165], v242, s[12:15], s25 offen sc1
  s_cmp_le_u32 s8, 3
  s_cbranch_scc1 L_el1
  s_mov_b32 s25, 15744000
  buffer_load_dwordx2 v[166:167], v242, s[12:15], s25 offen sc1
  s_cmp_le_u32 s8, 4
  s_cbranch_scc1 L_el1
  s_mov_b32 s25, 15749120
  buffer_load_dwordx2 v[244:245], v242, s[12:15], s25 offen sc1
  s_cmp_le_u32 s8, 5
  s_cbranch_scc1 L_el1
  s_mov_b32 s25, 15754240
  buffer_load_dwordx2 v[246:247], v242, s[12:15], s25 offen sc1
  s_cmp_le_u32 s8, 6
  s_cbranch_scc1 L_el1
  s_mov_b32 s25, 15759360
  buffer_load_dwordx2 v[248:249], v242, s[12:15], s25 offen sc1
L_el1:
  s_waitcnt vmcnt(0)
  s_branch L_rs_chk
L_rs_go:
  v_mov_b32 v252, 0
  v_mov_b32 v253, 0
  s_cmp_le_u32 s8, 0
  s_cbranch_scc1 L_rs_carry
  v_fma_f32 v250, v252, v236, v160
  v_fma_f32 v250, -v253, v237, v250
  v_fma_f32 v251, v252, v237, v161
  v_fma_f32 v253, v253, v236, v251
  v_mov_b32 v252, v250
  s_cmp_le_u32 s8, 1
  s_cbranch_scc1 L_rs_carry
  v_fma_f32 v250, v252, v236, v162
  v_fma_f32 v250, -v253, v237, v250
  v_fma_f32 v251, v252, v237, v163
  v_fma_f32 v253, v253, v236, v251
  v_mov_b32 v252, v250
  s_cmp_le_u32 s8, 2
  s_cbranch_scc1 L_rs_carry
  v_fma_f32 v250, v252, v236, v164
  v_fma_f32 v250, -v253, v237, v250
  v_fma_f32 v251, v252, v237, v165
  v_fma_f32 v253, v253, v236, v251
  v_mov_b32 v252, v250
  s_cmp_le_u32 s8, 3
  s_cbranch_scc1 L_rs_carry
  v_fma_f32 v250, v252, v236, v166
  v_fma_f32 v250, -v253, v237, v250
  v_fma_f32 v251, v252, v237, v167
  v_fma_f32 v253, v253, v236, v251
  v_mov_b32 v252, v250
  s_cmp_le_u32 s8, 4
  s_cbranch_scc1 L_rs_carry
  v_fma_f32 v250, v252, v236, v244
  v_fma_f32 v250, -v253, v237, v250
  v_fma_f32 v251, v252, v237, v245
  v_fma_f32 v253, v253, v236, v251
  v_mov_b32 v252, v250
  s_cmp_le_u32 s8, 5
  s_cbranch_scc1 L_rs_carry
  v_fma_f32 v250, v252, v236, v246
  v_fma_f32 v250, -v253, v237, v250
  v_fma_f32 v251, v252, v237, v247
  v_fma_f32 v253, v253, v236, v251
  v_mov_b32 v252, v250
  s_cmp_le_u32 s8, 6
  s_cbranch_scc1 L_rs_carry
  v_fma_f32 v250, v252, v236, v248
  v_fma_f32 v250, -v253, v237, v250
  v_fma_f32 v251, v252, v237, v249
  v_fma_f32 v253, v253, v236, v251
  v_mov_b32 v252, v250
L_rs_carry:
  v_fma_f32 v250, v252, v240, v238
  v_fma_f32 v250, -v253, v241, v250
  v_fma_f32 v251, v252, v241, v239
  v_fma_f32 v253, v253, v240, v251
  v_mov_b32 v252, v250
  v_mov_b32 v164, v234
  v_mov_b32 v165, v234
  v_mov_b32 v166, v235
  v_mov_b32 v167, v235
  v_fma_f32 v168, v232, v252, v168
  v_fma_f32 v184, v232, v253, v184
  v_fma_f32 v168, -v233, v253, v168
  v_fma_f32 v184, v233, v252, v184
  v_fma_f32 v169, v232, v168, v169
  v_fma_f32 v185, v232, v184, v185
  v_fma_f32 v169, -v233, v184, v169
  v_fma_f32 v185, v233, v168, v185
  v_cvt_pk_bf16_f32 v168, v168, v169
  v_cvt_pk_bf16_f32 v184, -v184, -v185
  v_fma_f32 v170, v232, v169, v170
  v_fma_f32 v186, v232, v185, v186
  v_fma_f32 v170, -v233, v185, v170
  v_fma_f32 v186, v233, v169, v186
  v_fma_f32 v171, v232, v170, v171
  v_fma_f32 v187, v232, v186, v187
  v_fma_f32 v171, -v233, v186, v171
  v_fma_f32 v187, v233, v170, v187
  v_cvt_pk_bf16_f32 v169, v170, v171
  v_cvt_pk_bf16_f32 v185, -v186, -v187
  v_fma_f32 v172, v232, v171, v172
  v_fma_f32 v188, v232, v187, v188
  v_fma_f32 v172, -v233, v187, v172
  v_fma_f32 v188, v233, v171, v188
  v_fma_f32 v173, v232, v172, v173
  v_fma_f32 v189, v232, v188, v189
  v_fma_f32 v173, -v233, v188, v173
  v_fma_f32 v189, v233, v172, v189
  v_cvt_pk_bf16_f32 v170, v172, v173
  v_cvt_pk_bf16_f32 v186, -v188, -v189
  v_fma_f32 v174, v232, v173, v174
  v_fma_f32 v190, v232, v189, v190
  v_fma_f32 v174, -v233, v189, v174
  v_fma_f32 v190, v233, v173, v190
  v_fma_f32 v175, v232, v174, v175
  v_fma_f32 v191, v232, v190, v191
  v_fma_f32 v175, -v233, v190, v175
  v_fma_f32 v191, v233, v174, v191
  v_cvt_pk_bf16_f32 v171, v174, v175
  v_cvt_pk_bf16_f32 v187, -v190, -v191
  v_xor_b32 v250, 0, v243
  s_add_u32 s25, s11, 0
  s_add_u32 s26, s11, 10240
  buffer_store_dwordx4 v[168:171], v250, s[12:15], s25 offen sc1
  buffer_store_dwordx4 v[184:187], v250, s[12:15], s26 offen sc1
  v_fma_f32 v176, v232, v175, v176
  v_fma_f32 v192, v232, v191, v192
  v_fma_f32 v176, -v233, v191, v176
  v_fma_f32 v192, v233, v175, v192
  v_fma_f32 v177, v232, v176, v177
  v_fma_f32 v193, v232, v192, v193
  v_fma_f32 v177, -v233, v192, v177
  v_fma_f32 v193, v233, v176, v193
  v_cvt_pk_bf16_f32 v176, v176, v177
  v_cvt_pk_bf16_f32 v192, -v192, -v193
  v_fma_f32 v178, v232, v177, v178
  v_fma_f32 v194, v232, v193, v194
  v_fma_f32 v178, -v233, v193, v178
  v_fma_f32 v194, v233, v177, v194
  v_fma_f32 v179, v232, v178, v179
  v_fma_f32 v195, v232, v194, v195
  v_fma_f32 v179, -v233, v194, v179
  v_fma_f32 v195, v233, v178, v195
  v_cvt_pk_bf16_f32 v177, v178, v179
  v_cvt_pk_bf16_f32 v193, -v194, -v195
  v_fma_f32 v180, v232, v179, v180
  v_fma_f32 v196, v232, v195, v196
  v_fma_f32 v180, -v233, v195, v180
  v_fma_f32 v196, v233, v179, v196
  v_fma_f32 v181, v232, v180, v181
  v_fma_f32 v197, v232, v196, v197
  v_fma_f32 v181, -v233, v196, v181
  v_fma_f32 v197, v233, v180, v197
  v_cvt_pk_bf16_f32 v178, v180, v181
  v_cvt_pk_bf16_f32 v194, -v196, -v197
  v_fma_f32 v182, v232, v181, v182
  v_fma_f32 v198, v232, v197, v198
  v_fma_f32 v182, -v233, v197, v182
  v_fma_f32 v198, v233, v181, v198
  v_fma_f32 v183, v232, v182, v183
  v_fma_f32 v199, v232, v198, v199
  v_fma_f32 v183, -v233, v198, v183
  v_fma_f32 v199, v233, v182, v199
  v_cvt_pk_bf16_f32 v179, v182, v183
  v_cvt_pk_bf16_f32 v195, -v198, -v199
  v_xor_b32 v250, 64, v243
  s_add_u32 s25, s11, 20480
  s_add_u32 s26, s11, 30720
  buffer_store_dwordx4 v[176:179], v250, s[12:15], s25 offen sc1
  buffer_store_dwordx4 v[192:195], v250, s[12:15], s26 offen sc1
  v_fma_f32 v200, v232, v183, v200
  v_fma_f32 v216, v232, v199, v216
  v_fma_f32 v200, -v233, v199, v200
  v_fma_f32 v216, v233, v183, v216
  v_fma_f32 v201, v232, v200, v201
  v_fma_f32 v217, v232, v216, v217
  v_fma_f32 v201, -v233, v216, v201
  v_fma_f32 v217, v233, v200, v217
  v_cvt_pk_bf16_f32 v200, v200, v201
  v_cvt_pk_bf16_f32 v216, -v216, -v217
  v_fma_f32 v202, v232, v201, v202
  v_fma_f32 v218, v232, v217, v218
  v_fma_f32 v202, -v233, v217, v202
  v_fma_f32 v218, v233, v201, v218
  v_fma_f32 v203, v232, v202, v203
  v_fma_f32 v219, v232, v218, v219
  v_fma_f32 v203, -v233, v218, v203
  v_fma_f32 v219, v233, v202, v219
  v_cvt_pk_bf16_f32 v201, v202, v203
  v_cvt_pk_bf16_f32 v217, -v218, -v219
  v_fma_f32 v204, v232, v203, v204
  v_fma_f32 v220, v232, v219, v220
  v_fma_f32 v204, -v233, v219, v204
  v_fma_f32 v220, v233, v203, v220
  v_fma_f32 v205, v232, v204, v205
  v_fma_f32 v221, v232, v220, v221
  v_fma_f32 v205, -v233, v220, v205
  v_fma_f32 v221, v233, v204, v221
  v_cvt_pk_bf16_f32 v202, v204, v205
  v_cvt_pk_bf16_f32 v218, -v220, -v221
  v_fma_f32 v206, v232, v205, v206
  v_fma_f32 v222, v232, v221, v222
  v_fma_f32 v206, -v233, v221, v206
  v_fma_f32 v222, v233, v205, v222
  v_fma_f32 v207, v232, v206, v207
  v_fma_f32 v223, v232, v222, v223
  v_fma_f32 v207, -v233, v222, v207
  v_fma_f32 v223, v233, v206, v223
  v_cvt_pk_bf16_f32 v203, v206, v207
  v_cvt_pk_bf16_f32 v219, -v222, -v223
  v_xor_b32 v250, 128, v243
  s_add_u32 s25, s11, 40960
  s_add_u32 s26, s11, 51200
  buffer_store_dwordx4 v[200:203], v250, s[12:15], s25 offen sc1
  buffer_store_dwordx4 v[216:219], v250, s[12:15], s26 offen sc1
  v_fma_f32 v208, v232, v207, v208
  v_fma_f32 v224, v232, v223, v224
  v_fma_f32 v208, -v233, v223, v208
  v_fma_f32 v224, v233, v207, v224
  v_fma_f32 v209, v232, v208, v209
  v_fma_f32 v225, v232, v224, v225
  v_fma_f32 v209, -v233, v224, v209
  v_fma_f32 v225, v233, v208, v225
  v_cvt_pk_bf16_f32 v208, v208, v209
  v_cvt_pk_bf16_f32 v224, -v224, -v225
  v_fma_f32 v210, v232, v209, v210
  v_fma_f32 v226, v232, v225, v226
  v_fma_f32 v210, -v233, v225, v210
  v_fma_f32 v226, v233, v209, v226
  v_fma_f32 v211, v232, v210, v211
  v_fma_f32 v227, v232, v226, v227
  v_fma_f32 v211, -v233, v226, v211
  v_fma_f32 v227, v233, v210, v227
  v_cvt_pk_bf16_f32 v209, v210, v211
  v_cvt_pk_bf16_f32 v225, -v226, -v227
  v_fma_f32 v212, v232, v211, v212
  v_fma_f32 v228, v232, v227, v228
  v_fma_f32 v212, -v233, v227, v212
  v_fma_f32 v228, v233, v211, v228
  v_fma_f32 v213, v232, v212, v213
  v_fma_f32 v229, v232, v228, v229
  v_fma_f32 v213, -v233, v228, v213
  v_fma_f32 v229, v233, v212, v229
  v_cvt_pk_bf16_f32 v210, v212, v213
  v_cvt_pk_bf16_f32 v226, -v228, -v229
  v_fma_f32 v214, v232, v213, v214
  v_fma_f32 v230, v232, v229, v230
  v_fma_f32 v214, -v233, v229, v214
  v_fma_f32 v230, v233, v213, v230
  v_fma_f32 v215, v232, v214, v215
  v_fma_f32 v231, v232, v230, v231
  v_fma_f32 v215, -v233, v230, v215
  v_fma_f32 v231, v233, v214, v231
  v_cvt_pk_bf16_f32 v211, v214, v215
  v_cvt_pk_bf16_f32 v227, -v230, -v231
  v_xor_b32 v250, 192, v243
  s_add_u32 s25, s11, 61440
  s_add_u32 s26, s11, 71680
  buffer_store_dwordx4 v[208:211], v250, s[12:15], s25 offen sc1
  buffer_store_dwordx4 v[224:227], v250, s[12:15], s26 offen sc1
L_hk1:
  v_exp_f32 v96, v96
  v_exp_f32 v97, v97
  v_exp_f32 v98, v98
  v_exp_f32 v99, v99
  v_exp_f32 v100, v100
  v_exp_f32 v101, v101
  v_exp_f32 v102, v102
  v_exp_f32 v103, v103
  v_mfma_f32_32x32x16_bf16 v[128:143], v[24:27], v[88:91], v[128:143]
  v_cvt_pk_bf16_f32 v96, v96, v97
  v_cvt_pk_bf16_f32 v97, v98, v99
  v_cvt_pk_bf16_f32 v98, v100, v101
  v_cvt_pk_bf16_f32 v99, v102, v103
  v_exp_f32 v104, v104
  v_exp_f32 v105, v105
  v_exp_f32 v106, v106
  v_mfma_f32_32x32x16_bf16 v[144:159], v[20:23], v[96:99], v[144:159]
  v_exp_f32 v107, v107
  v_exp_f32 v108, v108
  v_exp_f32 v109, v109
  v_exp_f32 v110, v110
  v_exp_f32 v111, v111
  v_cvt_pk_bf16_f32 v104, v104, v105
  v_cvt_pk_bf16_f32 v105, v106, v107
  v_cvt_pk_bf16_f32 v106, v108, v109
  v_cvt_pk_bf16_f32 v107, v110, v111
  s_waitcnt lgkmcnt(0)
  s_setprio 2
  v_mfma_f32_32x32x16_bf16 v[144:159], v[24:27], v[104:107], v[144:159]
  v_exp_f32 v48, v48
  v_exp_f32 v49, v49
  s_mov_b64 exec, s[66:67]
  ds_read_b128 v[20:23], v40 offset:23808
  ds_read_b128 v[24:27], v40 offset:24448
  s_mov_b64 exec, -1
  v_exp_f32 v50, v50
  v_exp_f32 v51, v51
  v_exp_f32 v52, v52
  v_mfma_f32_32x32x16_bf16 v[80:95], v[4:7], v[28:31], v[112:127]
  v_exp_f32 v53, v53
  v_exp_f32 v54, v54
  v_exp_f32 v55, v55
  v_cvt_pk_bf16_f32 v48, v48, v49
  v_cvt_pk_bf16_f32 v49, v50, v51
  v_cvt_pk_bf16_f32 v50, v52, v53
  v_cvt_pk_bf16_f32 v51, v54, v55
  v_mfma_f32_32x32x16_bf16 v[96:111], v[4:7], v[32:35], v[112:127]
  v_exp_f32 v56, v56
  v_exp_f32 v57, v57
  v_exp_f32 v58, v58
  v_exp_f32 v59, v59
  v_exp_f32 v60, v60
  v_mfma_f32_32x32x16_bf16 v[128:143], v[12:15], v[48:51], v[128:143]
  v_exp_f32 v61, v61
  v_exp_f32 v62, v62
  v_exp_f32 v63, v63
  v_cvt_pk_bf16_f32 v56, v56, v57
  v_cvt_pk_bf16_f32 v57, v58, v59
  v_cvt_pk_bf16_f32 v58, v60, v61
  v_cvt_pk_bf16_f32 v59, v62, v63
  v_mfma_f32_32x32x4_2b_bf16 v[80:111], v[10:11], v[36:37], v[80:111]
  ds_read_b128 v[4:7], v44 offset:23552
  v_exp_f32 v64, v64
  v_exp_f32 v65, v65
  v_exp_f32 v66, v66
  v_exp_f32 v67, v67
  ds_read2st64_b64 v[8:11], v39 offset0:46 offset1:47
  v_exp_f32 v68, v68
  v_exp_f32 v69, v69
  v_exp_f32 v70, v70
  v_exp_f32 v71, v71
  v_mfma_f32_32x32x16_bf16 v[128:143], v[16:19], v[56:59], v[128:143]
  v_cvt_pk_bf16_f32 v64, v64, v65
  v_cvt_pk_bf16_f32 v65, v66, v67
  v_cvt_pk_bf16_f32 v66, v68, v69
  v_cvt_pk_bf16_f32 v67, v70, v71
  v_exp_f32 v72, v72
  v_exp_f32 v73, v73
  v_exp_f32 v74, v74
  v_mfma_f32_32x32x16_bf16 v[144:159], v[12:15], v[64:67], v[144:159]
  v_exp_f32 v75, v75
  v_exp_f32 v76, v76
  v_exp_f32 v77, v77
  v_exp_f32 v78, v78
  v_exp_f32 v79, v79
  v_cvt_pk_bf16_f32 v72, v72, v73
  v_cvt_pk_bf16_f32 v73, v74, v75
  v_cvt_pk_bf16_f32 v74, v76, v77
  v_cvt_pk_bf16_f32 v75, v78, v79
  s_waitcnt lgkmcnt(0)
  s_setprio 1
  v_mfma_f32_32x32x16_bf16 v[144:159], v[16:19], v[72:75], v[144:159]
  v_exp_f32 v80, v80
  v_exp_f32 v81, v81
  s_mov_b64 exec, s[66:67]
  ds_read_b128 v[12:15], v40 offset:25088
  ds_read_b128 v[16:19], v40 offset:25728
  s_mov_b64 exec, -1
  v_exp_f32 v82, v82
  v_exp_f32 v83, v83
  v_exp_f32 v84, v84
  v_mfma_f32_32x32x16_bf16 v[48:63], v[4:7], v[28:31], v[112:127]
  v_exp_f32 v85, v85
  v_exp_f32 v86, v86
  v_exp_f32 v87, v87
  v_cvt_pk_bf16_f32 v80, v80, v81
  v_cvt_pk_bf16_f32 v81, v82, v83
  v_cvt_pk_bf16_f32 v82, v84, v85
  v_cvt_pk_bf16_f32 v83, v86, v87
  v_mfma_f32_32x32x16_bf16 v[64:79], v[4:7], v[32:35], v[112:127]
  v_exp_f32 v88, v88
  v_exp_f32 v89, v89
  v_exp_f32 v90, v90
  v_exp_f32 v91, v91
  v_exp_f32 v92, v92
  v_mfma_f32_32x32x16_bf16 v[128:143], v[20:23], v[80:83], v[128:143]
  v_exp_f32 v93, v93
  v_exp_f32 v94, v94
  v_exp_f32 v95, v95
  v_cvt_pk_bf16_f32 v88, v88, v89
  v_cvt_pk_bf16_f32 v89, v90, v91
  v_cvt_pk_bf16_f32 v90, v92, v93
  v_cvt_pk_bf16_f32 v91, v94, v95
  v_mfma_f32_32x32x4_2b_bf16 v[48:79], v[8:9], v[36:37], v[48:79]
  ds_read_b128 v[4:7], v44 offset:24064
  v_exp_f32 v96, v96
  v_exp_f32 v97, v97
  v_exp_f32 v98, v98
  v_exp_f32 v99, v99
  v_exp_f32 v100, v100
  v_exp_f32 v101, v101
  v_exp_f32 v102, v102
  v_exp_f32 v103, v103
  v_mfma_f32_32x32x16_bf16 v[128:143], v[24:27], v[88:91], v[128:143]
  v_cvt_pk_bf16_f32 v96, v96, v97
  v_cvt_pk_bf16_f32 v97, v98, v99
  v_cvt_pk_bf16_f32 v98, v100, v101
  v_cvt_pk_bf16_f32 v99, v102, v103
  v_exp_f32 v104, v104
  v_exp_f32 v105, v105
  v_exp_f32 v106, v106
  v_mfma_f32_32x32x16_bf16 v[144:159], v[20:23], v[96:99], v[144:159]
  v_exp_f32 v107, v107
  v_exp_f32 v108, v108
  v_exp_f32 v109, v109
  v_exp_f32 v110, v110
  v_exp_f32 v111, v111
  v_cvt_pk_bf16_f32 v104, v104, v105
  v_cvt_pk_bf16_f32 v105, v106, v107
  v_cvt_pk_bf16_f32 v106, v108, v109
  v_cvt_pk_bf16_f32 v107, v110, v111
  s_waitcnt lgkmcnt(0)
  s_setprio 0
  v_mfma_f32_32x32x16_bf16 v[144:159], v[24:27], v[104:107], v[144:159]
  v_exp_f32 v48, v48
  v_exp_f32 v49, v49
  s_mov_b64 exec, s[66:67]
  ds_read_b128 v[20:23], v40 offset:26368
  ds_read_b128 v[24:27], v40 offset:27008
  s_mov_b64 exec, -1
  v_exp_f32 v50, v50
  v_exp_f32 v51, v51
  v_exp_f32 v52, v52
  v_mfma_f32_32x32x16_bf16 v[80:95], v[4:7], v[28:31], v[112:127]
  v_exp_f32 v53, v53
  v_exp_f32 v54, v54
  v_exp_f32 v55, v55
  v_cvt_pk_bf16_f32 v48, v48, v49
  v_cvt_pk_bf16_f32 v49, v50, v51
  v_cvt_pk_bf16_f32 v50, v52, v53
  v_cvt_pk_bf16_f32 v51, v54, v55
  v_mfma_f32_32x32x16_bf16 v[96:111], v[4:7], v[32:35], v[112:127]
  v_exp_f32 v56, v56
  v_exp_f32 v57, v57
  v_exp_f32 v58, v58
  v_exp_f32 v59, v59
  v_exp_f32 v60, v60
  v_mfma_f32_32x32x16_bf16 v[128:143], v[12:15], v[48:51], v[128:143]
  v_exp_f32 v61, v61
  v_exp_f32 v62, v62
  v_exp_f32 v63, v63
  v_cvt_pk_bf16_f32 v56, v56, v57
  v_cvt_pk_bf16_f32 v57, v58, v59
  v_cvt_pk_bf16_f32 v58, v60, v61
  v_cvt_pk_bf16_f32 v59, v62, v63
  v_mfma_f32_32x32x4_2b_bf16 v[80:111], v[10:11], v[36:37], v[80:111]
  s_waitcnt vmcnt(0)
  s_barrier
  s_setprio 3
  ds_read_b128 v[4:7], v44 offset:0
  v_exp_f32 v64, v64
  v_exp_f32 v65, v65
  v_exp_f32 v66, v66
  v_exp_f32 v67, v67
  s_add_u32 m0, s28, 11264
  s_nop 0
  buffer_load_dwordx4 v38, s[12:15], s74 offen sc1 lds
  s_add_u32 s74, s74, 163840
  ds_read2st64_b64 v[8:11], v39 offset0:0 offset1:1
  v_exp_f32 v68, v68
  v_exp_f32 v69, v69
  v_exp_f32 v70, v70
  v_exp_f32 v71, v71
  v_mfma_f32_32x32x16_bf16 v[128:143], v[16:19], v[56:59], v[128:143]
  v_cvt_pk_bf16_f32 v64, v64, v65
  v_cvt_pk_bf16_f32 v65, v66, v67
  v_cvt_pk_bf16_f32 v66, v68, v69
  v_cvt_pk_bf16_f32 v67, v70, v71
  s_add_u32 m0, s28, 15360
  s_nop 0
  buffer_load_dwordx4 v38, s[12:15], s75 offen sc1 lds
  s_add_u32 s75, s75, s77
  v_exp_f32 v72, v72
  v_exp_f32 v73, v73
  v_exp_f32 v74, v74
  v_mfma_f32_32x32x16_bf16 v[144:159], v[12:15], v[64:67], v[144:159]
  v_exp_f32 v75, v75
  v_exp_f32 v76, v76
  v_exp_f32 v77, v77
  s_add_u32 m0, s28, 19456
  s_cmp_eq_u32 s22, 3
  s_cbranch_scc1 L_at_d10
  buffer_load_dwordx4 v38, s[12:15], s76 offen sc1 lds
  s_add_u32 s76, s76, 5120
L_at_d10:
  v_exp_f32 v78, v78
  v_exp_f32 v79, v79
  v_cvt_pk_bf16_f32 v72, v72, v73
  v_cvt_pk_bf16_f32 v73, v74, v75
  v_cvt_pk_bf16_f32 v74, v76, v77
  v_cvt_pk_bf16_f32 v75, v78, v79
  s_waitcnt lgkmcnt(0)
  s_nop 0
  v_mfma_f32_32x32x16_bf16 v[144:159], v[16:19], v[72:75], v[144:159]
  v_exp_f32 v80, v80
  v_exp_f32 v81, v81
  s_mov_b64 exec, s[66:67]
  ds_read_b128 v[12:15], v40 offset:0
  ds_read_b128 v[16:19], v40 offset:640
  s_mov_b64 exec, -1
  v_exp_f32 v82, v82
  v_exp_f32 v83, v83
  v_exp_f32 v84, v84
  v_mfma_f32_32x32x16_bf16 v[48:63], v[4:7], v[28:31], v[112:127]
  v_exp_f32 v85, v85
  v_exp_f32 v86, v86
  v_exp_f32 v87, v87
  v_cvt_pk_bf16_f32 v80, v80, v81
  v_cvt_pk_bf16_f32 v81, v82, v83
  v_cvt_pk_bf16_f32 v82, v84, v85
  v_cvt_pk_bf16_f32 v83, v86, v87
  v_mfma_f32_32x32x16_bf16 v[64:79], v[4:7], v[32:35], v[112:127]
  v_exp_f32 v88, v88
  v_exp_f32 v89, v89
  v_exp_f32 v90, v90
  v_exp_f32 v91, v91
  v_exp_f32 v92, v92
  v_mfma_f32_32x32x16_bf16 v[128:143], v[20:23], v[80:83], v[128:143]
  v_exp_f32 v93, v93
  v_exp_f32 v94, v94
  v_exp_f32 v95, v95
  v_cvt_pk_bf16_f32 v88, v88, v89
  v_cvt_pk_bf16_f32 v89, v90, v91
  v_cvt_pk_bf16_f32 v90, v92, v93
  v_cvt_pk_bf16_f32 v91, v94, v95
  v_mfma_f32_32x32x4_2b_bf16 v[48:79], v[8:9], v[36:37], v[48:79]
  ds_read_b128 v[4:7], v44 offset:512
  s_cmp_eq_u32 s10, 0
  s_cbranch_scc1 L_hk2
  s_cmp_lg_u32 s20, 0
  s_cbranch_scc1 L_hk2
  s_lshl_b32 s26, s8, 7
  s_lshl_b32 s25, s9, 2
  s_add_u32 s26, s26, s25
  s_add_u32 s26, s26, 15790080
  v_mov_b32 v250, 0
  s_mov_b64 exec, 1
  buffer_store_dword v250, v250, s[12:15], s26 offen sc1
  s_mov_b64 exec, -1
L_hk2:
  v_exp_f32 v96, v96
  v_exp_f32 v97, v97
  v_exp_f32 v98, v98
  v_exp_f32 v99, v99
  v_exp_f32 v100, v100
  v_exp_f32 v101, v101
  v_exp_f32 v102, v102
  v_exp_f32 v103, v103
  v_mfma_f32_32x32x16_bf16 v[128:143], v[24:27], v[88:91], v[128:143]
  v_cvt_pk_bf16_f32 v96, v96, v97
  v_cvt_pk_bf16_f32 v97, v98, v99
  v_cvt_pk_bf16_f32 v98, v100, v101
  v_cvt_pk_bf16_f32 v99, v102, v103
  v_exp_f32 v104, v104
  v_exp_f32 v105, v105
  v_exp_f32 v106, v106
  v_mfma_f32_32x32x16_bf16 v[144:159], v[20:23], v[96:99], v[144:159]
  v_exp_f32 v107, v107
  v_exp_f32 v108, v108
  v_exp_f32 v109, v109
  v_exp_f32 v110, v110
  v_exp_f32 v111, v111
  v_cvt_pk_bf16_f32 v104, v104, v105
  v_cvt_pk_bf16_f32 v105, v106, v107
  v_cvt_pk_bf16_f32 v106, v108, v109
  v_cvt_pk_bf16_f32 v107, v110, v111
  s_waitcnt lgkmcnt(0)
  s_setprio 2
  v_mfma_f32_32x32x16_bf16 v[144:159], v[24:27], v[104:107], v[144:159]
  v_exp_f32 v48, v48
  v_exp_f32 v49, v49
  s_mov_b64 exec, s[66:67]
  ds_read_b128 v[20:23], v40 offset:1280
  ds_read_b128 v[24:27], v40 offset:1920
  s_mov_b64 exec, -1
  v_exp_f32 v50, v50
  v_exp_f32 v51, v51
  v_exp_f32 v52, v52
  v_mfma_f32_32x32x16_bf16 v[80:95], v[4:7], v[28:31], v[112:127]
  v_exp_f32 v53, v53
  v_exp_f32 v54, v54
  v_exp_f32 v55, v55
  v_cvt_pk_bf16_f32 v48, v48, v49
  v_cvt_pk_bf16_f32 v49, v50, v51
  v_cvt_pk_bf16_f32 v50, v52, v53
  v_cvt_pk_bf16_f32 v51, v54, v55
  v_mfma_f32_32x32x16_bf16 v[96:111], v[4:7], v[32:35], v[112:127]
  v_exp_f32 v56, v56
  v_exp_f32 v57, v57
  v_exp_f32 v58, v58
  v_exp_f32 v59, v59
  v_exp_f32 v60, v60
  v_mfma_f32_32x32x16_bf16 v[128:143], v[12:15], v[48:51], v[128:143]
  v_exp_f32 v61, v61
  v_exp_f32 v62, v62
  v_exp_f32 v63, v63
  v_cvt_pk_bf16_f32 v56, v56, v57
  v_cvt_pk_bf16_f32 v57, v58, v59
  v_cvt_pk_bf16_f32 v58, v60, v61
  v_cvt_pk_bf16_f32 v59, v62, v63
  v_mfma_f32_32x32x4_2b_bf16 v[80:111], v[10:11], v[36:37], v[80:111]
  ds_read_b128 v[4:7], v44 offset:1024
  v_exp_f32 v64, v64
  v_exp_f32 v65, v65
  v_exp_f32 v66, v66
  v_exp_f32 v67, v67
  ds_read2st64_b64 v[8:11], v39 offset0:2 offset1:3
  v_exp_f32 v68, v68
  v_exp_f32 v69, v69
  v_exp_f32 v70, v70
  v_exp_f32 v71, v71
  v_mfma_f32_32x32x16_bf16 v[128:143], v[16:19], v[56:59], v[128:143]
  v_cvt_pk_bf16_f32 v64, v64, v65
  v_cvt_pk_bf16_f32 v65, v66, v67
  v_cvt_pk_bf16_f32 v66, v68, v69
  v_cvt_pk_bf16_f32 v67, v70, v71
  v_exp_f32 v72, v72
  v_exp_f32 v73, v73
  v_exp_f32 v74, v74
  v_mfma_f32_32x32x16_bf16 v[144:159], v[12:15], v[64:67], v[144:159]
  v_exp_f32 v75, v75
  v_exp_f32 v76, v76
  v_exp_f32 v77, v77
  v_exp_f32 v78, v78
  v_exp_f32 v79, v79
  v_cvt_pk_bf16_f32 v72, v72, v73
  v_cvt_pk_bf16_f32 v73, v74, v75
  v_cvt_pk_bf16_f32 v74, v76, v77
  v_cvt_pk_bf16_f32 v75, v78, v79
  s_waitcnt lgkmcnt(0)
  s_setprio 1
  v_mfma_f32_32x32x16_bf16 v[144:159], v[16:19], v[72:75], v[144:159]
  v_exp_f32 v80, v80
  v_exp_f32 v81, v81
  s_mov_b64 exec, s[66:67]
  ds_read_b128 v[12:15], v40 offset:2560
  ds_read_b128 v[16:19], v40 offset:3200
  s_mov_b64 exec, -1
  v_exp_f32 v82, v82
  v_exp_f32 v83, v83
  v_exp_f32 v84, v84
  v_mfma_f32_32x32x16_bf16 v[48:63], v[4:7], v[28:31], v[112:127]
  v_exp_f32 v85, v85
  v_exp_f32 v86, v86
  v_exp_f32 v87, v87
  v_cvt_pk_bf16_f32 v80, v80, v81
  v_cvt_pk_bf16_f32 v81, v82, v83
  v_cvt_pk_bf16_f32 v82, v84, v85
  v_cvt_pk_bf16_f32 v83, v86, v87
  v_mfma_f32_32x32x16_bf16 v[64:79], v[4:7], v[32:35], v[112:127]
  v_exp_f32 v88, v88
  v_exp_f32 v89, v89
  v_exp_f32 v90, v90
  v_exp_f32 v91, v91
  v_exp_f32 v92, v92
  v_mfma_f32_32x32x16_bf16 v[128:143], v[20:23], v[80:83], v[128:143]
  v_exp_f32 v93, v93
  v_exp_f32 v94, v94
  v_exp_f32 v95, v95
  v_cvt_pk_bf16_f32 v88, v88, v89
  v_cvt_pk_bf16_f32 v89, v90, v91
  v_cvt_pk_bf16_f32 v90, v92, v93
  v_cvt_pk_bf16_f32 v91, v94, v95
  v_mfma_f32_32x32x4_2b_bf16 v[48:79], v[8:9], v[36:37], v[48:79]
  ds_read_b128 v[4:7], v44 offset:1536
  v_exp_f32 v96, v96
  v_exp_f32 v97, v97
  v_exp_f32 v98, v98
  v_exp_f32 v99, v99
  v_exp_f32 v100, v100
  v_exp_f32 v101, v101
  v_exp_f32 v102, v102
  v_exp_f32 v103, v103
  v_mfma_f32_32x32x16_bf16 v[128:143], v[24:27], v[88:91], v[128:143]
  v_cvt_pk_bf16_f32 v96, v96, v97
  v_cvt_pk_bf16_f32 v97, v98, v99
  v_cvt_pk_bf16_f32 v98, v100, v101
  v_cvt_pk_bf16_f32 v99, v102, v103
  v_exp_f32 v104, v104
  v_exp_f32 v105, v105
  v_exp_f32 v106, v106
  v_mfma_f32_32x32x16_bf16 v[144:159], v[20:23], v[96:99], v[144:159]
  v_exp_f32 v107, v107
  v_exp_f32 v108, v108
  v_exp_f32 v109, v109
  v_exp_f32 v110, v110
  v_exp_f32 v111, v111
  v_cvt_pk_bf16_f32 v104, v104, v105
  v_cvt_pk_bf16_f32 v105, v106, v107
  v_cvt_pk_bf16_f32 v106, v108, v109
  v_cvt_pk_bf16_f32 v107, v110, v111
  s_waitcnt lgkmcnt(0)
  s_setprio 0
  v_mfma_f32_32x32x16_bf16 v[144:159], v[24:27], v[104:107], v[144:159]
  v_exp_f32 v48, v48
  v_exp_f32 v49, v49
  s_mov_b64 exec, s[66:67]
  ds_read_b128 v[20:23], v40 offset:3840
  ds_read_b128 v[24:27], v40 offset:4480
  s_mov_b64 exec, -1
  v_exp_f32 v50, v50
  v_exp_f32 v51, v51
  v_exp_f32 v52, v52
  v_mfma_f32_32x32x16_bf16 v[80:95], v[4:7], v[28:31], v[112:127]
  v_exp_f32 v53, v53
  v_exp_f32 v54, v54
  v_exp_f32 v55, v55
  v_cvt_pk_bf16_f32 v48, v48, v49
  v_cvt_pk_bf16_f32 v49, v50, v51
  v_cvt_pk_bf16_f32 v50, v52, v53
  v_cvt_pk_bf16_f32 v51, v54, v55
  v_mfma_f32_32x32x16_bf16 v[96:111], v[4:7], v[32:35], v[112:127]
  v_exp_f32 v56, v56
  v_exp_f32 v57, v57
  v_exp_f32 v58, v58
  v_exp_f32 v59, v59
  v_exp_f32 v60, v60
  v_mfma_f32_32x32x16_bf16 v[128:143], v[12:15], v[48:51], v[128:143]
  v_exp_f32 v61, v61
  v_exp_f32 v62, v62
  v_exp_f32 v63, v63
  v_cvt_pk_bf16_f32 v56, v56, v57
  v_cvt_pk_bf16_f32 v57, v58, v59
  v_cvt_pk_bf16_f32 v58, v60, v61
  v_cvt_pk_bf16_f32 v59, v62, v63
  v_mfma_f32_32x32x4_2b_bf16 v[80:111], v[10:11], v[36:37], v[80:111]
  s_waitcnt vmcnt(0)
  s_barrier
  s_setprio 3
  ds_read_b128 v[4:7], v44 offset:11264
  v_exp_f32 v64, v64
  v_exp_f32 v65, v65
  v_exp_f32 v66, v66
  v_exp_f32 v67, v67
  s_add_u32 m0, s28, 22528
  s_nop 0
  buffer_load_dwordx4 v38, s[12:15], s74 offen sc1 lds
  s_add_u32 s74, s74, 163840
  ds_read2st64_b64 v[8:11], v39 offset0:22 offset1:23
  v_exp_f32 v68, v68
  v_exp_f32 v69, v69
  v_exp_f32 v70, v70
  v_exp_f32 v71, v71
  v_mfma_f32_32x32x16_bf16 v[128:143], v[16:19], v[56:59], v[128:143]
  v_cvt_pk_bf16_f32 v64, v64, v65
  v_cvt_pk_bf16_f32 v65, v66, v67
  v_cvt_pk_bf16_f32 v66, v68, v69
  v_cvt_pk_bf16_f32 v67, v70, v71
  s_add_u32 m0, s28, 26624
  s_nop 0
  buffer_load_dwordx4 v38, s[12:15], s75 offen sc1 lds
  s_add_u32 s75, s75, s77
  v_exp_f32 v72, v72
  v_exp_f32 v73, v73
  v_exp_f32 v74, v74
  v_mfma_f32_32x32x16_bf16 v[144:159], v[12:15], v[64:67], v[144:159]
  v_exp_f32 v75, v75
  v_exp_f32 v76, v76
  v_exp_f32 v77, v77
  s_add_u32 m0, s28, 30720
  s_cmp_eq_u32 s22, 3
  s_cbranch_scc1 L_at_d13
  buffer_load_dwordx4 v38, s[12:15], s76 offen sc1 lds
  s_add_u32 s76, s76, 5120
L_at_d13:
  v_exp_f32 v78, v78
  v_exp_f32 v79, v79
  v_cvt_pk_bf16_f32 v72, v72, v73
  v_cvt_pk_bf16_f32 v73, v74, v75
  v_cvt_pk_bf16_f32 v74, v76, v77
  v_cvt_pk_bf16_f32 v75, v78, v79
  s_waitcnt lgkmcnt(0)
  s_nop 0
  v_mfma_f32_32x32x16_bf16 v[144:159], v[16:19], v[72:75], v[144:159]
  v_exp_f32 v80, v80
  v_exp_f32 v81, v81
  s_mov_b64 exec, s[66:67]
  ds_read_b128 v[12:15], v40 offset:11264
  ds_read_b128 v[16:19], v40 offset:11904
  s_mov_b64 exec, -1
  v_exp_f32 v82, v82
  v_exp_f32 v83, v83
  v_exp_f32 v84, v84
  v_mfma_f32_32x32x16_bf16 v[48:63], v[4:7], v[28:31], v[112:127]
  v_exp_f32 v85, v85
  v_exp_f32 v86, v86
  v_exp_f32 v87, v87
  v_cvt_pk_bf16_f32 v80, v80, v81
  v_cvt_pk_bf16_f32 v81, v82, v83
  v_cvt_pk_bf16_f32 v82, v84, v85
  v_cvt_pk_bf16_f32 v83, v86, v87
  v_mfma_f32_32x32x16_bf16 v[64:79], v[4:7], v[32:35], v[112:127]
  v_exp_f32 v88, v88
  v_exp_f32 v89, v89
  v_exp_f32 v90, v90
  v_exp_f32 v91, v91
  v_exp_f32 v92, v92
  v_mfma_f32_32x32x16_bf16 v[128:143], v[20:23], v[80:83], v[128:143]
  v_exp_f32 v93, v93
  v_exp_f32 v94, v94
  v_exp_f32 v95, v95
  v_cvt_pk_bf16_f32 v88, v88, v89
  v_cvt_pk_bf16_f32 v89, v90, v91
  v_cvt_pk_bf16_f32 v90, v92, v93
  v_cvt_pk_bf16_f32 v91, v94, v95
  v_mfma_f32_32x32x4_2b_bf16 v[48:79], v[8:9], v[36:37], v[48:79]
  ds_read_b128 v[4:7], v44 offset:11776
  s_and_b32 s29, s20, 3
  s_lshr_b32 s38, s29, 1
  s_and_b32 s39, s29, 1
  s_and_b32 s53, s2, 7
  s_bfe_u32 s47, s2, 0x10003
  s_lshr_b32 s50, s2, 4
  s_lshl_b32 s51, s53, 1
  s_add_u32 s51, s51, s47
  s_mov_b32 s52, 1
  s_cmp_lt_u32 s50, 8
  s_cbranch_scc1 L_p3g
  s_sub_u32 s50, s50, 5
  s_cmp_ge_u32 s50, 8
  s_cbranch_scc1 L_p3q
  s_sub_u32 s50, s50, 3
  s_lshl_b32 s40, s51, 7
  s_lshl_b32 s41, s50, 7
  s_mov_b32 s52, 2
  s_cmp_lt_u32 s20, 4
  s_cbranch_scc1 L_p3r
  s_mov_b32 s52, 4
  s_branch L_p3r
L_p3q:
  s_cmp_lt_u32 s50, 10
  s_cbranch_scc1 L_p3g
  s_mov_b32 s52, 0
  s_branch L_p3r
L_p3g:
  s_lshl_b32 s40, s50, 6
  s_lshl_b32 s41, s51, 7
  s_cmp_lt_u32 s20, 4
  s_cbranch_scc1 L_p3r
  s_mov_b32 s52, 3
L_p3r:
  s_lshr_b32 s25, s2, 3
  s_lshl_b32 s25, s25, 3
  s_add_u32 s25, s25, s20
  v_lshlrev_b32 v2, 7, v1
  s_mov_b32 s4, s54
  s_mov_b32 s5, s55
  s_and_b32 s5, s5, 0xffff
  s_mov_b32 s6, 819200
  s_mov_b32 s7, 0x00020000
  s_lshl_b32 s25, s25, 13
  buffer_load_dword v43, v2, s[4:7], s25 offen
  v_exp_f32 v96, v96
  v_exp_f32 v97, v97
  v_exp_f32 v98, v98
  v_exp_f32 v99, v99
  v_exp_f32 v100, v100
  v_exp_f32 v101, v101
  v_exp_f32 v102, v102
  v_exp_f32 v103, v103
  v_mfma_f32_32x32x16_bf16 v[128:143], v[24:27], v[88:91], v[128:143]
  v_cvt_pk_bf16_f32 v96, v96, v97
  v_cvt_pk_bf16_f32 v97, v98, v99
  v_cvt_pk_bf16_f32 v98, v100, v101
  v_cvt_pk_bf16_f32 v99, v102, v103
  v_exp_f32 v104, v104
  v_exp_f32 v105, v105
  v_exp_f32 v106, v106
  v_mfma_f32_32x32x16_bf16 v[144:159], v[20:23], v[96:99], v[144:159]
  v_exp_f32 v107, v107
  v_exp_f32 v108, v108
  v_exp_f32 v109, v109
  v_exp_f32 v110, v110
  v_exp_f32 v111, v111
  v_cvt_pk_bf16_f32 v104, v104, v105
  v_cvt_pk_bf16_f32 v105, v106, v107
  v_cvt_pk_bf16_f32 v106, v108, v109
  v_cvt_pk_bf16_f32 v107, v110, v111
  s_waitcnt lgkmcnt(0)
  s_setprio 2
  v_mfma_f32_32x32x16_bf16 v[144:159], v[24:27], v[104:107], v[144:159]
  v_exp_f32 v48, v48
  v_exp_f32 v49, v49
  s_mov_b64 exec, s[66:67]
  ds_read_b128 v[20:23], v40 offset:12544
  ds_read_b128 v[24:27], v40 offset:13184
  s_mov_b64 exec, -1
  v_exp_f32 v50, v50
  v_exp_f32 v51, v51
  v_exp_f32 v52, v52
  v_mfma_f32_32x32x16_bf16 v[80:95], v[4:7], v[28:31], v[112:127]
  v_exp_f32 v53, v53
  v_exp_f32 v54, v54
  v_exp_f32 v55, v55
  v_cvt_pk_bf16_f32 v48, v48, v49
  v_cvt_pk_bf16_f32 v49, v50, v51
  v_cvt_pk_bf16_f32 v50, v52, v53
  v_cvt_pk_bf16_f32 v51, v54, v55
  v_mfma_f32_32x32x16_bf16 v[96:111], v[4:7], v[32:35], v[112:127]
  v_exp_f32 v56, v56
  v_exp_f32 v57, v57
  v_exp_f32 v58, v58
  v_exp_f32 v59, v59
  v_exp_f32 v60, v60
  v_mfma_f32_32x32x16_bf16 v[128:143], v[12:15], v[48:51], v[128:143]
  v_exp_f32 v61, v61
  v_exp_f32 v62, v62
  v_exp_f32 v63, v63
  v_cvt_pk_bf16_f32 v56, v56, v57
  v_cvt_pk_bf16_f32 v57, v58, v59
  v_cvt_pk_bf16_f32 v58, v60, v61
  v_cvt_pk_bf16_f32 v59, v62, v63
  v_mfma_f32_32x32x4_2b_bf16 v[80:111], v[10:11], v[36:37], v[80:111]
  ds_read_b128 v[4:7], v44 offset:12288
  v_exp_f32 v64, v64
  v_exp_f32 v65, v65
  v_exp_f32 v66, v66
  v_exp_f32 v67, v67
  ds_read2st64_b64 v[8:11], v39 offset0:24 offset1:25
  v_exp_f32 v68, v68
  v_exp_f32 v69, v69
  v_exp_f32 v70, v70
  v_exp_f32 v71, v71
  v_mfma_f32_32x32x16_bf16 v[128:143], v[16:19], v[56:59], v[128:143]
  v_cvt_pk_bf16_f32 v64, v64, v65
  v_cvt_pk_bf16_f32 v65, v66, v67
  v_cvt_pk_bf16_f32 v66, v68, v69
  v_cvt_pk_bf16_f32 v67, v70, v71
  v_exp_f32 v72, v72
  v_exp_f32 v73, v73
  v_exp_f32 v74, v74
  v_mfma_f32_32x32x16_bf16 v[144:159], v[12:15], v[64:67], v[144:159]
  v_exp_f32 v75, v75
  v_exp_f32 v76, v76
  v_exp_f32 v77, v77
  v_exp_f32 v78, v78
  v_exp_f32 v79, v79
  v_cvt_pk_bf16_f32 v72, v72, v73
  v_cvt_pk_bf16_f32 v73, v74, v75
  v_cvt_pk_bf16_f32 v74, v76, v77
  v_cvt_pk_bf16_f32 v75, v78, v79
  s_waitcnt lgkmcnt(0)
  s_setprio 1
  v_mfma_f32_32x32x16_bf16 v[144:159], v[16:19], v[72:75], v[144:159]
  v_exp_f32 v80, v80
  v_exp_f32 v81, v81
  s_mov_b64 exec, s[66:67]
  ds_read_b128 v[12:15], v40 offset:13824
  ds_read_b128 v[16:19], v40 offset:14464
  s_mov_b64 exec, -1
  v_exp_f32 v82, v82
  v_exp_f32 v83, v83
  v_exp_f32 v84, v84
  v_mfma_f32_32x32x16_bf16 v[48:63], v[4:7], v[28:31], v[112:127]
  v_exp_f32 v85, v85
  v_exp_f32 v86, v86
  v_exp_f32 v87, v87
  v_cvt_pk_bf16_f32 v80, v80, v81
  v_cvt_pk_bf16_f32 v81, v82, v83
  v_cvt_pk_bf16_f32 v82, v84, v85
  v_cvt_pk_bf16_f32 v83, v86, v87
  v_mfma_f32_32x32x16_bf16 v[64:79], v[4:7], v[32:35], v[112:127]
  v_exp_f32 v88, v88
  v_exp_f32 v89, v89
  v_exp_f32 v90, v90
  v_exp_f32 v91, v91
  v_exp_f32 v92, v92
  v_mfma_f32_32x32x16_bf16 v[128:143], v[20:23], v[80:83], v[128:143]
  v_exp_f32 v93, v93
  v_exp_f32 v94, v94
  v_exp_f32 v95, v95
  v_cvt_pk_bf16_f32 v88, v88, v89
  v_cvt_pk_bf16_f32 v89, v90, v91
  v_cvt_pk_bf16_f32 v90, v92, v93
  v_cvt_pk_bf16_f32 v91, v94, v95
  v_mfma_f32_32x32x4_2b_bf16 v[48:79], v[8:9], v[36:37], v[48:79]
  ds_read_b128 v[4:7], v44 offset:12800
  v_exp_f32 v96, v96
  v_exp_f32 v97, v97
  v_exp_f32 v98, v98
  v_exp_f32 v99, v99
  v_exp_f32 v100, v100
  v_exp_f32 v101, v101
  v_exp_f32 v102, v102
  v_exp_f32 v103, v103
  v_mfma_f32_32x32x16_bf16 v[128:143], v[24:27], v[88:91], v[128:143]
  v_cvt_pk_bf16_f32 v96, v96, v97
  v_cvt_pk_bf16_f32 v97, v98, v99
  v_cvt_pk_bf16_f32 v98, v100, v101
  v_cvt_pk_bf16_f32 v99, v102, v103
  v_exp_f32 v104, v104
  v_exp_f32 v105, v105
  v_exp_f32 v106, v106
  v_mfma_f32_32x32x16_bf16 v[144:159], v[20:23], v[96:99], v[144:159]
  v_exp_f32 v107, v107
  v_exp_f32 v108, v108
  v_exp_f32 v109, v109
  v_exp_f32 v110, v110
  v_exp_f32 v111, v111
  v_cvt_pk_bf16_f32 v104, v104, v105
  v_cvt_pk_bf16_f32 v105, v106, v107
  v_cvt_pk_bf16_f32 v106, v108, v109
  v_cvt_pk_bf16_f32 v107, v110, v111
  s_waitcnt lgkmcnt(0)
  s_setprio 0
  v_mfma_f32_32x32x16_bf16 v[144:159], v[24:27], v[104:107], v[144:159]
  v_exp_f32 v48, v48
  v_exp_f32 v49, v49
  s_mov_b64 exec, s[66:67]
  ds_read_b128 v[20:23], v40 offset:15104
  ds_read_b128 v[24:27], v40 offset:15744
  s_mov_b64 exec, -1
  v_exp_f32 v50, v50
  v_exp_f32 v51, v51
  v_exp_f32 v52, v52
  v_mfma_f32_32x32x16_bf16 v[80:95], v[4:7], v[28:31], v[112:127]
  v_exp_f32 v53, v53
  v_exp_f32 v54, v54
  v_exp_f32 v55, v55
  v_cvt_pk_bf16_f32 v48, v48, v49
  v_cvt_pk_bf16_f32 v49, v50, v51
  v_cvt_pk_bf16_f32 v50, v52, v53
  v_cvt_pk_bf16_f32 v51, v54, v55
  v_mfma_f32_32x32x16_bf16 v[96:111], v[4:7], v[32:35], v[112:127]
  v_exp_f32 v56, v56
  v_exp_f32 v57, v57
  v_exp_f32 v58, v58
  v_exp_f32 v59, v59
  v_exp_f32 v60, v60
  v_mfma_f32_32x32x16_bf16 v[128:143], v[12:15], v[48:51], v[128:143]
  v_exp_f32 v61, v61
  v_exp_f32 v62, v62
  v_exp_f32 v63, v63
  v_cvt_pk_bf16_f32 v56, v56, v57
  v_cvt_pk_bf16_f32 v57, v58, v59
  v_cvt_pk_bf16_f32 v58, v60, v61
  v_cvt_pk_bf16_f32 v59, v62, v63
  v_mfma_f32_32x32x4_2b_bf16 v[80:111], v[10:11], v[36:37], v[80:111]
  s_waitcnt vmcnt(0)
  s_barrier
  s_setprio 3
  ds_read_b128 v[4:7], v44 offset:22528
  v_exp_f32 v64, v64
  v_exp_f32 v65, v65
  v_exp_f32 v66, v66
  v_exp_f32 v67, v67
  s_add_u32 m0, s28, 0
  s_nop 0
  buffer_load_dwordx4 v38, s[12:15], s74 offen sc1 lds
  s_add_u32 s74, s74, 163840
  ds_read2st64_b64 v[8:11], v39 offset0:44 offset1:45
  v_exp_f32 v68, v68
  v_exp_f32 v69, v69
  v_exp_f32 v70, v70
  v_exp_f32 v71, v71
  v_mfma_f32_32x32x16_bf16 v[128:143], v[16:19], v[56:59], v[128:143]
  v_cvt_pk_bf16_f32 v64, v64, v65
  v_cvt_pk_bf16_f32 v65, v66, v67
  v_cvt_pk_bf16_f32 v66, v68, v69
  v_cvt_pk_bf16_f32 v67, v70, v71
  s_add_u32 m0, s28, 4096
  s_nop 0
  buffer_load_dwordx4 v38, s[12:15], s75 offen sc1 lds
  s_add_u32 s75, s75, s77
  v_exp_f32 v72, v72
  v_exp_f32 v73, v73
  v_exp_f32 v74, v74
  v_mfma_f32_32x32x16_bf16 v[144:159], v[12:15], v[64:67], v[144:159]
  v_exp_f32 v75, v75
  v_exp_f32 v76, v76
  v_exp_f32 v77, v77
  s_add_u32 m0, s28, 8192
  s_cmp_eq_u32 s22, 3
  s_cbranch_scc1 L_at_d16
  buffer_load_dwordx4 v38, s[12:15], s76 offen sc1 lds
  s_add_u32 s76, s76, 5120
L_at_d16:
  v_exp_f32 v78, v78
  v_exp_f32 v79, v79
  v_cvt_pk_bf16_f32 v72, v72, v73
  v_cvt_pk_bf16_f32 v73, v74, v75
  v_cvt_pk_bf16_f32 v74, v76, v77
  v_cvt_pk_bf16_f32 v75, v78, v79
  s_waitcnt lgkmcnt(0)
  s_nop 0
  v_mfma_f32_32x32x16_bf16 v[144:159], v[16:19], v[72:75], v[144:159]
  v_exp_f32 v80, v80
  v_exp_f32 v81, v81
  s_mov_b64 exec, s[66:67]
  ds_read_b128 v[12:15], v40 offset:22528
  ds_read_b128 v[16:19], v40 offset:23168
  s_mov_b64 exec, -1
  v_exp_f32 v82, v82
  v_exp_f32 v83, v83
  v_exp_f32 v84, v84
  v_mfma_f32_32x32x16_bf16 v[48:63], v[4:7], v[28:31], v[112:127]
  v_exp_f32 v85, v85
  v_exp_f32 v86, v86
  v_exp_f32 v87, v87
  v_cvt_pk_bf16_f32 v80, v80, v81
  v_cvt_pk_bf16_f32 v81, v82, v83
  v_cvt_pk_bf16_f32 v82, v84, v85
  v_cvt_pk_bf16_f32 v83, v86, v87
  v_mfma_f32_32x32x16_bf16 v[64:79], v[4:7], v[32:35], v[112:127]
  v_exp_f32 v88, v88
  v_exp_f32 v89, v89
  v_exp_f32 v90, v90
  v_exp_f32 v91, v91
  v_exp_f32 v92, v92
  v_mfma_f32_32x32x16_bf16 v[128:143], v[20:23], v[80:83], v[128:143]
  v_exp_f32 v93, v93
  v_exp_f32 v94, v94
  v_exp_f32 v95, v95
  v_cvt_pk_bf16_f32 v88, v88, v89
  v_cvt_pk_bf16_f32 v89, v90, v91
  v_cvt_pk_bf16_f32 v90, v92, v93
  v_cvt_pk_bf16_f32 v91, v94, v95
  v_mfma_f32_32x32x4_2b_bf16 v[48:79], v[8:9], v[36:37], v[48:79]
  ds_read_b128 v[4:7], v44 offset:23040
  s_cmp_eq_u32 s52, 1
  s_cbranch_scc1 L_p4_1
  s_cmp_eq_u32 s52, 3
  s_cbranch_scc1 L_p4_3
  s_cmp_eq_u32 s52, 4
  s_cbranch_scc1 L_p4_4
  s_branch L_p4_e
L_p4_1:
  s_mov_b32 s4, s32
  s_and_b32 s5, s33, 0xffff
  s_mov_b32 s6, 2621440
  s_mov_b32 s7, 0x00020000
  s_mov_b32 s8, s48
  s_and_b32 s9, s49, 0xffff
  s_mov_b32 s10, 1280
  s_mov_b32 s11, 0x00020000
  v_and_b32 v250, 31, v1
  s_lshl_b32 s25, s39, 6
  s_add_u32 s25, s25, s41
  v_add_u32 v251, s25, v250
  v_mul_u32_u24 v251, 1280, v251
  v_lshrrev_b32 v185, 5, v1
  v_lshl_add_u32 v251, v185, 4, v251
  s_lshl_b32 s25, s38, 5
  s_add_u32 s25, s25, s40
  v_add_u32 v186, s25, v250
  s_lshl_b32 s25, s25, 1
  s_add_u32 s26, s25, 40960
  buffer_load_dwordx4 v[168:171], v251, s[4:7], s25 offen
  buffer_load_dwordx4 v[172:175], v251, s[4:7], s25 offen offset:32
  buffer_load_dwordx4 v[176:179], v251, s[4:7], s26 offen
  buffer_load_dwordx4 v[180:183], v251, s[4:7], s26 offen offset:32
  v_lshlrev_b32 v251, 1, v186
  buffer_load_ushort v184, v251, s[8:11], 0 offen
  s_branch L_p4_e
L_p4_3:
  s_mul_i32 s25, s47, 20
  s_lshr_b32 s25, s25, 1
  s_mul_i32 s46, s50, 2
  s_add_u32 s46, s46, s25
  s_cmp_ge_u32 s46, 20
  s_cselect_b32 s25, 20, 0
  s_sub_u32 s46, s46, s25
  s_cmp_ge_u32 s46, 20
  s_cselect_b32 s25, 20, 0
  s_sub_u32 s46, s46, s25
  s_add_u32 s25, s50, s47
  s_and_b32 s25, s25, 1
  s_add_u32 s46, s46, s25
  v_lshrrev_b32 v251, 4, v1
  v_xor_b32 v251, v251, v1
  v_and_b32 v251, 7, v251
  v_lshlrev_b32 v251, 4, v251
  v_lshrrev_b32 v250, 3, v1
  s_mul_i32 s25, s29, 16
  s_add_u32 s25, s25, s40
  v_add_u32 v250, s25, v250
  v_mul_u32_u24 v250, 1280, v250
  v_add_u32 v244, v250, v251
  v_xor_b32 v245, 64, v244
  s_lshr_b32 s25, s41, 3
  s_mul_i32 s26, s29, 4
  s_add_u32 s25, s25, s26
  s_mul_i32 s25, s25, 20480
  v_lshlrev_b32 v246, 4, v1
  v_add_u32 v246, s25, v246
  s_mul_i32 s34, s29, 2048
  s_mul_i32 s35, s29, 4096
  v_min_u32 v252, 9, v1
  v_lshlrev_b32 v252, 2, v252
  s_lshl_b32 s3, s53, 7
  s_add_u32 s3, s3, 15790080
  buffer_load_dword v253, v252, s[12:15], s3 offen sc1
  s_mov_b32 s4, s42
  s_and_b32 s5, s43, 0xffff
  s_mov_b32 s6, 819200
  s_mov_b32 s7, 0x00020000
  s_mov_b32 s16, s42
  s_and_b32 s17, s43, 0xffff
  s_mov_b32 s18, s44
  s_and_b32 s19, s45, 0xffff
  s_add_u32 s8, s60, 10485760
  s_addc_u32 s9, s61, 0
  s_and_b32 s9, s9, 0xffff
  s_mov_b32 s10, 5242880
  s_mov_b32 s11, 0x00020000
  s_mul_i32 s37, s46, 1024
  s_mul_i32 s36, s46, 128
  s_cmp_ge_u32 s46, 10
  s_cselect_b32 s4, s18, s16
  s_cselect_b32 s5, s19, s17
  s_cselect_b32 s25, 1280, 0
  s_sub_u32 s36, s36, s25
  s_add_u32 m0, s34, 0
  s_add_u32 s25, s36, 0
  buffer_load_dwordx4 v244, s[4:7], s25 offen  lds
  s_add_u32 m0, s34, 1024
  s_add_u32 s25, s36, 10240
  buffer_load_dwordx4 v245, s[4:7], s25 offen  lds
  s_add_u32 s36, s36, 128
  s_xor_b32 s25, s16, s18
  s_xor_b32 s26, s17, s19
  s_cmp_eq_u32 s36, 1280
  s_cselect_b32 s36, 0, s36
  s_cselect_b32 s25, s25, 0
  s_cselect_b32 s26, s26, 0
  s_xor_b32 s4, s4, s25
  s_xor_b32 s5, s5, s26
  s_add_u32 m0, s34, 24576
  s_add_u32 s25, s36, 0
  buffer_load_dwordx4 v244, s[4:7], s25 offen  lds
  s_add_u32 m0, s34, 25600
  s_add_u32 s25, s36, 10240
  buffer_load_dwordx4 v245, s[4:7], s25 offen  lds
  s_add_u32 s36, s36, 128
  s_xor_b32 s25, s16, s18
  s_xor_b32 s26, s17, s19
  s_cmp_eq_u32 s36, 1280
  s_cselect_b32 s36, 0, s36
  s_cselect_b32 s25, s25, 0
  s_cselect_b32 s26, s26, 0
  s_xor_b32 s4, s4, s25
  s_xor_b32 s5, s5, s26
  s_add_u32 m0, s34, 49152
  s_add_u32 s25, s36, 0
  buffer_load_dwordx4 v244, s[4:7], s25 offen  lds
  s_add_u32 m0, s34, 50176
  s_add_u32 s25, s36, 10240
  buffer_load_dwordx4 v245, s[4:7], s25 offen  lds
  s_add_u32 s36, s36, 128
  s_xor_b32 s25, s16, s18
  s_xor_b32 s26, s17, s19
  s_cmp_eq_u32 s36, 1280
  s_cselect_b32 s36, 0, s36
  s_cselect_b32 s25, s25, 0
  s_cselect_b32 s26, s26, 0
  s_xor_b32 s4, s4, s25
  s_xor_b32 s5, s5, s26
  s_branch L_p4_e
L_p4_4:
  s_mov_b32 s46, 0
  v_lshrrev_b32 v251, 4, v1
  v_xor_b32 v251, v251, v1
  v_and_b32 v251, 7, v251
  v_lshlrev_b32 v251, 4, v251
  v_lshrrev_b32 v250, 3, v1
  s_lshr_b32 s25, s40, 5
  s_add_u32 s25, s25, s29
  s_mul_i32 s25, s25, 40960
  v_lshlrev_b32 v244, 4, v1
  v_add_u32 v244, s25, v244
  v_lshrrev_b32 v250, 4, v1
  s_mul_i32 s25, s29, 16
  v_add_u32 v246, s25, v250
  v_mul_u32_u24 v246, 1280, v246
  v_lshlrev_b32 v250, 2, v250
  v_xor_b32 v250, v250, v1
  v_and_b32 v250, 15, v250
  v_lshlrev_b32 v250, 4, v250
  v_add_u32 v246, v246, v250
  s_lshl_b32 s25, s41, 1
  v_add_u32 v246, s25, v246
  s_mul_i32 s34, s29, 4096
  s_mul_i32 s35, s29, 4096
  s_add_u32 s4, s60, 7864320
  s_addc_u32 s5, s61, 0
  s_and_b32 s5, s5, 0xffff
  s_mov_b32 s6, 2621440
  s_mov_b32 s7, 0x00020000
  s_mov_b32 s8, s54
  s_and_b32 s9, s55, 0xffff
  s_mov_b32 s10, 819200
  s_mov_b32 s11, 0x00020000
  s_mul_i32 s37, s46, 81920
  s_mul_i32 s36, s46, 4096
  s_add_u32 m0, s35, 0
  s_add_u32 s25, s37, 0
  buffer_load_dwordx4 v246, s[8:11], s25 offen  lds
  s_add_u32 m0, s35, 1024
  s_add_u32 s25, s37, 5120
  buffer_load_dwordx4 v246, s[8:11], s25 offen  lds
  s_add_u32 m0, s35, 2048
  s_add_u32 s25, s37, 10240
  buffer_load_dwordx4 v246, s[8:11], s25 offen  lds
  s_add_u32 m0, s35, 3072
  s_add_u32 s25, s37, 15360
  buffer_load_dwordx4 v246, s[8:11], s25 offen  lds
  s_add_u32 s37, s37, 81920
  s_cmp_eq_u32 s37, 409600
  s_cselect_b32 s37, 0, s37
  s_add_u32 m0, s35, 16384
  s_add_u32 s25, s37, 0
  buffer_load_dwordx4 v246, s[8:11], s25 offen  lds
  s_add_u32 m0, s35, 17408
  s_add_u32 s25, s37, 5120
  buffer_load_dwordx4 v246, s[8:11], s25 offen  lds
  s_add_u32 m0, s35, 18432
  s_add_u32 s25, s37, 10240
  buffer_load_dwordx4 v246, s[8:11], s25 offen  lds
  s_add_u32 m0, s35, 19456
  s_add_u32 s25, s37, 15360
  buffer_load_dwordx4 v246, s[8:11], s25 offen  lds
  s_add_u32 s37, s37, 81920
  s_cmp_eq_u32 s37, 409600
  s_cselect_b32 s37, 0, s37
L_p4_e:
  v_exp_f32 v96, v96
  v_exp_f32 v97, v97
  v_exp_f32 v98, v98
  v_exp_f32 v99, v99
  v_exp_f32 v100, v100
  v_exp_f32 v101, v101
  v_exp_f32 v102, v102
  v_exp_f32 v103, v103
  v_mfma_f32_32x32x16_bf16 v[128:143], v[24:27], v[88:91], v[128:143]
  v_cvt_pk_bf16_f32 v96, v96, v97
  v_cvt_pk_bf16_f32 v97, v98, v99
  v_cvt_pk_bf16_f32 v98, v100, v101
  v_cvt_pk_bf16_f32 v99, v102, v103
  v_exp_f32 v104, v104
  v_exp_f32 v105, v105
  v_exp_f32 v106, v106
  v_mfma_f32_32x32x16_bf16 v[144:159], v[20:23], v[96:99], v[144:159]
  v_exp_f32 v107, v107
  v_exp_f32 v108, v108
  v_exp_f32 v109, v109
  v_exp_f32 v110, v110
  v_exp_f32 v111, v111
  v_cvt_pk_bf16_f32 v104, v104, v105
  v_cvt_pk_bf16_f32 v105, v106, v107
  v_cvt_pk_bf16_f32 v106, v108, v109
  v_cvt_pk_bf16_f32 v107, v110, v111
  s_waitcnt lgkmcnt(0)
  s_setprio 2
  v_mfma_f32_32x32x16_bf16 v[144:159], v[24:27], v[104:107], v[144:159]
  v_exp_f32 v48, v48
  v_exp_f32 v49, v49
  s_mov_b64 exec, s[66:67]
  ds_read_b128 v[20:23], v40 offset:23808
  ds_read_b128 v[24:27], v40 offset:24448
  s_mov_b64 exec, -1
  v_exp_f32 v50, v50
  v_exp_f32 v51, v51
  v_exp_f32 v52, v52
  v_mfma_f32_32x32x16_bf16 v[80:95], v[4:7], v[28:31], v[112:127]
  v_exp_f32 v53, v53
  v_exp_f32 v54, v54
  v_exp_f32 v55, v55
  v_cvt_pk_bf16_f32 v48, v48, v49
  v_cvt_pk_bf16_f32 v49, v50, v51
  v_cvt_pk_bf16_f32 v50, v52, v53
  v_cvt_pk_bf16_f32 v51, v54, v55
  v_mfma_f32_32x32x16_bf16 v[96:111], v[4:7], v[32:35], v[112:127]
  v_exp_f32 v56, v56
  v_exp_f32 v57, v57
  v_exp_f32 v58, v58
  v_exp_f32 v59, v59
  v_exp_f32 v60, v60
  v_mfma_f32_32x32x16_bf16 v[128:143], v[12:15], v[48:51], v[128:143]
  v_exp_f32 v61, v61
  v_exp_f32 v62, v62
  v_exp_f32 v63, v63
  v_cvt_pk_bf16_f32 v56, v56, v57
  v_cvt_pk_bf16_f32 v57, v58, v59
  v_cvt_pk_bf16_f32 v58, v60, v61
  v_cvt_pk_bf16_f32 v59, v62, v63
  v_mfma_f32_32x32x4_2b_bf16 v[80:111], v[10:11], v[36:37], v[80:111]
  ds_read_b128 v[4:7], v44 offset:23552
  v_exp_f32 v64, v64
  v_exp_f32 v65, v65
  v_exp_f32 v66, v66
  v_exp_f32 v67, v67
  ds_read2st64_b64 v[8:11], v39 offset0:46 offset1:47
  v_exp_f32 v68, v68
  v_exp_f32 v69, v69
  v_exp_f32 v70, v70
  v_exp_f32 v71, v71
  v_mfma_f32_32x32x16_bf16 v[128:143], v[16:19], v[56:59], v[128:143]
  v_cvt_pk_bf16_f32 v64, v64, v65
  v_cvt_pk_bf16_f32 v65, v66, v67
  v_cvt_pk_bf16_f32 v66, v68, v69
  v_cvt_pk_bf16_f32 v67, v70, v71
  v_exp_f32 v72, v72
  v_exp_f32 v73, v73
  v_exp_f32 v74, v74
  v_mfma_f32_32x32x16_bf16 v[144:159], v[12:15], v[64:67], v[144:159]
  v_exp_f32 v75, v75
  v_exp_f32 v76, v76
  v_exp_f32 v77, v77
  v_exp_f32 v78, v78
  v_exp_f32 v79, v79
  v_cvt_pk_bf16_f32 v72, v72, v73
  v_cvt_pk_bf16_f32 v73, v74, v75
  v_cvt_pk_bf16_f32 v74, v76, v77
  v_cvt_pk_bf16_f32 v75, v78, v79
  s_waitcnt lgkmcnt(0)
  s_setprio 1
  v_mfma_f32_32x32x16_bf16 v[144:159], v[16:19], v[72:75], v[144:159]
  v_exp_f32 v80, v80
  v_exp_f32 v81, v81
  s_mov_b64 exec, s[66:67]
  ds_read_b128 v[12:15], v40 offset:25088
  ds_read_b128 v[16:19], v40 offset:25728
  s_mov_b64 exec, -1
  v_exp_f32 v82, v82
  v_exp_f32 v83, v83
  v_exp_f32 v84, v84
  v_mfma_f32_32x32x16_bf16 v[48:63], v[4:7], v[28:31], v[112:127]
  v_exp_f32 v85, v85
  v_exp_f32 v86, v86
  v_exp_f32 v87, v87
  v_cvt_pk_bf16_f32 v80, v80, v81
  v_cvt_pk_bf16_f32 v81, v82, v83
  v_cvt_pk_bf16_f32 v82, v84, v85
  v_cvt_pk_bf16_f32 v83, v86, v87
  v_mfma_f32_32x32x16_bf16 v[64:79], v[4:7], v[32:35], v[112:127]
  v_exp_f32 v88, v88
  v_exp_f32 v89, v89
  v_exp_f32 v90, v90
  v_exp_f32 v91, v91
  v_exp_f32 v92, v92
  v_mfma_f32_32x32x16_bf16 v[128:143], v[20:23], v[80:83], v[128:143]
  v_exp_f32 v93, v93
  v_exp_f32 v94, v94
  v_exp_f32 v95, v95
  v_cvt_pk_bf16_f32 v88, v88, v89
  v_cvt_pk_bf16_f32 v89, v90, v91
  v_cvt_pk_bf16_f32 v90, v92, v93
  v_cvt_pk_bf16_f32 v91, v94, v95
  v_mfma_f32_32x32x4_2b_bf16 v[48:79], v[8:9], v[36:37], v[48:79]
  ds_read_b128 v[4:7], v44 offset:24064
  v_exp_f32 v96, v96
  v_exp_f32 v97, v97
  v_exp_f32 v98, v98
  v_exp_f32 v99, v99
  v_exp_f32 v100, v100
  v_exp_f32 v101, v101
  v_exp_f32 v102, v102
  v_exp_f32 v103, v103
  v_mfma_f32_32x32x16_bf16 v[128:143], v[24:27], v[88:91], v[128:143]
  v_cvt_pk_bf16_f32 v96, v96, v97
  v_cvt_pk_bf16_f32 v97, v98, v99
  v_cvt_pk_bf16_f32 v98, v100, v101
  v_cvt_pk_bf16_f32 v99, v102, v103
  v_exp_f32 v104, v104
  v_exp_f32 v105, v105
  v_exp_f32 v106, v106
  v_mfma_f32_32x32x16_bf16 v[144:159], v[20:23], v[96:99], v[144:159]
  v_exp_f32 v107, v107
  v_exp_f32 v108, v108
  v_exp_f32 v109, v109
  v_exp_f32 v110, v110
  v_exp_f32 v111, v111
  v_cvt_pk_bf16_f32 v104, v104, v105
  v_cvt_pk_bf16_f32 v105, v106, v107
  v_cvt_pk_bf16_f32 v106, v108, v109
  v_cvt_pk_bf16_f32 v107, v110, v111
  s_waitcnt lgkmcnt(0)
  s_setprio 0
  v_mfma_f32_32x32x16_bf16 v[144:159], v[24:27], v[104:107], v[144:159]
  v_exp_f32 v48, v48
  v_exp_f32 v49, v49
  s_mov_b64 exec, s[66:67]
  ds_read_b128 v[20:23], v40 offset:26368
  ds_read_b128 v[24:27], v40 offset:27008
  s_mov_b64 exec, -1
  v_exp_f32 v50, v50
  v_exp_f32 v51, v51
  v_exp_f32 v52, v52
  v_mfma_f32_32x32x16_bf16 v[80:95], v[4:7], v[28:31], v[112:127]
  v_exp_f32 v53, v53
  v_exp_f32 v54, v54
  v_exp_f32 v55, v55
  v_cvt_pk_bf16_f32 v48, v48, v49
  v_cvt_pk_bf16_f32 v49, v50, v51
  v_cvt_pk_bf16_f32 v50, v52, v53
  v_cvt_pk_bf16_f32 v51, v54, v55
  v_mfma_f32_32x32x16_bf16 v[96:111], v[4:7], v[32:35], v[112:127]
  v_exp_f32 v56, v56
  v_exp_f32 v57, v57
  v_exp_f32 v58, v58
  v_exp_f32 v59, v59
  v_exp_f32 v60, v60
  v_mfma_f32_32x32x16_bf16 v[128:143], v[12:15], v[48:51], v[128:143]
  v_exp_f32 v61, v61
  v_exp_f32 v62, v62
  v_exp_f32 v63, v63
  v_cvt_pk_bf16_f32 v56, v56, v57
  v_cvt_pk_bf16_f32 v57, v58, v59
  v_cvt_pk_bf16_f32 v58, v60, v61
  v_cvt_pk_bf16_f32 v59, v62, v63
  v_mfma_f32_32x32x4_2b_bf16 v[80:111], v[10:11], v[36:37], v[80:111]
  s_waitcnt vmcnt(0)
  s_barrier
  s_setprio 3
  ds_read_b128 v[4:7], v44 offset:0
  v_exp_f32 v64, v64
  v_exp_f32 v65, v65
  v_exp_f32 v66, v66
  v_exp_f32 v67, v67
  s_add_u32 m0, s28, 11264
  s_nop 0
  buffer_load_dwordx4 v38, s[12:15], s74 offen sc1 lds
  s_add_u32 s74, s74, 163840
  ds_read2st64_b64 v[8:11], v39 offset0:0 offset1:1
  v_exp_f32 v68, v68
  v_exp_f32 v69, v69
  v_exp_f32 v70, v70
  v_exp_f32 v71, v71
  v_mfma_f32_32x32x16_bf16 v[128:143], v[16:19], v[56:59], v[128:143]
  v_cvt_pk_bf16_f32 v64, v64, v65
  v_cvt_pk_bf16_f32 v65, v66, v67
  v_cvt_pk_bf16_f32 v66, v68, v69
  v_cvt_pk_bf16_f32 v67, v70, v71
  s_add_u32 m0, s28, 15360
  s_nop 0
  buffer_load_dwordx4 v38, s[12:15], s75 offen sc1 lds
  s_add_u32 s75, s75, s77
  v_exp_f32 v72, v72
  v_exp_f32 v73, v73
  v_exp_f32 v74, v74
  v_mfma_f32_32x32x16_bf16 v[144:159], v[12:15], v[64:67], v[144:159]
  v_exp_f32 v75, v75
  v_exp_f32 v76, v76
  v_exp_f32 v77, v77
  s_add_u32 m0, s28, 19456
  s_cmp_eq_u32 s22, 3
  s_cbranch_scc1 L_at_d19
  buffer_load_dwordx4 v38, s[12:15], s76 offen sc1 lds
  s_add_u32 s76, s76, 5120
L_at_d19:
  v_exp_f32 v78, v78
  v_exp_f32 v79, v79
  v_cvt_pk_bf16_f32 v72, v72, v73
  v_cvt_pk_bf16_f32 v73, v74, v75
  v_cvt_pk_bf16_f32 v74, v76, v77
  v_cvt_pk_bf16_f32 v75, v78, v79
  s_waitcnt lgkmcnt(0)
  s_nop 0
  v_mfma_f32_32x32x16_bf16 v[144:159], v[16:19], v[72:75], v[144:159]
  v_exp_f32 v80, v80
  v_exp_f32 v81, v81
  s_mov_b64 exec, s[66:67]
  ds_read_b128 v[12:15], v40 offset:0
  ds_read_b128 v[16:19], v40 offset:640
  s_mov_b64 exec, -1
  v_exp_f32 v82, v82
  v_exp_f32 v83, v83
  v_exp_f32 v84, v84
  v_mfma_f32_32x32x16_bf16 v[48:63], v[4:7], v[28:31], v[112:127]
  v_exp_f32 v85, v85
  v_exp_f32 v86, v86
  v_exp_f32 v87, v87
  v_cvt_pk_bf16_f32 v80, v80, v81
  v_cvt_pk_bf16_f32 v81, v82, v83
  v_cvt_pk_bf16_f32 v82, v84, v85
  v_cvt_pk_bf16_f32 v83, v86, v87
  v_mfma_f32_32x32x16_bf16 v[64:79], v[4:7], v[32:35], v[112:127]
  v_exp_f32 v88, v88
  v_exp_f32 v89, v89
  v_exp_f32 v90, v90
  v_exp_f32 v91, v91
  v_exp_f32 v92, v92
  v_mfma_f32_32x32x16_bf16 v[128:143], v[20:23], v[80:83], v[128:143]
  v_exp_f32 v93, v93
  v_exp_f32 v94, v94
  v_exp_f32 v95, v95
  v_cvt_pk_bf16_f32 v88, v88, v89
  v_cvt_pk_bf16_f32 v89, v90, v91
  v_cvt_pk_bf16_f32 v90, v92, v93
  v_cvt_pk_bf16_f32 v91, v94, v95
  v_mfma_f32_32x32x4_2b_bf16 v[48:79], v[8:9], v[36:37], v[48:79]
  ds_read_b128 v[4:7], v44 offset:512
  s_cmp_eq_u32 s52, 1
  s_cbranch_scc1 L_p5_1
  s_cmp_eq_u32 s52, 2
  s_cbranch_scc1 L_p5_2
  s_cmp_eq_u32 s52, 3
  s_cbranch_scc1 L_p5_3
  s_cmp_eq_u32 s52, 4
  s_cbranch_scc1 L_p5_4
  s_branch L_p5_e
L_p5_1:
  v_and_b32 v250, 31, v1
  v_lshrrev_b32 v189, 5, v1
  v_mov_b32 v251, v250
  v_bfe_u32 v188, v251, 1, 3
  v_xor_b32 v188, v188, v189
  v_lshlrev_b32 v188, 4, v188
  v_lshl_add_u32 v188, v251, 7, v188
  s_mul_i32 s25, s38, 4096
  v_add_u32 v188, s25, v188
  v_xor_b32 v189, 32, v188
  v_xor_b32 v190, 64, v188
  v_xor_b32 v191, 96, v188
  v_add_u32 v192, 0x10000, v188
  v_add_u32 v193, 0x10000, v189
  v_add_u32 v194, 0x10000, v190
  v_add_u32 v195, 0x10000, v191
  v_bfe_u32 v250, v1, 4, 1
  v_bfe_u32 v251, v1, 1, 1
  v_lshl_add_u32 v250, v250, 1, v251
  v_lshrrev_b32 v251, 5, v1
  v_bfe_u32 v200, v1, 2, 2
  v_lshl_add_u32 v251, v251, 3, v200
  v_lshlrev_b32 v200, 2, v250
  v_xor_b32 v251, v251, v200
  v_lshlrev_b32 v251, 4, v251
  v_lshl_add_u32 v251, v250, 10, v251
  v_and_b32 v250, 1, v1
  v_lshl_add_u32 v251, v250, 3, v251
  s_mul_i32 s25, s39, 8192
  v_add_u32 v200, s25, v251
  v_xor_b32 v201, 64, v200
  v_add_u32 v204, 0x10000, v200
  v_add_u32 v205, 0x10000, v201
  s_lshl_b32 s25, s39, 6
  s_add_u32 s25, s25, s41
  v_lshlrev_b32 v250, 2, v185
  v_add_u32 v250, s25, v250
  v_mul_u32_u24 v250, 5120, v250
  v_lshl_add_u32 v254, v186, 2, v250
  s_branch L_p5_e
L_p5_2:
  v_and_b32 v250, 31, v1
  v_lshrrev_b32 v189, 5, v1
  v_lshlrev_b32 v188, 3, v250
  v_lshl_add_u32 v188, v189, 9, v188
  s_mul_i32 s25, s38, 8192
  v_add_u32 v188, s25, v188
  v_add_u32 v192, 0x10000, v188
  v_add_u32 v196, 0x20000, v188
  v_bfe_u32 v250, v1, 2, 2
  v_lshrrev_b32 v251, 5, v1
  v_lshl_add_u32 v251, v251, 3, v250
  v_lshlrev_b32 v251, 8, v251
  v_bfe_u32 v200, v1, 4, 1
  v_lshl_add_u32 v251, v200, 5, v251
  v_and_b32 v200, 3, v1
  v_lshl_add_u32 v251, v200, 3, v251
  v_lshlrev_b32 v250, 2, v250
  s_mul_i32 s25, s39, 8
  v_xor_b32 v200, s25, v250
  v_lshl_add_u32 v200, v200, 4, v251
  s_add_u32 s25, s25, 4
  v_xor_b32 v201, s25, v250
  v_lshl_add_u32 v201, v201, 4, v251
  v_add_u32 v204, 0x10000, v200
  v_add_u32 v205, 0x10000, v201
  v_add_u32 v208, 0x20000, v200
  v_add_u32 v209, 0x20000, v201
  s_lshl_b32 s25, s38, 6
  s_add_u32 s25, s25, s40
  v_lshrrev_b32 v250, 5, v1
  v_lshlrev_b32 v250, 2, v250
  v_add_u32 v250, s25, v250
  v_mul_u32_u24 v250, 5120, v250
  s_lshl_b32 s25, s39, 6
  s_add_u32 s25, s25, s41
  s_add_u32 s25, s25, 640
  v_and_b32 v251, 31, v1
  v_add_u32 v251, s25, v251
  v_lshl_add_u32 v254, v251, 2, v250
  s_branch L_p5_e
L_p5_3:
L_p5c:
  v_cmp_eq_u32 vcc, -1, v253
  s_nop 1
  s_cbranch_vccz L_p5g
  s_sleep 4
  buffer_load_dword v253, v252, s[12:15], s3 offen sc1
  s_waitcnt vmcnt(0)
  s_branch L_p5c
L_p5g:
  s_lshl_b32 s25, s50, 1
  s_add_u32 s25, s25, s47
  s_lshl_b32 s25, s25, 2
  s_add_u32 s25, s25, s29
  s_lshl_b32 s25, s25, 13
  s_mul_i32 s26, s53, 655360
  s_add_u32 s25, s25, s26
  v_lshlrev_b32 v252, 7, v1
  buffer_load_dword v253, v252, s[8:11], s25 offen sc1
  s_branch L_p5_e
L_p5_4:
  s_add_u32 m0, s35, 32768
  s_add_u32 s25, s37, 0
  buffer_load_dwordx4 v246, s[8:11], s25 offen  lds
  s_add_u32 m0, s35, 33792
  s_add_u32 s25, s37, 5120
  buffer_load_dwordx4 v246, s[8:11], s25 offen  lds
  s_add_u32 m0, s35, 34816
  s_add_u32 s25, s37, 10240
  buffer_load_dwordx4 v246, s[8:11], s25 offen  lds
  s_add_u32 m0, s35, 35840
  s_add_u32 s25, s37, 15360
  buffer_load_dwordx4 v246, s[8:11], s25 offen  lds
  s_add_u32 s37, s37, 81920
  s_cmp_eq_u32 s37, 409600
  s_cselect_b32 s37, 0, s37
  s_add_u32 m0, s35, 49152
  s_add_u32 s25, s37, 0
  buffer_load_dwordx4 v246, s[8:11], s25 offen  lds
  s_add_u32 m0, s35, 50176
  s_add_u32 s25, s37, 5120
  buffer_load_dwordx4 v246, s[8:11], s25 offen  lds
  s_add_u32 m0, s35, 51200
  s_add_u32 s25, s37, 10240
  buffer_load_dwordx4 v246, s[8:11], s25 offen  lds
  s_add_u32 m0, s35, 52224
  s_add_u32 s25, s37, 15360
  buffer_load_dwordx4 v246, s[8:11], s25 offen  lds
  s_add_u32 s37, s37, 81920
  s_cmp_eq_u32 s37, 409600
  s_cselect_b32 s37, 0, s37
L_p5_e:
  v_exp_f32 v96, v96
  v_exp_f32 v97, v97
  v_exp_f32 v98, v98
  v_exp_f32 v99, v99
  v_exp_f32 v100, v100
  v_exp_f32 v101, v101
  v_exp_f32 v102, v102
  v_exp_f32 v103, v103
  v_mfma_f32_32x32x16_bf16 v[128:143], v[24:27], v[88:91], v[128:143]
  v_cvt_pk_bf16_f32 v96, v96, v97
  v_cvt_pk_bf16_f32 v97, v98, v99
  v_cvt_pk_bf16_f32 v98, v100, v101
  v_cvt_pk_bf16_f32 v99, v102, v103
  v_exp_f32 v104, v104
  v_exp_f32 v105, v105
  v_exp_f32 v106, v106
  v_mfma_f32_32x32x16_bf16 v[144:159], v[20:23], v[96:99], v[144:159]
  v_exp_f32 v107, v107
  v_exp_f32 v108, v108
  v_exp_f32 v109, v109
  v_exp_f32 v110, v110
  v_exp_f32 v111, v111
  v_cvt_pk_bf16_f32 v104, v104, v105
  v_cvt_pk_bf16_f32 v105, v106, v107
  v_cvt_pk_bf16_f32 v106, v108, v109
  v_cvt_pk_bf16_f32 v107, v110, v111
  s_waitcnt lgkmcnt(0)
  s_setprio 2
  v_mfma_f32_32x32x16_bf16 v[144:159], v[24:27], v[104:107], v[144:159]
  v_exp_f32 v48, v48
  v_exp_f32 v49, v49
  s_mov_b64 exec, s[66:67]
  ds_read_b128 v[20:23], v40 offset:1280
  ds_read_b128 v[24:27], v40 offset:1920
  s_mov_b64 exec, -1
  v_exp_f32 v50, v50
  v_exp_f32 v51, v51
  v_exp_f32 v52, v52
  v_mfma_f32_32x32x16_bf16 v[80:95], v[4:7], v[28:31], v[112:127]
  v_exp_f32 v53, v53
  v_exp_f32 v54, v54
  v_exp_f32 v55, v55
  v_cvt_pk_bf16_f32 v48, v48, v49
  v_cvt_pk_bf16_f32 v49, v50, v51
  v_cvt_pk_bf16_f32 v50, v52, v53
  v_cvt_pk_bf16_f32 v51, v54, v55
  v_mfma_f32_32x32x16_bf16 v[96:111], v[4:7], v[32:35], v[112:127]
  v_exp_f32 v56, v56
  v_exp_f32 v57, v57
  v_exp_f32 v58, v58
  v_exp_f32 v59, v59
  v_exp_f32 v60, v60
  v_mfma_f32_32x32x16_bf16 v[128:143], v[12:15], v[48:51], v[128:143]
  v_exp_f32 v61, v61
  v_exp_f32 v62, v62
  v_exp_f32 v63, v63
  v_cvt_pk_bf16_f32 v56, v56, v57
  v_cvt_pk_bf16_f32 v57, v58, v59
  v_cvt_pk_bf16_f32 v58, v60, v61
  v_cvt_pk_bf16_f32 v59, v62, v63
  v_mfma_f32_32x32x4_2b_bf16 v[80:111], v[10:11], v[36:37], v[80:111]
  ds_read_b128 v[4:7], v44 offset:1024
  v_exp_f32 v64, v64
  v_exp_f32 v65, v65
  v_exp_f32 v66, v66
  v_exp_f32 v67, v67
  ds_read2st64_b64 v[8:11], v39 offset0:2 offset1:3
  v_exp_f32 v68, v68
  v_exp_f32 v69, v69
  v_exp_f32 v70, v70
  v_exp_f32 v71, v71
  v_mfma_f32_32x32x16_bf16 v[128:143], v[16:19], v[56:59], v[128:143]
  v_cvt_pk_bf16_f32 v64, v64, v65
  v_cvt_pk_bf16_f32 v65, v66, v67
  v_cvt_pk_bf16_f32 v66, v68, v69
  v_cvt_pk_bf16_f32 v67, v70, v71
  v_exp_f32 v72, v72
  v_exp_f32 v73, v73
  v_exp_f32 v74, v74
  v_mfma_f32_32x32x16_bf16 v[144:159], v[12:15], v[64:67], v[144:159]
  v_exp_f32 v75, v75
  v_exp_f32 v76, v76
  v_exp_f32 v77, v77
  v_exp_f32 v78, v78
  v_exp_f32 v79, v79
  v_cvt_pk_bf16_f32 v72, v72, v73
  v_cvt_pk_bf16_f32 v73, v74, v75
  v_cvt_pk_bf16_f32 v74, v76, v77
  v_cvt_pk_bf16_f32 v75, v78, v79
  s_waitcnt lgkmcnt(0)
  s_setprio 1
  v_mfma_f32_32x32x16_bf16 v[144:159], v[16:19], v[72:75], v[144:159]
  v_exp_f32 v80, v80
  v_exp_f32 v81, v81
  s_mov_b64 exec, s[66:67]
  ds_read_b128 v[12:15], v40 offset:2560
  ds_read_b128 v[16:19], v40 offset:3200
  s_mov_b64 exec, -1
  v_exp_f32 v82, v82
  v_exp_f32 v83, v83
  v_exp_f32 v84, v84
  v_mfma_f32_32x32x16_bf16 v[48:63], v[4:7], v[28:31], v[112:127]
  v_exp_f32 v85, v85
  v_exp_f32 v86, v86
  v_exp_f32 v87, v87
  v_cvt_pk_bf16_f32 v80, v80, v81
  v_cvt_pk_bf16_f32 v81, v82, v83
  v_cvt_pk_bf16_f32 v82, v84, v85
  v_cvt_pk_bf16_f32 v83, v86, v87
  v_mfma_f32_32x32x16_bf16 v[64:79], v[4:7], v[32:35], v[112:127]
  v_exp_f32 v88, v88
  v_exp_f32 v89, v89
  v_exp_f32 v90, v90
  v_exp_f32 v91, v91
  v_exp_f32 v92, v92
  v_mfma_f32_32x32x16_bf16 v[128:143], v[20:23], v[80:83], v[128:143]
  v_exp_f32 v93, v93
  v_exp_f32 v94, v94
  v_exp_f32 v95, v95
  v_cvt_pk_bf16_f32 v88, v88, v89
  v_cvt_pk_bf16_f32 v89, v90, v91
  v_cvt_pk_bf16_f32 v90, v92, v93
  v_cvt_pk_bf16_f32 v91, v94, v95
  v_mfma_f32_32x32x4_2b_bf16 v[48:79], v[8:9], v[36:37], v[48:79]
  ds_read_b128 v[4:7], v44 offset:1536
  s_cmp_eq_u32 s52, 3
  s_cbranch_scc1 L_p55_3
  s_cmp_eq_u32 s52, 4
  s_cbranch_scc1 L_p55_4
  s_branch L_p55_e
L_p55_3:
  s_add_u32 m0, s35, 8192
  s_add_u32 s25, s37, 0
  buffer_load_dwordx4 v246, s[8:11], s25 offen sc1 lds
  s_add_u32 m0, s35, 9216
  s_add_u32 s25, s37, 20480
  buffer_load_dwordx4 v246, s[8:11], s25 offen sc1 lds
  s_add_u32 m0, s35, 10240
  s_add_u32 s25, s37, 40960
  buffer_load_dwordx4 v246, s[8:11], s25 offen sc1 lds
  s_add_u32 m0, s35, 11264
  s_add_u32 s25, s37, 61440
  buffer_load_dwordx4 v246, s[8:11], s25 offen sc1 lds
  s_add_u32 s37, s37, 1024
  s_cmp_eq_u32 s37, 20480
  s_cselect_b32 s37, 0, s37
  s_add_u32 m0, s35, 32768
  s_add_u32 s25, s37, 0
  buffer_load_dwordx4 v246, s[8:11], s25 offen sc1 lds
  s_add_u32 m0, s35, 33792
  s_add_u32 s25, s37, 20480
  buffer_load_dwordx4 v246, s[8:11], s25 offen sc1 lds
  s_add_u32 m0, s35, 34816
  s_add_u32 s25, s37, 40960
  buffer_load_dwordx4 v246, s[8:11], s25 offen sc1 lds
  s_add_u32 m0, s35, 35840
  s_add_u32 s25, s37, 61440
  buffer_load_dwordx4 v246, s[8:11], s25 offen sc1 lds
  s_add_u32 s37, s37, 1024
  s_cmp_eq_u32 s37, 20480
  s_cselect_b32 s37, 0, s37
  s_branch L_p55_e
L_p55_4:
  s_add_u32 m0, s35, 65536
  s_add_u32 s25, s37, 0
  buffer_load_dwordx4 v246, s[8:11], s25 offen  lds
  s_add_u32 m0, s35, 66560
  s_add_u32 s25, s37, 5120
  buffer_load_dwordx4 v246, s[8:11], s25 offen  lds
  s_add_u32 m0, s35, 67584
  s_add_u32 s25, s37, 10240
  buffer_load_dwordx4 v246, s[8:11], s25 offen  lds
  s_add_u32 m0, s35, 68608
  s_add_u32 s25, s37, 15360
  buffer_load_dwordx4 v246, s[8:11], s25 offen  lds
  s_add_u32 s37, s37, 81920
  s_cmp_eq_u32 s37, 409600
  s_cselect_b32 s37, 0, s37
L_p55_e:
  v_exp_f32 v96, v96
  v_exp_f32 v97, v97
  v_exp_f32 v98, v98
  v_exp_f32 v99, v99
  v_exp_f32 v100, v100
  v_exp_f32 v101, v101
  v_exp_f32 v102, v102
  v_exp_f32 v103, v103
  v_mfma_f32_32x32x16_bf16 v[128:143], v[24:27], v[88:91], v[128:143]
  v_cvt_pk_bf16_f32 v96, v96, v97
  v_cvt_pk_bf16_f32 v97, v98, v99
  v_cvt_pk_bf16_f32 v98, v100, v101
  v_cvt_pk_bf16_f32 v99, v102, v103
  v_exp_f32 v104, v104
  v_exp_f32 v105, v105
  v_exp_f32 v106, v106
  v_mfma_f32_32x32x16_bf16 v[144:159], v[20:23], v[96:99], v[144:159]
  v_exp_f32 v107, v107
  v_exp_f32 v108, v108
  v_exp_f32 v109, v109
  v_exp_f32 v110, v110
  v_exp_f32 v111, v111
  v_cvt_pk_bf16_f32 v104, v104, v105
  v_cvt_pk_bf16_f32 v105, v106, v107
  v_cvt_pk_bf16_f32 v106, v108, v109
  v_cvt_pk_bf16_f32 v107, v110, v111
  s_waitcnt lgkmcnt(0)
  s_setprio 0
  v_mfma_f32_32x32x16_bf16 v[144:159], v[24:27], v[104:107], v[144:159]
  v_exp_f32 v48, v48
  v_exp_f32 v49, v49
  s_mov_b64 exec, s[66:67]
  ds_read_b128 v[20:23], v40 offset:3840
  ds_read_b128 v[24:27], v40 offset:4480
  s_mov_b64 exec, -1
  v_exp_f32 v50, v50
  v_exp_f32 v51, v51
  v_exp_f32 v52, v52
  v_mfma_f32_32x32x16_bf16 v[80:95], v[4:7], v[28:31], v[112:127]
  v_exp_f32 v53, v53
  v_exp_f32 v54, v54
  v_exp_f32 v55, v55
  v_cvt_pk_bf16_f32 v48, v48, v49
  v_cvt_pk_bf16_f32 v49, v50, v51
  v_cvt_pk_bf16_f32 v50, v52, v53
  v_cvt_pk_bf16_f32 v51, v54, v55
  v_mfma_f32_32x32x16_bf16 v[96:111], v[4:7], v[32:35], v[112:127]
  v_exp_f32 v56, v56
  v_exp_f32 v57, v57
  v_exp_f32 v58, v58
  v_exp_f32 v59, v59
  v_exp_f32 v60, v60
  v_mfma_f32_32x32x16_bf16 v[128:143], v[12:15], v[48:51], v[128:143]
  v_exp_f32 v61, v61
  v_exp_f32 v62, v62
  v_exp_f32 v63, v63
  v_cvt_pk_bf16_f32 v56, v56, v57
  v_cvt_pk_bf16_f32 v57, v58, v59
  v_cvt_pk_bf16_f32 v58, v60, v61
  v_cvt_pk_bf16_f32 v59, v62, v63
  v_mfma_f32_32x32x4_2b_bf16 v[80:111], v[10:11], v[36:37], v[80:111]
  s_waitcnt vmcnt(0)
  s_barrier
  s_setprio 3
  ds_read_b128 v[4:7], v44 offset:11264
  v_exp_f32 v64, v64
  v_exp_f32 v65, v65
  v_exp_f32 v66, v66
  v_exp_f32 v67, v67
  ds_read2st64_b64 v[8:11], v39 offset0:22 offset1:23
  v_exp_f32 v68, v68
  v_exp_f32 v69, v69
  v_exp_f32 v70, v70
  v_exp_f32 v71, v71
  v_mfma_f32_32x32x16_bf16 v[128:143], v[16:19], v[56:59], v[128:143]
  v_cvt_pk_bf16_f32 v64, v64, v65
  v_cvt_pk_bf16_f32 v65, v66, v67
  v_cvt_pk_bf16_f32 v66, v68, v69
  v_cvt_pk_bf16_f32 v67, v70, v71
  v_exp_f32 v72, v72
  v_exp_f32 v73, v73
  v_exp_f32 v74, v74
  v_mfma_f32_32x32x16_bf16 v[144:159], v[12:15], v[64:67], v[144:159]
  v_exp_f32 v75, v75
  v_exp_f32 v76, v76
  v_exp_f32 v77, v77
  v_exp_f32 v78, v78
  v_exp_f32 v79, v79
  v_cvt_pk_bf16_f32 v72, v72, v73
  v_cvt_pk_bf16_f32 v73, v74, v75
  v_cvt_pk_bf16_f32 v74, v76, v77
  v_cvt_pk_bf16_f32 v75, v78, v79
  s_waitcnt lgkmcnt(0)
  s_nop 0
  v_mfma_f32_32x32x16_bf16 v[144:159], v[16:19], v[72:75], v[144:159]
  v_exp_f32 v80, v80
  v_exp_f32 v81, v81
  s_mov_b64 exec, s[66:67]
  ds_read_b128 v[12:15], v40 offset:11264
  ds_read_b128 v[16:19], v40 offset:11904
  s_mov_b64 exec, -1
  v_exp_f32 v82, v82
  v_exp_f32 v83, v83
  v_exp_f32 v84, v84
  v_mfma_f32_32x32x16_bf16 v[48:63], v[4:7], v[28:31], v[112:127]
  v_exp_f32 v85, v85
  v_exp_f32 v86, v86
  v_exp_f32 v87, v87
  v_cvt_pk_bf16_f32 v80, v80, v81
  v_cvt_pk_bf16_f32 v81, v82, v83
  v_cvt_pk_bf16_f32 v82, v84, v85
  v_cvt_pk_bf16_f32 v83, v86, v87
  v_mfma_f32_32x32x16_bf16 v[64:79], v[4:7], v[32:35], v[112:127]
  v_exp_f32 v88, v88
  v_exp_f32 v89, v89
  v_exp_f32 v90, v90
  v_exp_f32 v91, v91
  v_exp_f32 v92, v92
  v_mfma_f32_32x32x16_bf16 v[128:143], v[20:23], v[80:83], v[128:143]
  v_exp_f32 v93, v93
  v_exp_f32 v94, v94
  v_exp_f32 v95, v95
  v_cvt_pk_bf16_f32 v88, v88, v89
  v_cvt_pk_bf16_f32 v89, v90, v91
  v_cvt_pk_bf16_f32 v90, v92, v93
  v_cvt_pk_bf16_f32 v91, v94, v95
  v_mfma_f32_32x32x4_2b_bf16 v[48:79], v[8:9], v[36:37], v[48:79]
  ds_read_b128 v[4:7], v44 offset:11776
  s_cmp_eq_u32 s52, 1
  s_cbranch_scc1 L_p6_1
  s_cmp_eq_u32 s52, 3
  s_cbranch_scc1 L_p6_3
  s_cmp_eq_u32 s52, 4
  s_cbranch_scc1 L_p6_4
  s_branch L_p6_e
L_p6_1:
  v_and_b32 v250, 31, v1
  v_and_b32 v251, 1, v1
  v_lshlrev_b32 v251, 4, v251
  v_lshlrev_b32 v184, v251, v184
  v_lshrrev_b32 v250, 1, v250
  v_lshlrev_b32 v251, 2, v185
  v_sub_u32 v250, v250, v251
  v_cmp_eq_u32 vcc, 0, v250
  s_nop 1
  v_cndmask_b32 v160, 0, v184, vcc
  v_cmp_eq_u32 vcc, 1, v250
  s_nop 1
  v_cndmask_b32 v161, 0, v184, vcc
  v_cmp_eq_u32 vcc, 2, v250
  s_nop 1
  v_cndmask_b32 v162, 0, v184, vcc
  v_cmp_eq_u32 vcc, 3, v250
  s_nop 1
  v_cndmask_b32 v163, 0, v184, vcc
  v_cmp_eq_u32 vcc, 8, v250
  s_nop 1
  v_cndmask_b32 v164, 0, v184, vcc
  v_cmp_eq_u32 vcc, 9, v250
  s_nop 1
  v_cndmask_b32 v165, 0, v184, vcc
  v_cmp_eq_u32 vcc, 10, v250
  s_nop 1
  v_cndmask_b32 v166, 0, v184, vcc
  v_cmp_eq_u32 vcc, 11, v250
  s_nop 1
  v_cndmask_b32 v167, 0, v184, vcc
  v_mfma_f32_32x32x16_bf16 v[212:227], v[168:171], v[160:163], 0
  s_nop 0
  v_mfma_f32_32x32x16_bf16 v[212:227], v[172:175], v[164:167], v[212:227]
  v_mfma_f32_32x32x16_bf16 v[228:243], v[176:179], v[160:163], 0
  v_mfma_f32_32x32x16_bf16 v[228:243], v[180:183], v[164:167], v[228:243]
  s_branch L_p6_e
L_p6_3:
  s_add_u32 m0, s35, 57344
  s_add_u32 s25, s37, 0
  buffer_load_dwordx4 v246, s[8:11], s25 offen sc1 lds
  s_add_u32 m0, s35, 58368
  s_add_u32 s25, s37, 20480
  buffer_load_dwordx4 v246, s[8:11], s25 offen sc1 lds
  s_add_u32 m0, s35, 59392
  s_add_u32 s25, s37, 40960
  buffer_load_dwordx4 v246, s[8:11], s25 offen sc1 lds
  s_add_u32 m0, s35, 60416
  s_add_u32 s25, s37, 61440
  buffer_load_dwordx4 v246, s[8:11], s25 offen sc1 lds
  s_add_u32 s37, s37, 1024
  s_cmp_eq_u32 s37, 20480
  s_cselect_b32 s37, 0, s37
  s_branch L_p6_e
L_p6_4:
  v_and_b32 v252, 15, v1
  v_lshlrev_b32 v252, 2, v252
  s_mul_i32 s3, s53, 10
  s_lshl_b32 s25, s50, 1
  s_add_u32 s3, s3, s25
  s_add_u32 s3, s3, s47
  s_lshl_b32 s3, s3, 7
  s_add_u32 s3, s3, 15777792
L_p6_e:
  v_exp_f32 v96, v96
  v_exp_f32 v97, v97
  v_exp_f32 v98, v98
  v_exp_f32 v99, v99
  v_exp_f32 v100, v100
  v_exp_f32 v101, v101
  v_exp_f32 v102, v102
  v_exp_f32 v103, v103
  v_mfma_f32_32x32x16_bf16 v[128:143], v[24:27], v[88:91], v[128:143]
  v_cvt_pk_bf16_f32 v96, v96, v97
  v_cvt_pk_bf16_f32 v97, v98, v99
  v_cvt_pk_bf16_f32 v98, v100, v101
  v_cvt_pk_bf16_f32 v99, v102, v103
  v_exp_f32 v104, v104
  v_exp_f32 v105, v105
  v_exp_f32 v106, v106
  v_mfma_f32_32x32x16_bf16 v[144:159], v[20:23], v[96:99], v[144:159]
  v_exp_f32 v107, v107
  v_exp_f32 v108, v108
  v_exp_f32 v109, v109
  v_exp_f32 v110, v110
  v_exp_f32 v111, v111
  v_cvt_pk_bf16_f32 v104, v104, v105
  v_cvt_pk_bf16_f32 v105, v106, v107
  v_cvt_pk_bf16_f32 v106, v108, v109
  v_cvt_pk_bf16_f32 v107, v110, v111
  s_waitcnt lgkmcnt(0)
  s_nop 0
  v_mfma_f32_32x32x16_bf16 v[144:159], v[24:27], v[104:107], v[144:159]
  v_exp_f32 v48, v48
  v_exp_f32 v49, v49
  s_mov_b64 exec, s[66:67]
  ds_read_b128 v[20:23], v40 offset:12544
  ds_read_b128 v[24:27], v40 offset:13184
  s_mov_b64 exec, -1
  v_exp_f32 v50, v50
  v_exp_f32 v51, v51
  v_exp_f32 v52, v52
  v_mfma_f32_32x32x16_bf16 v[80:95], v[4:7], v[28:31], v[112:127]
  v_exp_f32 v53, v53
  v_exp_f32 v54, v54
  v_exp_f32 v55, v55
  v_cvt_pk_bf16_f32 v48, v48, v49
  v_cvt_pk_bf16_f32 v49, v50, v51
  v_cvt_pk_bf16_f32 v50, v52, v53
  v_cvt_pk_bf16_f32 v51, v54, v55
  v_mfma_f32_32x32x16_bf16 v[96:111], v[4:7], v[32:35], v[112:127]
  v_exp_f32 v56, v56
  v_exp_f32 v57, v57
  v_exp_f32 v58, v58
  v_exp_f32 v59, v59
  v_exp_f32 v60, v60
  v_mfma_f32_32x32x16_bf16 v[128:143], v[12:15], v[48:51], v[128:143]
  v_exp_f32 v61, v61
  v_exp_f32 v62, v62
  v_exp_f32 v63, v63
  v_cvt_pk_bf16_f32 v56, v56, v57
  v_cvt_pk_bf16_f32 v57, v58, v59
  v_cvt_pk_bf16_f32 v58, v60, v61
  v_cvt_pk_bf16_f32 v59, v62, v63
  v_mfma_f32_32x32x4_2b_bf16 v[80:111], v[10:11], v[36:37], v[80:111]
  ds_read_b128 v[4:7], v44 offset:12288
  v_exp_f32 v64, v64
  v_exp_f32 v65, v65
  v_exp_f32 v66, v66
  v_exp_f32 v67, v67
  ds_read2st64_b64 v[8:11], v39 offset0:24 offset1:25
  v_exp_f32 v68, v68
  v_exp_f32 v69, v69
  v_exp_f32 v70, v70
  v_exp_f32 v71, v71
  v_mfma_f32_32x32x16_bf16 v[128:143], v[16:19], v[56:59], v[128:143]
  v_cvt_pk_bf16_f32 v64, v64, v65
  v_cvt_pk_bf16_f32 v65, v66, v67
  v_cvt_pk_bf16_f32 v66, v68, v69
  v_cvt_pk_bf16_f32 v67, v70, v71
  v_exp_f32 v72, v72
  v_exp_f32 v73, v73
  v_exp_f32 v74, v74
  v_mfma_f32_32x32x16_bf16 v[144:159], v[12:15], v[64:67], v[144:159]
  v_exp_f32 v75, v75
  v_exp_f32 v76, v76
  v_exp_f32 v77, v77
  v_exp_f32 v78, v78
  v_exp_f32 v79, v79
  v_cvt_pk_bf16_f32 v72, v72, v73
  v_cvt_pk_bf16_f32 v73, v74, v75
  v_cvt_pk_bf16_f32 v74, v76, v77
  v_cvt_pk_bf16_f32 v75, v78, v79
  s_waitcnt lgkmcnt(0)
  s_setprio 2
  v_mfma_f32_32x32x16_bf16 v[144:159], v[16:19], v[72:75], v[144:159]
  v_exp_f32 v80, v80
  v_exp_f32 v81, v81
  s_mov_b64 exec, s[66:67]
  ds_read_b128 v[12:15], v40 offset:13824
  ds_read_b128 v[16:19], v40 offset:14464
  s_mov_b64 exec, -1
  v_exp_f32 v82, v82
  v_exp_f32 v83, v83
  v_exp_f32 v84, v84
  v_mfma_f32_32x32x16_bf16 v[48:63], v[4:7], v[28:31], v[112:127]
  v_exp_f32 v85, v85
  v_exp_f32 v86, v86
  v_exp_f32 v87, v87
  v_cvt_pk_bf16_f32 v80, v80, v81
  v_cvt_pk_bf16_f32 v81, v82, v83
  v_cvt_pk_bf16_f32 v82, v84, v85
  v_cvt_pk_bf16_f32 v83, v86, v87
  v_mfma_f32_32x32x16_bf16 v[64:79], v[4:7], v[32:35], v[112:127]
  v_exp_f32 v88, v88
  v_exp_f32 v89, v89
  v_exp_f32 v90, v90
  v_exp_f32 v91, v91
  v_exp_f32 v92, v92
  v_mfma_f32_32x32x16_bf16 v[128:143], v[20:23], v[80:83], v[128:143]
  v_exp_f32 v93, v93
  v_exp_f32 v94, v94
  v_exp_f32 v95, v95
  v_cvt_pk_bf16_f32 v88, v88, v89
  v_cvt_pk_bf16_f32 v89, v90, v91
  v_cvt_pk_bf16_f32 v90, v92, v93
  v_cvt_pk_bf16_f32 v91, v94, v95
  v_mfma_f32_32x32x4_2b_bf16 v[48:79], v[8:9], v[36:37], v[48:79]
  ds_read_b128 v[4:7], v44 offset:12800
  s_cmp_eq_u32 s52, 3
  s_cbranch_scc1 L_p65_3
  s_cmp_eq_u32 s52, 4
  s_cbranch_scc1 L_p65_4
  s_branch L_p65_e
L_p65_3:
  s_branch L_p65_e
L_p65_4:
L_p65_e:
  v_exp_f32 v96, v96
  v_exp_f32 v97, v97
  v_exp_f32 v98, v98
  v_exp_f32 v99, v99
  v_exp_f32 v100, v100
  v_exp_f32 v101, v101
  v_exp_f32 v102, v102
  v_exp_f32 v103, v103
  v_mfma_f32_32x32x16_bf16 v[128:143], v[24:27], v[88:91], v[128:143]
  v_cvt_pk_bf16_f32 v96, v96, v97
  v_cvt_pk_bf16_f32 v97, v98, v99
  v_cvt_pk_bf16_f32 v98, v100, v101
  v_cvt_pk_bf16_f32 v99, v102, v103
  v_exp_f32 v104, v104
  v_exp_f32 v105, v105
  v_exp_f32 v106, v106
  v_mfma_f32_32x32x16_bf16 v[144:159], v[20:23], v[96:99], v[144:159]
  v_exp_f32 v107, v107
  v_exp_f32 v108, v108
  v_exp_f32 v109, v109
  v_exp_f32 v110, v110
  v_exp_f32 v111, v111
  v_cvt_pk_bf16_f32 v104, v104, v105
  v_cvt_pk_bf16_f32 v105, v106, v107
  v_cvt_pk_bf16_f32 v106, v108, v109
  v_cvt_pk_bf16_f32 v107, v110, v111
  s_waitcnt lgkmcnt(0)
  s_nop 0
  v_mfma_f32_32x32x16_bf16 v[144:159], v[24:27], v[104:107], v[144:159]
  v_exp_f32 v48, v48
  v_exp_f32 v49, v49
  s_mov_b64 exec, s[66:67]
  ds_read_b128 v[20:23], v40 offset:15104
  ds_read_b128 v[24:27], v40 offset:15744
  s_mov_b64 exec, -1
  v_exp_f32 v50, v50
  v_exp_f32 v51, v51
  v_exp_f32 v52, v52
  v_mfma_f32_32x32x16_bf16 v[80:95], v[4:7], v[28:31], v[112:127]
  v_exp_f32 v53, v53
  v_exp_f32 v54, v54
  v_exp_f32 v55, v55
  v_cvt_pk_bf16_f32 v48, v48, v49
  v_cvt_pk_bf16_f32 v49, v50, v51
  v_cvt_pk_bf16_f32 v50, v52, v53
  v_cvt_pk_bf16_f32 v51, v54, v55
  v_mfma_f32_32x32x16_bf16 v[96:111], v[4:7], v[32:35], v[112:127]
  v_exp_f32 v56, v56
  v_exp_f32 v57, v57
  v_exp_f32 v58, v58
  v_exp_f32 v59, v59
  v_exp_f32 v60, v60
  v_mfma_f32_32x32x16_bf16 v[128:143], v[12:15], v[48:51], v[128:143]
  v_exp_f32 v61, v61
  v_exp_f32 v62, v62
  v_exp_f32 v63, v63
  v_cvt_pk_bf16_f32 v56, v56, v57
  v_cvt_pk_bf16_f32 v57, v58, v59
  v_cvt_pk_bf16_f32 v58, v60, v61
  v_cvt_pk_bf16_f32 v59, v62, v63
  v_mfma_f32_32x32x4_2b_bf16 v[80:111], v[10:11], v[36:37], v[80:111]
  s_setprio 1
  v_exp_f32 v64, v64
  v_exp_f32 v65, v65
  v_exp_f32 v66, v66
  v_exp_f32 v67, v67
  v_exp_f32 v68, v68
  v_exp_f32 v69, v69
  v_exp_f32 v70, v70
  v_exp_f32 v71, v71
  v_mfma_f32_32x32x16_bf16 v[128:143], v[16:19], v[56:59], v[128:143]
  v_cvt_pk_bf16_f32 v64, v64, v65
  v_cvt_pk_bf16_f32 v65, v66, v67
  v_cvt_pk_bf16_f32 v66, v68, v69
  v_cvt_pk_bf16_f32 v67, v70, v71
  v_exp_f32 v72, v72
  v_exp_f32 v73, v73
  v_exp_f32 v74, v74
  v_mfma_f32_32x32x16_bf16 v[144:159], v[12:15], v[64:67], v[144:159]
  v_exp_f32 v75, v75
  v_exp_f32 v76, v76
  v_exp_f32 v77, v77
  v_exp_f32 v78, v78
  v_exp_f32 v79, v79
  v_cvt_pk_bf16_f32 v72, v72, v73
  v_cvt_pk_bf16_f32 v73, v74, v75
  v_cvt_pk_bf16_f32 v74, v76, v77
  v_cvt_pk_bf16_f32 v75, v78, v79
  s_waitcnt lgkmcnt(0)
  s_nop 0
  v_mfma_f32_32x32x16_bf16 v[144:159], v[16:19], v[72:75], v[144:159]
  v_exp_f32 v80, v80
  v_exp_f32 v81, v81
  v_exp_f32 v82, v82
  v_exp_f32 v83, v83
  v_exp_f32 v84, v84
  v_exp_f32 v85, v85
  v_exp_f32 v86, v86
  v_exp_f32 v87, v87
  v_cvt_pk_bf16_f32 v80, v80, v81
  v_cvt_pk_bf16_f32 v81, v82, v83
  v_cvt_pk_bf16_f32 v82, v84, v85
  v_cvt_pk_bf16_f32 v83, v86, v87
  v_exp_f32 v88, v88
  v_exp_f32 v89, v89
  v_exp_f32 v90, v90
  v_exp_f32 v91, v91
  v_exp_f32 v92, v92
  v_mfma_f32_32x32x16_bf16 v[128:143], v[20:23], v[80:83], v[128:143]
  v_exp_f32 v93, v93
  v_exp_f32 v94, v94
  v_exp_f32 v95, v95
  v_cvt_pk_bf16_f32 v88, v88, v89
  v_cvt_pk_bf16_f32 v89, v90, v91
  v_cvt_pk_bf16_f32 v90, v92, v93
  v_cvt_pk_bf16_f32 v91, v94, v95
  s_setprio 0
  v_exp_f32 v96, v96
  v_exp_f32 v97, v97
  v_exp_f32 v98, v98
  v_exp_f32 v99, v99
  v_exp_f32 v100, v100
  v_exp_f32 v101, v101
  v_exp_f32 v102, v102
  v_exp_f32 v103, v103
  v_mfma_f32_32x32x16_bf16 v[128:143], v[24:27], v[88:91], v[128:143]
  v_cvt_pk_bf16_f32 v96, v96, v97
  v_cvt_pk_bf16_f32 v97, v98, v99
  v_cvt_pk_bf16_f32 v98, v100, v101
  v_cvt_pk_bf16_f32 v99, v102, v103
  v_exp_f32 v104, v104
  v_exp_f32 v105, v105
  v_exp_f32 v106, v106
  v_mfma_f32_32x32x16_bf16 v[144:159], v[20:23], v[96:99], v[144:159]
  v_exp_f32 v107, v107
  v_exp_f32 v108, v108
  v_exp_f32 v109, v109
  v_exp_f32 v110, v110
  v_exp_f32 v111, v111
  v_cvt_pk_bf16_f32 v104, v104, v105
  v_cvt_pk_bf16_f32 v105, v106, v107
  v_cvt_pk_bf16_f32 v106, v108, v109
  v_cvt_pk_bf16_f32 v107, v110, v111
  s_waitcnt lgkmcnt(0)
  s_nop 0
  v_mfma_f32_32x32x16_bf16 v[144:159], v[24:27], v[104:107], v[144:159]
  v_pk_add_f32 v[2:3], v[128:129], v[130:131]
  v_pk_add_f32 v[2:3], v[2:3], v[132:133]
  v_pk_add_f32 v[2:3], v[2:3], v[134:135]
  v_pk_add_f32 v[2:3], v[2:3], v[136:137]
  v_pk_add_f32 v[2:3], v[2:3], v[138:139]
  s_nop 6
  v_pk_add_f32 v[2:3], v[2:3], v[144:145]
  v_pk_add_f32 v[2:3], v[2:3], v[146:147]
  v_pk_add_f32 v[2:3], v[2:3], v[148:149]
  v_pk_add_f32 v[2:3], v[2:3], v[150:151]
  v_pk_add_f32 v[2:3], v[2:3], v[152:153]
  v_pk_add_f32 v[2:3], v[2:3], v[154:155]
  v_min_f32 v4, v140, v156
  v_add_f32 v5, v140, v156
  v_add_f32 v2, v2, v3
  v_cmp_ngt_f32 vcc, 0x71800000, v5
  v_mov_b32 v3, 0x207
  v_cmp_class_f32 s[70:71], v2, v3
  s_nop 0
  s_or_b64 s[70:71], vcc, s[70:71]
  v_cmp_nlt_f32 vcc, 0x21800000, v4
  s_nop 0
  s_or_b64 vcc, vcc, s[70:71]
  s_cbranch_vccnz L_at_slow
L_at_fin:
  s_barrier
  s_lshl_b32 s25, s20, 12
  s_add_u32 s25, s25, 131072
  s_xor_b32 s27, s25, 0x4000
  v_add_u32 v2, s25, v38
  s_cmp_eq_u32 s23, 0
  s_cbranch_scc1 L_at_h0
  v_mov_b32 v141, v41
  ds_write_b128 v2, v[128:131] offset:0
  ds_write_b128 v2, v[132:135] offset:1024
  ds_write_b128 v2, v[136:139] offset:2048
  ds_write_b64 v2, v[140:141] offset:3072
  s_nop 1
  v_mov_b32 v128, v144
  v_mov_b32 v129, v145
  v_mov_b32 v130, v146
  v_mov_b32 v131, v147
  v_mov_b32 v132, v148
  v_mov_b32 v133, v149
  v_mov_b32 v134, v150
  v_mov_b32 v135, v151
  v_mov_b32 v136, v152
  v_mov_b32 v137, v153
  v_mov_b32 v138, v154
  v_mov_b32 v139, v155
  v_mov_b32 v140, v156
  v_mov_b32 v41, v42
  s_branch L_at_h
L_at_h0:
  v_mov_b32 v157, v42
  ds_write_b128 v2, v[144:147] offset:0
  ds_write_b128 v2, v[148:151] offset:1024
  ds_write_b128 v2, v[152:155] offset:2048
  ds_write_b64 v2, v[156:157] offset:3072
L_at_h:
  v_add_u32 v2, s27, v38
  s_cmp_eq_u32 s52, 3
  s_cbranch_scc1 L_p8_3
  s_cmp_eq_u32 s52, 4
  s_cbranch_scc1 L_p8_4
  s_branch L_p8_e
L_p8_3:
  s_add_u32 m0, s34, 73728
  s_add_u32 s25, s36, 0
  buffer_load_dwordx4 v244, s[4:7], s25 offen  lds
  s_add_u32 m0, s34, 74752
  s_add_u32 s25, s36, 10240
  buffer_load_dwordx4 v245, s[4:7], s25 offen  lds
  s_add_u32 s36, s36, 128
  s_xor_b32 s25, s16, s18
  s_xor_b32 s26, s17, s19
  s_cmp_eq_u32 s36, 1280
  s_cselect_b32 s36, 0, s36
  s_cselect_b32 s25, s25, 0
  s_cselect_b32 s26, s26, 0
  s_xor_b32 s4, s4, s25
  s_xor_b32 s5, s5, s26
  s_add_u32 m0, s35, 81920
  s_add_u32 s25, s37, 0
  buffer_load_dwordx4 v246, s[8:11], s25 offen sc1 lds
  s_add_u32 m0, s35, 82944
  s_add_u32 s25, s37, 20480
  buffer_load_dwordx4 v246, s[8:11], s25 offen sc1 lds
  s_add_u32 m0, s35, 83968
  s_add_u32 s25, s37, 40960
  buffer_load_dwordx4 v246, s[8:11], s25 offen sc1 lds
  s_add_u32 m0, s35, 84992
  s_add_u32 s25, s37, 61440
  buffer_load_dwordx4 v246, s[8:11], s25 offen sc1 lds
  s_add_u32 s37, s37, 1024
  s_cmp_eq_u32 s37, 20480
  s_cselect_b32 s37, 0, s37
  s_branch L_p8_e
L_p8_4:
  buffer_load_dword v253, v252, s[12:15], s3 offen sc1
L_p8_e:
  s_waitcnt lgkmcnt(0)
  s_barrier
  ds_read_b64 v[60:61], v2 offset:3072
  ds_read_b128 v[48:51], v2 offset:0
  ds_read_b128 v[52:55], v2 offset:1024
  ds_read_b128 v[56:59], v2 offset:2048
  s_lshl_b32 s25, s31, 3
  s_lshl_b32 s26, s22, 1
  s_add_u32 s25, s25, s26
  s_add_u32 s25, s25, s23
  s_mul_i32 s25, s25, 40960
  s_mul_i32 s26, s30, 1280
  s_add_u32 s25, s25, s26
  s_add_u32 s25, s25, 7864320
  v_lshlrev_b32 v3, 3, v1
  s_waitcnt lgkmcnt(3)
  v_max_f32 v2, v41, v61
  v_sub_f32 v4, v41, v2
  v_sub_f32 v5, v61, v2
  v_exp_f32 v4, v4
  v_exp_f32 v5, v5
  s_nop 0
  v_mul_f32 v2, v4, v140
  v_fma_f32 v2, v5, v60, v2
  v_rcp_f32 v2, v2
  s_nop 0
  v_mul_f32 v4, v4, v2
  v_mul_f32 v5, v5, v2
  s_waitcnt lgkmcnt(0)
  v_mul_f32 v48, v5, v48
  v_fma_f32 v48, v4, v128, v48
  v_mul_f32 v49, v5, v49
  v_fma_f32 v49, v4, v129, v49
  v_mul_f32 v50, v5, v50
  v_fma_f32 v50, v4, v130, v50
  v_mul_f32 v51, v5, v51
  v_fma_f32 v51, v4, v131, v51
  v_mul_f32 v52, v5, v52
  v_fma_f32 v52, v4, v132, v52
  v_mul_f32 v53, v5, v53
  v_fma_f32 v53, v4, v133, v53
  v_mul_f32 v54, v5, v54
  v_fma_f32 v54, v4, v134, v54
  v_mul_f32 v55, v5, v55
  v_fma_f32 v55, v4, v135, v55
  v_mul_f32 v56, v5, v56
  v_fma_f32 v56, v4, v136, v56
  v_mul_f32 v57, v5, v57
  v_fma_f32 v57, v4, v137, v57
  v_mul_f32 v58, v5, v58
  v_fma_f32 v58, v4, v138, v58
  v_mul_f32 v59, v5, v59
  v_fma_f32 v59, v4, v139, v59
  v_cvt_pk_bf16_f32 v48, v48, v49
  v_cvt_pk_bf16_f32 v49, v50, v51
  v_cvt_pk_bf16_f32 v50, v52, v53
  v_cvt_pk_bf16_f32 v51, v54, v55
  v_cvt_pk_bf16_f32 v52, v56, v57
  v_cvt_pk_bf16_f32 v53, v58, v59
  v_add_u32 v3, s27, v3
  v_add_u32 v2, s27, v38
  ds_write_b64 v3, v[48:49]
  ds_write_b64 v3, v[50:51] offset:512
  ds_write_b64 v3, v[52:53] offset:1024
  ds_read_b128 v[56:59], v2
  ds_read_b128 v[60:63], v2 offset:1024
  s_waitcnt lgkmcnt(1)
  buffer_store_dwordx4 v[56:59], v38, s[12:15], s25 offen sc1
  s_mov_b64 exec, 0xffff
  s_waitcnt lgkmcnt(0)
  buffer_store_dwordx4 v[60:63], v38, s[12:15], s25 offen offset:1024 sc1
  s_mov_b64 exec, -1
  s_branch L_ph3
L_at_slow:
  v_subrev_u32 v45, s24, v44
  v_subrev_u32 v46, s24, v39
  s_add_u32 s25, s24, 6144
  v_subrev_u32 v47, s25, v40
  v_mov_b32 v41, 0xff800000
  v_mov_b32 v42, 0xff800000
  s_mov_b32 s65, 0
L_at_slow_pass:
  s_mov_b32 s68, 0
  s_mov_b32 s74, s72
  s_mov_b32 s75, s73
L_at_slow_loop:
  buffer_load_dwordx4 v[4:7], v45, s[12:15], s74 offen offset:0 sc1
  buffer_load_dwordx2 v[8:9], v46, s[12:15], s74 offen offset:0 sc1
  s_add_u32 s25, s75, 0
  s_mov_b64 exec, s[66:67]
  buffer_load_dwordx4 v[12:15], v47, s[12:15], s25 offen sc1
  buffer_load_dwordx4 v[16:19], v47, s[12:15], s25 offen offset:640 sc1
  s_mov_b64 exec, -1
  s_waitcnt vmcnt(0)
  v_mfma_f32_32x32x16_bf16 v[48:63], v[4:7], v[28:31], 0
  v_mfma_f32_32x32x16_bf16 v[64:79], v[4:7], v[32:35], 0
  s_nop 9
  v_mfma_f32_32x32x4_2b_bf16 v[48:79], v[8:9], v[36:37], v[48:79]
  s_nop 15
  s_nop 3
  s_cmp_lg_u32 s65, 0
  s_cbranch_scc1 L_at_slow_acc0
  v_max3_f32 v41, v41, v48, v49
  v_max3_f32 v41, v41, v50, v51
  v_max3_f32 v41, v41, v52, v53
  v_max3_f32 v41, v41, v54, v55
  v_max3_f32 v41, v41, v56, v57
  v_max3_f32 v41, v41, v58, v59
  v_max3_f32 v41, v41, v60, v61
  v_max3_f32 v41, v41, v62, v63
  v_max3_f32 v42, v42, v64, v65
  v_max3_f32 v42, v42, v66, v67
  v_max3_f32 v42, v42, v68, v69
  v_max3_f32 v42, v42, v70, v71
  v_max3_f32 v42, v42, v72, v73
  v_max3_f32 v42, v42, v74, v75
  v_max3_f32 v42, v42, v76, v77
  v_max3_f32 v42, v42, v78, v79
  s_branch L_at_slow_nx0
L_at_slow_acc0:
  v_sub_f32 v48, v48, v41
  v_sub_f32 v49, v49, v41
  v_sub_f32 v50, v50, v41
  v_sub_f32 v51, v51, v41
  v_sub_f32 v52, v52, v41
  v_sub_f32 v53, v53, v41
  v_sub_f32 v54, v54, v41
  v_sub_f32 v55, v55, v41
  v_sub_f32 v56, v56, v41
  v_sub_f32 v57, v57, v41
  v_sub_f32 v58, v58, v41
  v_sub_f32 v59, v59, v41
  v_sub_f32 v60, v60, v41
  v_sub_f32 v61, v61, v41
  v_sub_f32 v62, v62, v41
  v_sub_f32 v63, v63, v41
  v_sub_f32 v64, v64, v42
  v_sub_f32 v65, v65, v42
  v_sub_f32 v66, v66, v42
  v_sub_f32 v67, v67, v42
  v_sub_f32 v68, v68, v42
  v_sub_f32 v69, v69, v42
  v_sub_f32 v70, v70, v42
  v_sub_f32 v71, v71, v42
  v_sub_f32 v72, v72, v42
  v_sub_f32 v73, v73, v42
  v_sub_f32 v74, v74, v42
  v_sub_f32 v75, v75, v42
  v_sub_f32 v76, v76, v42
  v_sub_f32 v77, v77, v42
  v_sub_f32 v78, v78, v42
  v_sub_f32 v79, v79, v42
  v_exp_f32 v48, v48
  v_exp_f32 v49, v49
  v_exp_f32 v50, v50
  v_exp_f32 v51, v51
  v_exp_f32 v52, v52
  v_exp_f32 v53, v53
  v_exp_f32 v54, v54
  v_exp_f32 v55, v55
  v_exp_f32 v56, v56
  v_exp_f32 v57, v57
  v_exp_f32 v58, v58
  v_exp_f32 v59, v59
  v_exp_f32 v60, v60
  v_exp_f32 v61, v61
  v_exp_f32 v62, v62
  v_exp_f32 v63, v63
  v_exp_f32 v64, v64
  v_exp_f32 v65, v65
  v_exp_f32 v66, v66
  v_exp_f32 v67, v67
  v_exp_f32 v68, v68
  v_exp_f32 v69, v69
  v_exp_f32 v70, v70
  v_exp_f32 v71, v71
  v_exp_f32 v72, v72
  v_exp_f32 v73, v73
  v_exp_f32 v74, v74
  v_exp_f32 v75, v75
  v_exp_f32 v76, v76
  v_exp_f32 v77, v77
  v_exp_f32 v78, v78
  v_exp_f32 v79, v79
  v_cvt_pk_bf16_f32 v48, v48, v49
  v_cvt_pk_bf16_f32 v49, v50, v51
  v_cvt_pk_bf16_f32 v50, v52, v53
  v_cvt_pk_bf16_f32 v51, v54, v55
  v_cvt_pk_bf16_f32 v56, v56, v57
  v_cvt_pk_bf16_f32 v57, v58, v59
  v_cvt_pk_bf16_f32 v58, v60, v61
  v_cvt_pk_bf16_f32 v59, v62, v63
  v_cvt_pk_bf16_f32 v64, v64, v65
  v_cvt_pk_bf16_f32 v65, v66, v67
  v_cvt_pk_bf16_f32 v66, v68, v69
  v_cvt_pk_bf16_f32 v67, v70, v71
  v_cvt_pk_bf16_f32 v72, v72, v73
  v_cvt_pk_bf16_f32 v73, v74, v75
  v_cvt_pk_bf16_f32 v74, v76, v77
  v_cvt_pk_bf16_f32 v75, v78, v79
  v_mfma_f32_32x32x16_bf16 v[128:143], v[12:15], v[48:51], v[128:143]
  v_mfma_f32_32x32x16_bf16 v[128:143], v[16:19], v[56:59], v[128:143]
  v_mfma_f32_32x32x16_bf16 v[144:159], v[12:15], v[64:67], v[144:159]
  v_mfma_f32_32x32x16_bf16 v[144:159], v[16:19], v[72:75], v[144:159]
L_at_slow_nx0:
  buffer_load_dwordx4 v[4:7], v45, s[12:15], s74 offen offset:512 sc1
  buffer_load_dwordx2 v[8:9], v46, s[12:15], s74 offen offset:512 sc1
  s_add_u32 s25, s75, 1280
  s_mov_b64 exec, s[66:67]
  buffer_load_dwordx4 v[12:15], v47, s[12:15], s25 offen sc1
  buffer_load_dwordx4 v[16:19], v47, s[12:15], s25 offen offset:640 sc1
  s_mov_b64 exec, -1
  s_waitcnt vmcnt(0)
  v_mfma_f32_32x32x16_bf16 v[48:63], v[4:7], v[28:31], 0
  v_mfma_f32_32x32x16_bf16 v[64:79], v[4:7], v[32:35], 0
  s_nop 9
  v_mfma_f32_32x32x4_2b_bf16 v[48:79], v[8:9], v[36:37], v[48:79]
  s_nop 15
  s_nop 3
  s_cmp_lg_u32 s65, 0
  s_cbranch_scc1 L_at_slow_acc1
  v_max3_f32 v41, v41, v48, v49
  v_max3_f32 v41, v41, v50, v51
  v_max3_f32 v41, v41, v52, v53
  v_max3_f32 v41, v41, v54, v55
  v_max3_f32 v41, v41, v56, v57
  v_max3_f32 v41, v41, v58, v59
  v_max3_f32 v41, v41, v60, v61
  v_max3_f32 v41, v41, v62, v63
  v_max3_f32 v42, v42, v64, v65
  v_max3_f32 v42, v42, v66, v67
  v_max3_f32 v42, v42, v68, v69
  v_max3_f32 v42, v42, v70, v71
  v_max3_f32 v42, v42, v72, v73
  v_max3_f32 v42, v42, v74, v75
  v_max3_f32 v42, v42, v76, v77
  v_max3_f32 v42, v42, v78, v79
  s_branch L_at_slow_nx1
L_at_slow_acc1:
  v_sub_f32 v48, v48, v41
  v_sub_f32 v49, v49, v41
  v_sub_f32 v50, v50, v41
  v_sub_f32 v51, v51, v41
  v_sub_f32 v52, v52, v41
  v_sub_f32 v53, v53, v41
  v_sub_f32 v54, v54, v41
  v_sub_f32 v55, v55, v41
  v_sub_f32 v56, v56, v41
  v_sub_f32 v57, v57, v41
  v_sub_f32 v58, v58, v41
  v_sub_f32 v59, v59, v41
  v_sub_f32 v60, v60, v41
  v_sub_f32 v61, v61, v41
  v_sub_f32 v62, v62, v41
  v_sub_f32 v63, v63, v41
  v_sub_f32 v64, v64, v42
  v_sub_f32 v65, v65, v42
  v_sub_f32 v66, v66, v42
  v_sub_f32 v67, v67, v42
  v_sub_f32 v68, v68, v42
  v_sub_f32 v69, v69, v42
  v_sub_f32 v70, v70, v42
  v_sub_f32 v71, v71, v42
  v_sub_f32 v72, v72, v42
  v_sub_f32 v73, v73, v42
  v_sub_f32 v74, v74, v42
  v_sub_f32 v75, v75, v42
  v_sub_f32 v76, v76, v42
  v_sub_f32 v77, v77, v42
  v_sub_f32 v78, v78, v42
  v_sub_f32 v79, v79, v42
  v_exp_f32 v48, v48
  v_exp_f32 v49, v49
  v_exp_f32 v50, v50
  v_exp_f32 v51, v51
  v_exp_f32 v52, v52
  v_exp_f32 v53, v53
  v_exp_f32 v54, v54
  v_exp_f32 v55, v55
  v_exp_f32 v56, v56
  v_exp_f32 v57, v57
  v_exp_f32 v58, v58
  v_exp_f32 v59, v59
  v_exp_f32 v60, v60
  v_exp_f32 v61, v61
  v_exp_f32 v62, v62
  v_exp_f32 v63, v63
  v_exp_f32 v64, v64
  v_exp_f32 v65, v65
  v_exp_f32 v66, v66
  v_exp_f32 v67, v67
  v_exp_f32 v68, v68
  v_exp_f32 v69, v69
  v_exp_f32 v70, v70
  v_exp_f32 v71, v71
  v_exp_f32 v72, v72
  v_exp_f32 v73, v73
  v_exp_f32 v74, v74
  v_exp_f32 v75, v75
  v_exp_f32 v76, v76
  v_exp_f32 v77, v77
  v_exp_f32 v78, v78
  v_exp_f32 v79, v79
  v_cvt_pk_bf16_f32 v48, v48, v49
  v_cvt_pk_bf16_f32 v49, v50, v51
  v_cvt_pk_bf16_f32 v50, v52, v53
  v_cvt_pk_bf16_f32 v51, v54, v55
  v_cvt_pk_bf16_f32 v56, v56, v57
  v_cvt_pk_bf16_f32 v57, v58, v59
  v_cvt_pk_bf16_f32 v58, v60, v61
  v_cvt_pk_bf16_f32 v59, v62, v63
  v_cvt_pk_bf16_f32 v64, v64, v65
  v_cvt_pk_bf16_f32 v65, v66, v67
  v_cvt_pk_bf16_f32 v66, v68, v69
  v_cvt_pk_bf16_f32 v67, v70, v71
  v_cvt_pk_bf16_f32 v72, v72, v73
  v_cvt_pk_bf16_f32 v73, v74, v75
  v_cvt_pk_bf16_f32 v74, v76, v77
  v_cvt_pk_bf16_f32 v75, v78, v79
  v_mfma_f32_32x32x16_bf16 v[128:143], v[12:15], v[48:51], v[128:143]
  v_mfma_f32_32x32x16_bf16 v[128:143], v[16:19], v[56:59], v[128:143]
  v_mfma_f32_32x32x16_bf16 v[144:159], v[12:15], v[64:67], v[144:159]
  v_mfma_f32_32x32x16_bf16 v[144:159], v[16:19], v[72:75], v[144:159]
L_at_slow_nx1:
  buffer_load_dwordx4 v[4:7], v45, s[12:15], s74 offen offset:1024 sc1
  buffer_load_dwordx2 v[8:9], v46, s[12:15], s74 offen offset:1024 sc1
  s_add_u32 s25, s75, 2560
  s_mov_b64 exec, s[66:67]
  buffer_load_dwordx4 v[12:15], v47, s[12:15], s25 offen sc1
  buffer_load_dwordx4 v[16:19], v47, s[12:15], s25 offen offset:640 sc1
  s_mov_b64 exec, -1
  s_waitcnt vmcnt(0)
  v_mfma_f32_32x32x16_bf16 v[48:63], v[4:7], v[28:31], 0
  v_mfma_f32_32x32x16_bf16 v[64:79], v[4:7], v[32:35], 0
  s_nop 9
  v_mfma_f32_32x32x4_2b_bf16 v[48:79], v[8:9], v[36:37], v[48:79]
  s_nop 15
  s_nop 3
  s_cmp_lg_u32 s65, 0
  s_cbranch_scc1 L_at_slow_acc2
  v_max3_f32 v41, v41, v48, v49
  v_max3_f32 v41, v41, v50, v51
  v_max3_f32 v41, v41, v52, v53
  v_max3_f32 v41, v41, v54, v55
  v_max3_f32 v41, v41, v56, v57
  v_max3_f32 v41, v41, v58, v59
  v_max3_f32 v41, v41, v60, v61
  v_max3_f32 v41, v41, v62, v63
  v_max3_f32 v42, v42, v64, v65
  v_max3_f32 v42, v42, v66, v67
  v_max3_f32 v42, v42, v68, v69
  v_max3_f32 v42, v42, v70, v71
  v_max3_f32 v42, v42, v72, v73
  v_max3_f32 v42, v42, v74, v75
  v_max3_f32 v42, v42, v76, v77
  v_max3_f32 v42, v42, v78, v79
  s_branch L_at_slow_nx2
L_at_slow_acc2:
  v_sub_f32 v48, v48, v41
  v_sub_f32 v49, v49, v41
  v_sub_f32 v50, v50, v41
  v_sub_f32 v51, v51, v41
  v_sub_f32 v52, v52, v41
  v_sub_f32 v53, v53, v41
  v_sub_f32 v54, v54, v41
  v_sub_f32 v55, v55, v41
  v_sub_f32 v56, v56, v41
  v_sub_f32 v57, v57, v41
  v_sub_f32 v58, v58, v41
  v_sub_f32 v59, v59, v41
  v_sub_f32 v60, v60, v41
  v_sub_f32 v61, v61, v41
  v_sub_f32 v62, v62, v41
  v_sub_f32 v63, v63, v41
  v_sub_f32 v64, v64, v42
  v_sub_f32 v65, v65, v42
  v_sub_f32 v66, v66, v42
  v_sub_f32 v67, v67, v42
  v_sub_f32 v68, v68, v42
  v_sub_f32 v69, v69, v42
  v_sub_f32 v70, v70, v42
  v_sub_f32 v71, v71, v42
  v_sub_f32 v72, v72, v42
  v_sub_f32 v73, v73, v42
  v_sub_f32 v74, v74, v42
  v_sub_f32 v75, v75, v42
  v_sub_f32 v76, v76, v42
  v_sub_f32 v77, v77, v42
  v_sub_f32 v78, v78, v42
  v_sub_f32 v79, v79, v42
  v_exp_f32 v48, v48
  v_exp_f32 v49, v49
  v_exp_f32 v50, v50
  v_exp_f32 v51, v51
  v_exp_f32 v52, v52
  v_exp_f32 v53, v53
  v_exp_f32 v54, v54
  v_exp_f32 v55, v55
  v_exp_f32 v56, v56
  v_exp_f32 v57, v57
  v_exp_f32 v58, v58
  v_exp_f32 v59, v59
  v_exp_f32 v60, v60
  v_exp_f32 v61, v61
  v_exp_f32 v62, v62
  v_exp_f32 v63, v63
  v_exp_f32 v64, v64
  v_exp_f32 v65, v65
  v_exp_f32 v66, v66
  v_exp_f32 v67, v67
  v_exp_f32 v68, v68
  v_exp_f32 v69, v69
  v_exp_f32 v70, v70
  v_exp_f32 v71, v71
  v_exp_f32 v72, v72
  v_exp_f32 v73, v73
  v_exp_f32 v74, v74
  v_exp_f32 v75, v75
  v_exp_f32 v76, v76
  v_exp_f32 v77, v77
  v_exp_f32 v78, v78
  v_exp_f32 v79, v79
  v_cvt_pk_bf16_f32 v48, v48, v49
  v_cvt_pk_bf16_f32 v49, v50, v51
  v_cvt_pk_bf16_f32 v50, v52, v53
  v_cvt_pk_bf16_f32 v51, v54, v55
  v_cvt_pk_bf16_f32 v56, v56, v57
  v_cvt_pk_bf16_f32 v57, v58, v59
  v_cvt_pk_bf16_f32 v58, v60, v61
  v_cvt_pk_bf16_f32 v59, v62, v63
  v_cvt_pk_bf16_f32 v64, v64, v65
  v_cvt_pk_bf16_f32 v65, v66, v67
  v_cvt_pk_bf16_f32 v66, v68, v69
  v_cvt_pk_bf16_f32 v67, v70, v71
  v_cvt_pk_bf16_f32 v72, v72, v73
  v_cvt_pk_bf16_f32 v73, v74, v75
  v_cvt_pk_bf16_f32 v74, v76, v77
  v_cvt_pk_bf16_f32 v75, v78, v79
  v_mfma_f32_32x32x16_bf16 v[128:143], v[12:15], v[48:51], v[128:143]
  v_mfma_f32_32x32x16_bf16 v[128:143], v[16:19], v[56:59], v[128:143]
  v_mfma_f32_32x32x16_bf16 v[144:159], v[12:15], v[64:67], v[144:159]
  v_mfma_f32_32x32x16_bf16 v[144:159], v[16:19], v[72:75], v[144:159]
L_at_slow_nx2:
  buffer_load_dwordx4 v[4:7], v45, s[12:15], s74 offen offset:1536 sc1
  buffer_load_dwordx2 v[8:9], v46, s[12:15], s74 offen offset:1536 sc1
  s_add_u32 s25, s75, 3840
  s_mov_b64 exec, s[66:67]
  buffer_load_dwordx4 v[12:15], v47, s[12:15], s25 offen sc1
  buffer_load_dwordx4 v[16:19], v47, s[12:15], s25 offen offset:640 sc1
  s_mov_b64 exec, -1
  s_waitcnt vmcnt(0)
  v_mfma_f32_32x32x16_bf16 v[48:63], v[4:7], v[28:31], 0
  v_mfma_f32_32x32x16_bf16 v[64:79], v[4:7], v[32:35], 0
  s_nop 9
  v_mfma_f32_32x32x4_2b_bf16 v[48:79], v[8:9], v[36:37], v[48:79]
  s_nop 15
  s_nop 3
  s_cmp_lg_u32 s65, 0
  s_cbranch_scc1 L_at_slow_acc3
  v_max3_f32 v41, v41, v48, v49
  v_max3_f32 v41, v41, v50, v51
  v_max3_f32 v41, v41, v52, v53
  v_max3_f32 v41, v41, v54, v55
  v_max3_f32 v41, v41, v56, v57
  v_max3_f32 v41, v41, v58, v59
  v_max3_f32 v41, v41, v60, v61
  v_max3_f32 v41, v41, v62, v63
  v_max3_f32 v42, v42, v64, v65
  v_max3_f32 v42, v42, v66, v67
  v_max3_f32 v42, v42, v68, v69
  v_max3_f32 v42, v42, v70, v71
  v_max3_f32 v42, v42, v72, v73
  v_max3_f32 v42, v42, v74, v75
  v_max3_f32 v42, v42, v76, v77
  v_max3_f32 v42, v42, v78, v79
  s_branch L_at_slow_nx3
L_at_slow_acc3:
  v_sub_f32 v48, v48, v41
  v_sub_f32 v49, v49, v41
  v_sub_f32 v50, v50, v41
  v_sub_f32 v51, v51, v41
  v_sub_f32 v52, v52, v41
  v_sub_f32 v53, v53, v41
  v_sub_f32 v54, v54, v41
  v_sub_f32 v55, v55, v41
  v_sub_f32 v56, v56, v41
  v_sub_f32 v57, v57, v41
  v_sub_f32 v58, v58, v41
  v_sub_f32 v59, v59, v41
  v_sub_f32 v60, v60, v41
  v_sub_f32 v61, v61, v41
  v_sub_f32 v62, v62, v41
  v_sub_f32 v63, v63, v41
  v_sub_f32 v64, v64, v42
  v_sub_f32 v65, v65, v42
  v_sub_f32 v66, v66, v42
  v_sub_f32 v67, v67, v42
  v_sub_f32 v68, v68, v42
  v_sub_f32 v69, v69, v42
  v_sub_f32 v70, v70, v42
  v_sub_f32 v71, v71, v42
  v_sub_f32 v72, v72, v42
  v_sub_f32 v73, v73, v42
  v_sub_f32 v74, v74, v42
  v_sub_f32 v75, v75, v42
  v_sub_f32 v76, v76, v42
  v_sub_f32 v77, v77, v42
  v_sub_f32 v78, v78, v42
  v_sub_f32 v79, v79, v42
  v_exp_f32 v48, v48
  v_exp_f32 v49, v49
  v_exp_f32 v50, v50
  v_exp_f32 v51, v51
  v_exp_f32 v52, v52
  v_exp_f32 v53, v53
  v_exp_f32 v54, v54
  v_exp_f32 v55, v55
  v_exp_f32 v56, v56
  v_exp_f32 v57, v57
  v_exp_f32 v58, v58
  v_exp_f32 v59, v59
  v_exp_f32 v60, v60
  v_exp_f32 v61, v61
  v_exp_f32 v62, v62
  v_exp_f32 v63, v63
  v_exp_f32 v64, v64
  v_exp_f32 v65, v65
  v_exp_f32 v66, v66
  v_exp_f32 v67, v67
  v_exp_f32 v68, v68
  v_exp_f32 v69, v69
  v_exp_f32 v70, v70
  v_exp_f32 v71, v71
  v_exp_f32 v72, v72
  v_exp_f32 v73, v73
  v_exp_f32 v74, v74
  v_exp_f32 v75, v75
  v_exp_f32 v76, v76
  v_exp_f32 v77, v77
  v_exp_f32 v78, v78
  v_exp_f32 v79, v79
  v_cvt_pk_bf16_f32 v48, v48, v49
  v_cvt_pk_bf16_f32 v49, v50, v51
  v_cvt_pk_bf16_f32 v50, v52, v53
  v_cvt_pk_bf16_f32 v51, v54, v55
  v_cvt_pk_bf16_f32 v56, v56, v57
  v_cvt_pk_bf16_f32 v57, v58, v59
  v_cvt_pk_bf16_f32 v58, v60, v61
  v_cvt_pk_bf16_f32 v59, v62, v63
  v_cvt_pk_bf16_f32 v64, v64, v65
  v_cvt_pk_bf16_f32 v65, v66, v67
  v_cvt_pk_bf16_f32 v66, v68, v69
  v_cvt_pk_bf16_f32 v67, v70, v71
  v_cvt_pk_bf16_f32 v72, v72, v73
  v_cvt_pk_bf16_f32 v73, v74, v75
  v_cvt_pk_bf16_f32 v74, v76, v77
  v_cvt_pk_bf16_f32 v75, v78, v79
  v_mfma_f32_32x32x16_bf16 v[128:143], v[12:15], v[48:51], v[128:143]
  v_mfma_f32_32x32x16_bf16 v[128:143], v[16:19], v[56:59], v[128:143]
  v_mfma_f32_32x32x16_bf16 v[144:159], v[12:15], v[64:67], v[144:159]
  v_mfma_f32_32x32x16_bf16 v[144:159], v[16:19], v[72:75], v[144:159]
L_at_slow_nx3:
  s_add_u32 s74, s74, 163840
  s_add_u32 s75, s75, 5120
  s_add_u32 s68, s68, 1
  s_cmp_lt_u32 s68, 8
  s_cbranch_scc1 L_at_slow_loop
  s_nop 15
  s_cmp_lg_u32 s65, 0
  s_cbranch_scc1 L_at_fin
  s_mov_b32 s65, 1
  v_mov_b32 v2, v41
  s_nop 1
  v_permlane32_swap_b32 v41, v2
  v_max_f32 v41, v41, v2
  v_mov_b32 v2, v42
  s_nop 1
  v_permlane32_swap_b32 v42, v2
  v_max_f32 v42, v42, v2
  v_mov_b32 v128, 0
  v_mov_b32 v129, 0
  v_mov_b32 v130, 0
  v_mov_b32 v131, 0
  v_mov_b32 v132, 0
  v_mov_b32 v133, 0
  v_mov_b32 v134, 0
  v_mov_b32 v135, 0
  v_mov_b32 v136, 0
  v_mov_b32 v137, 0
  v_mov_b32 v138, 0
  v_mov_b32 v139, 0
  v_mov_b32 v140, 0
  v_mov_b32 v141, 0
  v_mov_b32 v142, 0
  v_mov_b32 v143, 0
  v_mov_b32 v144, 0
  v_mov_b32 v145, 0
  v_mov_b32 v146, 0
  v_mov_b32 v147, 0
  v_mov_b32 v148, 0
  v_mov_b32 v149, 0
  v_mov_b32 v150, 0
  v_mov_b32 v151, 0
  v_mov_b32 v152, 0
  v_mov_b32 v153, 0
  v_mov_b32 v154, 0
  v_mov_b32 v155, 0
  v_mov_b32 v156, 0
  v_mov_b32 v157, 0
  v_mov_b32 v158, 0
  v_mov_b32 v159, 0
  s_branch L_at_slow_pass
L_ph3:
  s_mov_b32 s68, s56
  s_and_b32 s69, s57, 0xffff
  s_mov_b32 s70, 10485760
  s_mov_b32 s71, 0x00020000
  s_cmp_eq_u32 s52, 0
  s_cbranch_scc1 L_spare
  s_cmp_eq_u32 s52, 2
  s_cbranch_scc1 L_oproj
  s_cmp_eq_u32 s52, 3
  s_cbranch_scc1 L_g2p
  s_cmp_eq_u32 s52, 4
  s_cbranch_scc1 L_opp
  s_barrier
  ds_read_b128 v[32:35], v188 offset:0
  ds_read_b64_tr_b16 v[40:41], v200 offset:8192
  ds_read_b64_tr_b16 v[42:43], v201 offset:8192
  ds_read_b64_tr_b16 v[44:45], v200 offset:12288
  ds_read_b64_tr_b16 v[46:47], v201 offset:12288
  ds_read_b128 v[48:51], v189 offset:0
  ds_read_b64_tr_b16 v[56:57], v200 offset:8448
  ds_read_b64_tr_b16 v[58:59], v201 offset:8448
  ds_read_b64_tr_b16 v[60:61], v200 offset:12544
  ds_read_b64_tr_b16 v[62:63], v201 offset:12544
  ds_read_b128 v[144:147], v190 offset:0
  ds_read_b64_tr_b16 v[152:153], v200 offset:8704
  ds_read_b64_tr_b16 v[154:155], v201 offset:8704
  ds_read_b64_tr_b16 v[156:157], v200 offset:12800
  ds_read_b64_tr_b16 v[158:159], v201 offset:12800
  s_mov_b32 s3, 4
.p2align 6
L_g2l:
  s_waitcnt lgkmcnt(10)
  v_mfma_f32_32x32x16_bf16 v[212:227], v[40:43], v[32:35], v[212:227]
  ds_read_b128 v[128:131], v191 offset:0
  ds_read_b64_tr_b16 v[136:137], v200 offset:8960
  ds_read_b64_tr_b16 v[138:139], v201 offset:8960
  v_mfma_f32_32x32x16_bf16 v[228:243], v[44:47], v[32:35], v[228:243]
  ds_read_b64_tr_b16 v[140:141], v200 offset:13056
  ds_read_b64_tr_b16 v[142:143], v201 offset:13056
  s_waitcnt vmcnt(0) lgkmcnt(10)
  s_barrier
  v_mfma_f32_32x32x16_bf16 v[212:227], v[56:59], v[48:51], v[212:227]
  ds_read_b128 v[32:35], v188 offset:24576
  ds_read_b64_tr_b16 v[40:41], v200 offset:32768
  ds_read_b64_tr_b16 v[42:43], v201 offset:32768
  v_mfma_f32_32x32x16_bf16 v[228:243], v[60:63], v[48:51], v[228:243]
  ds_read_b64_tr_b16 v[44:45], v200 offset:36864
  ds_read_b64_tr_b16 v[46:47], v201 offset:36864
  s_waitcnt lgkmcnt(10)
  v_mfma_f32_32x32x16_bf16 v[212:227], v[152:155], v[144:147], v[212:227]
  ds_read_b128 v[48:51], v189 offset:24576
  ds_read_b64_tr_b16 v[56:57], v200 offset:33024
  ds_read_b64_tr_b16 v[58:59], v201 offset:33024
  v_mfma_f32_32x32x16_bf16 v[228:243], v[156:159], v[144:147], v[228:243]
  ds_read_b64_tr_b16 v[60:61], v200 offset:37120
  ds_read_b64_tr_b16 v[62:63], v201 offset:37120
  s_waitcnt lgkmcnt(10)
  v_mfma_f32_32x32x16_bf16 v[212:227], v[136:139], v[128:131], v[212:227]
  ds_read_b128 v[144:147], v190 offset:24576
  ds_read_b64_tr_b16 v[152:153], v200 offset:33280
  ds_read_b64_tr_b16 v[154:155], v201 offset:33280
  v_mfma_f32_32x32x16_bf16 v[228:243], v[140:143], v[128:131], v[228:243]
  ds_read_b64_tr_b16 v[156:157], v200 offset:37376
  ds_read_b64_tr_b16 v[158:159], v201 offset:37376
  s_waitcnt lgkmcnt(10)
  v_mfma_f32_32x32x16_bf16 v[212:227], v[40:43], v[32:35], v[212:227]
  ds_read_b128 v[128:131], v191 offset:24576
  ds_read_b64_tr_b16 v[136:137], v200 offset:33536
  ds_read_b64_tr_b16 v[138:139], v201 offset:33536
  v_mfma_f32_32x32x16_bf16 v[228:243], v[44:47], v[32:35], v[228:243]
  ds_read_b64_tr_b16 v[140:141], v200 offset:37632
  ds_read_b64_tr_b16 v[142:143], v201 offset:37632
  s_waitcnt vmcnt(0) lgkmcnt(10)
  s_barrier
  v_mfma_f32_32x32x16_bf16 v[212:227], v[56:59], v[48:51], v[212:227]
  ds_read_b128 v[32:35], v188 offset:49152
  ds_read_b64_tr_b16 v[40:41], v200 offset:57344
  ds_read_b64_tr_b16 v[42:43], v201 offset:57344
  v_mfma_f32_32x32x16_bf16 v[228:243], v[60:63], v[48:51], v[228:243]
  ds_read_b64_tr_b16 v[44:45], v200 offset:61440
  ds_read_b64_tr_b16 v[46:47], v201 offset:61440
  s_waitcnt lgkmcnt(10)
  v_mfma_f32_32x32x16_bf16 v[212:227], v[152:155], v[144:147], v[212:227]
  ds_read_b128 v[48:51], v189 offset:49152
  ds_read_b64_tr_b16 v[56:57], v200 offset:57600
  ds_read_b64_tr_b16 v[58:59], v201 offset:57600
  v_mfma_f32_32x32x16_bf16 v[228:243], v[156:159], v[144:147], v[228:243]
  ds_read_b64_tr_b16 v[60:61], v200 offset:61696
  ds_read_b64_tr_b16 v[62:63], v201 offset:61696
  s_waitcnt lgkmcnt(10)
  v_mfma_f32_32x32x16_bf16 v[212:227], v[136:139], v[128:131], v[212:227]
  ds_read_b128 v[144:147], v190 offset:49152
  ds_read_b64_tr_b16 v[152:153], v200 offset:57856
  ds_read_b64_tr_b16 v[154:155], v201 offset:57856
  v_mfma_f32_32x32x16_bf16 v[228:243], v[140:143], v[128:131], v[228:243]
  ds_read_b64_tr_b16 v[156:157], v200 offset:61952
  ds_read_b64_tr_b16 v[158:159], v201 offset:61952
  s_waitcnt lgkmcnt(10)
  v_mfma_f32_32x32x16_bf16 v[212:227], v[40:43], v[32:35], v[212:227]
  ds_read_b128 v[128:131], v191 offset:49152
  ds_read_b64_tr_b16 v[136:137], v200 offset:58112
  ds_read_b64_tr_b16 v[138:139], v201 offset:58112
  v_mfma_f32_32x32x16_bf16 v[228:243], v[44:47], v[32:35], v[228:243]
  ds_read_b64_tr_b16 v[140:141], v200 offset:62208
  ds_read_b64_tr_b16 v[142:143], v201 offset:62208
  s_waitcnt vmcnt(0) lgkmcnt(10)
  s_barrier
  v_mfma_f32_32x32x16_bf16 v[212:227], v[56:59], v[48:51], v[212:227]
  ds_read_b128 v[32:35], v192 offset:8192
  ds_read_b64_tr_b16 v[40:41], v204 offset:16384
  ds_read_b64_tr_b16 v[42:43], v205 offset:16384
  v_mfma_f32_32x32x16_bf16 v[228:243], v[60:63], v[48:51], v[228:243]
  ds_read_b64_tr_b16 v[44:45], v204 offset:20480
  ds_read_b64_tr_b16 v[46:47], v205 offset:20480
  s_waitcnt lgkmcnt(10)
  v_mfma_f32_32x32x16_bf16 v[212:227], v[152:155], v[144:147], v[212:227]
  ds_read_b128 v[48:51], v193 offset:8192
  ds_read_b64_tr_b16 v[56:57], v204 offset:16640
  ds_read_b64_tr_b16 v[58:59], v205 offset:16640
  v_mfma_f32_32x32x16_bf16 v[228:243], v[156:159], v[144:147], v[228:243]
  ds_read_b64_tr_b16 v[60:61], v204 offset:20736
  ds_read_b64_tr_b16 v[62:63], v205 offset:20736
  s_waitcnt lgkmcnt(10)
  v_mfma_f32_32x32x16_bf16 v[212:227], v[136:139], v[128:131], v[212:227]
  ds_read_b128 v[144:147], v194 offset:8192
  ds_read_b64_tr_b16 v[152:153], v204 offset:16896
  ds_read_b64_tr_b16 v[154:155], v205 offset:16896
  v_mfma_f32_32x32x16_bf16 v[228:243], v[140:143], v[128:131], v[228:243]
  ds_read_b64_tr_b16 v[156:157], v204 offset:20992
  ds_read_b64_tr_b16 v[158:159], v205 offset:20992
  s_waitcnt lgkmcnt(10)
  v_mfma_f32_32x32x16_bf16 v[212:227], v[40:43], v[32:35], v[212:227]
  ds_read_b128 v[128:131], v195 offset:8192
  ds_read_b64_tr_b16 v[136:137], v204 offset:17152
  ds_read_b64_tr_b16 v[138:139], v205 offset:17152
  v_mfma_f32_32x32x16_bf16 v[228:243], v[44:47], v[32:35], v[228:243]
  ds_read_b64_tr_b16 v[140:141], v204 offset:21248
  ds_read_b64_tr_b16 v[142:143], v205 offset:21248
  s_waitcnt vmcnt(0) lgkmcnt(10)
  s_barrier
  v_mfma_f32_32x32x16_bf16 v[212:227], v[56:59], v[48:51], v[212:227]
  ds_read_b128 v[32:35], v192 offset:32768
  ds_read_b64_tr_b16 v[40:41], v204 offset:40960
  ds_read_b64_tr_b16 v[42:43], v205 offset:40960
  v_mfma_f32_32x32x16_bf16 v[228:243], v[60:63], v[48:51], v[228:243]
  ds_read_b64_tr_b16 v[44:45], v204 offset:45056
  ds_read_b64_tr_b16 v[46:47], v205 offset:45056
  s_waitcnt lgkmcnt(10)
  v_mfma_f32_32x32x16_bf16 v[212:227], v[152:155], v[144:147], v[212:227]
  ds_read_b128 v[48:51], v193 offset:32768
  ds_read_b64_tr_b16 v[56:57], v204 offset:41216
  ds_read_b64_tr_b16 v[58:59], v205 offset:41216
  v_mfma_f32_32x32x16_bf16 v[228:243], v[156:159], v[144:147], v[228:243]
  ds_read_b64_tr_b16 v[60:61], v204 offset:45312
  ds_read_b64_tr_b16 v[62:63], v205 offset:45312
  s_waitcnt lgkmcnt(10)
  v_mfma_f32_32x32x16_bf16 v[212:227], v[136:139], v[128:131], v[212:227]
  ds_read_b128 v[144:147], v194 offset:32768
  ds_read_b64_tr_b16 v[152:153], v204 offset:41472
  ds_read_b64_tr_b16 v[154:155], v205 offset:41472
  v_mfma_f32_32x32x16_bf16 v[228:243], v[140:143], v[128:131], v[228:243]
  ds_read_b64_tr_b16 v[156:157], v204 offset:45568
  ds_read_b64_tr_b16 v[158:159], v205 offset:45568
  s_waitcnt lgkmcnt(10)
  v_mfma_f32_32x32x16_bf16 v[212:227], v[40:43], v[32:35], v[212:227]
  ds_read_b128 v[128:131], v195 offset:32768
  ds_read_b64_tr_b16 v[136:137], v204 offset:41728
  ds_read_b64_tr_b16 v[138:139], v205 offset:41728
  v_mfma_f32_32x32x16_bf16 v[228:243], v[44:47], v[32:35], v[228:243]
  ds_read_b64_tr_b16 v[140:141], v204 offset:45824
  ds_read_b64_tr_b16 v[142:143], v205 offset:45824
  s_waitcnt vmcnt(0) lgkmcnt(10)
  s_barrier
  v_mfma_f32_32x32x16_bf16 v[212:227], v[56:59], v[48:51], v[212:227]
  ds_read_b128 v[32:35], v188 offset:0
  ds_read_b64_tr_b16 v[40:41], v200 offset:8192
  ds_read_b64_tr_b16 v[42:43], v201 offset:8192
  v_mfma_f32_32x32x16_bf16 v[228:243], v[60:63], v[48:51], v[228:243]
  ds_read_b64_tr_b16 v[44:45], v200 offset:12288
  ds_read_b64_tr_b16 v[46:47], v201 offset:12288
  s_waitcnt lgkmcnt(10)
  v_mfma_f32_32x32x16_bf16 v[212:227], v[152:155], v[144:147], v[212:227]
  ds_read_b128 v[48:51], v189 offset:0
  ds_read_b64_tr_b16 v[56:57], v200 offset:8448
  ds_read_b64_tr_b16 v[58:59], v201 offset:8448
  v_mfma_f32_32x32x16_bf16 v[228:243], v[156:159], v[144:147], v[228:243]
  ds_read_b64_tr_b16 v[60:61], v200 offset:12544
  ds_read_b64_tr_b16 v[62:63], v201 offset:12544
  s_waitcnt lgkmcnt(10)
  v_mfma_f32_32x32x16_bf16 v[212:227], v[136:139], v[128:131], v[212:227]
  ds_read_b128 v[144:147], v190 offset:0
  ds_read_b64_tr_b16 v[152:153], v200 offset:8704
  ds_read_b64_tr_b16 v[154:155], v201 offset:8704
  v_mfma_f32_32x32x16_bf16 v[228:243], v[140:143], v[128:131], v[228:243]
  ds_read_b64_tr_b16 v[156:157], v200 offset:12800
  ds_read_b64_tr_b16 v[158:159], v201 offset:12800
  s_sub_u32 s3, s3, 1
  s_cmp_lg_u32 s3, 0
  s_cbranch_scc1 L_g2l
  s_waitcnt lgkmcnt(0)
  s_mov_b32 s25, 0
  s_nop 0
  buffer_store_dword v212, v254, s[68:71], s25 offen sc1
  s_mov_b32 s25, 5120
  buffer_store_dword v213, v254, s[68:71], s25 offen sc1
  s_mov_b32 s25, 10240
  buffer_store_dword v214, v254, s[68:71], s25 offen sc1
  s_mov_b32 s25, 15360
  buffer_store_dword v215, v254, s[68:71], s25 offen sc1
  s_mov_b32 s25, 40960
  buffer_store_dword v216, v254, s[68:71], s25 offen sc1
  s_mov_b32 s25, 46080
  buffer_store_dword v217, v254, s[68:71], s25 offen sc1
  s_mov_b32 s25, 51200
  buffer_store_dword v218, v254, s[68:71], s25 offen sc1
  s_mov_b32 s25, 56320
  buffer_store_dword v219, v254, s[68:71], s25 offen sc1
  s_mov_b32 s25, 81920
  buffer_store_dword v220, v254, s[68:71], s25 offen sc1
  s_mov_b32 s25, 87040
  buffer_store_dword v221, v254, s[68:71], s25 offen sc1
  s_mov_b32 s25, 92160
  buffer_store_dword v222, v254, s[68:71], s25 offen sc1
  s_mov_b32 s25, 97280
  buffer_store_dword v223, v254, s[68:71], s25 offen sc1
  s_mov_b32 s25, 122880
  buffer_store_dword v224, v254, s[68:71], s25 offen sc1
  s_mov_b32 s25, 128000
  buffer_store_dword v225, v254, s[68:71], s25 offen sc1
  s_mov_b32 s25, 133120
  buffer_store_dword v226, v254, s[68:71], s25 offen sc1
  s_mov_b32 s25, 138240
  buffer_store_dword v227, v254, s[68:71], s25 offen sc1
  s_mov_b32 s25, 163840
  buffer_store_dword v228, v254, s[68:71], s25 offen sc1
  s_mov_b32 s25, 168960
  buffer_store_dword v229, v254, s[68:71], s25 offen sc1
  s_mov_b32 s25, 174080
  buffer_store_dword v230, v254, s[68:71], s25 offen sc1
  s_mov_b32 s25, 179200
  buffer_store_dword v231, v254, s[68:71], s25 offen sc1
  s_mov_b32 s25, 204800
  buffer_store_dword v232, v254, s[68:71], s25 offen sc1
  s_mov_b32 s25, 209920
  buffer_store_dword v233, v254, s[68:71], s25 offen sc1
  s_mov_b32 s25, 215040
  buffer_store_dword v234, v254, s[68:71], s25 offen sc1
  s_mov_b32 s25, 220160
  buffer_store_dword v235, v254, s[68:71], s25 offen sc1
  s_mov_b32 s25, 245760
  buffer_store_dword v236, v254, s[68:71], s25 offen sc1
  s_mov_b32 s25, 250880
  buffer_store_dword v237, v254, s[68:71], s25 offen sc1
  s_mov_b32 s25, 256000
  buffer_store_dword v238, v254, s[68:71], s25 offen sc1
  s_mov_b32 s25, 261120
  buffer_store_dword v239, v254, s[68:71], s25 offen sc1
  s_mov_b32 s25, 286720
  buffer_store_dword v240, v254, s[68:71], s25 offen sc1
  s_mov_b32 s25, 291840
  buffer_store_dword v241, v254, s[68:71], s25 offen sc1
  s_mov_b32 s25, 296960
  buffer_store_dword v242, v254, s[68:71], s25 offen sc1
  s_mov_b32 s25, 302080
  buffer_store_dword v243, v254, s[68:71], s25 offen sc1
  s_endpgm
L_g2p:
  s_nop 0
  s_waitcnt vmcnt(16)
  s_barrier
  s_waitcnt vmcnt(0) lgkmcnt(0)
  s_barrier
  s_cmp_lg_u32 s20, 4
  s_cbranch_scc1 L_po0
  s_mul_i32 s26, s31, 1280
  s_lshl_b32 s25, s30, 2
  s_add_u32 s26, s26, s25
  s_add_u32 s26, s26, 15777792
  v_lshlrev_b32 v6, 7, v1
  s_mov_b64 exec, 0x3ff
  buffer_store_dword v6, v6, s[12:15], s26 offen sc1
  s_mov_b64 exec, -1
L_po0:
  s_add_u32 m0, s34, 98304
  s_add_u32 s25, s36, 0
  buffer_load_dwordx4 v244, s[4:7], s25 offen  lds
  s_add_u32 m0, s34, 99328
  s_add_u32 s25, s36, 10240
  buffer_load_dwordx4 v245, s[4:7], s25 offen  lds
  s_add_u32 s36, s36, 128
  s_xor_b32 s25, s16, s18
  s_xor_b32 s26, s17, s19
  s_cmp_eq_u32 s36, 1280
  s_cselect_b32 s36, 0, s36
  s_cselect_b32 s25, s25, 0
  s_cselect_b32 s26, s26, 0
  s_xor_b32 s4, s4, s25
  s_xor_b32 s5, s5, s26
  s_add_u32 m0, s35, 106496
  s_add_u32 s25, s37, 0
  buffer_load_dwordx4 v246, s[8:11], s25 offen sc1 lds
  s_add_u32 m0, s35, 107520
  s_add_u32 s25, s37, 20480
  buffer_load_dwordx4 v246, s[8:11], s25 offen sc1 lds
  s_add_u32 m0, s35, 108544
  s_add_u32 s25, s37, 40960
  buffer_load_dwordx4 v246, s[8:11], s25 offen sc1 lds
  s_add_u32 m0, s35, 109568
  s_add_u32 s25, s37, 61440
  buffer_load_dwordx4 v246, s[8:11], s25 offen sc1 lds
  s_add_u32 s37, s37, 1024
  s_cmp_eq_u32 s37, 20480
  s_cselect_b32 s37, 0, s37
  s_waitcnt vmcnt(14) lgkmcnt(0)
  s_barrier
  s_add_u32 m0, s34, 0
  s_add_u32 s25, s36, 0
  buffer_load_dwordx4 v244, s[4:7], s25 offen  lds
  s_add_u32 m0, s34, 1024
  s_add_u32 s25, s36, 10240
  buffer_load_dwordx4 v245, s[4:7], s25 offen  lds
  s_add_u32 s36, s36, 128
  s_xor_b32 s25, s16, s18
  s_xor_b32 s26, s17, s19
  s_cmp_eq_u32 s36, 1280
  s_cselect_b32 s36, 0, s36
  s_cselect_b32 s25, s25, 0
  s_cselect_b32 s26, s26, 0
  s_xor_b32 s4, s4, s25
  s_xor_b32 s5, s5, s26
  s_add_u32 m0, s35, 8192
  s_add_u32 s25, s37, 0
  buffer_load_dwordx4 v246, s[8:11], s25 offen sc1 lds
  s_add_u32 m0, s35, 9216
  s_add_u32 s25, s37, 20480
  buffer_load_dwordx4 v246, s[8:11], s25 offen sc1 lds
  s_add_u32 m0, s35, 10240
  s_add_u32 s25, s37, 40960
  buffer_load_dwordx4 v246, s[8:11], s25 offen sc1 lds
  s_add_u32 m0, s35, 11264
  s_add_u32 s25, s37, 61440
  buffer_load_dwordx4 v246, s[8:11], s25 offen sc1 lds
  s_add_u32 s37, s37, 1024
  s_cmp_eq_u32 s37, 20480
  s_cselect_b32 s37, 0, s37
  s_waitcnt vmcnt(14) lgkmcnt(0)
  s_barrier
  s_add_u32 m0, s34, 24576
  s_add_u32 s25, s36, 0
  buffer_load_dwordx4 v244, s[4:7], s25 offen  lds
  s_add_u32 m0, s34, 25600
  s_add_u32 s25, s36, 10240
  buffer_load_dwordx4 v245, s[4:7], s25 offen  lds
  s_add_u32 s36, s36, 128
  s_xor_b32 s25, s16, s18
  s_xor_b32 s26, s17, s19
  s_cmp_eq_u32 s36, 1280
  s_cselect_b32 s36, 0, s36
  s_cselect_b32 s25, s25, 0
  s_cselect_b32 s26, s26, 0
  s_xor_b32 s4, s4, s25
  s_xor_b32 s5, s5, s26
  s_add_u32 m0, s35, 32768
  s_add_u32 s25, s37, 0
  buffer_load_dwordx4 v246, s[8:11], s25 offen sc1 lds
  s_add_u32 m0, s35, 33792
  s_add_u32 s25, s37, 20480
  buffer_load_dwordx4 v246, s[8:11], s25 offen sc1 lds
  s_add_u32 m0, s35, 34816
  s_add_u32 s25, s37, 40960
  buffer_load_dwordx4 v246, s[8:11], s25 offen sc1 lds
  s_add_u32 m0, s35, 35840
  s_add_u32 s25, s37, 61440
  buffer_load_dwordx4 v246, s[8:11], s25 offen sc1 lds
  s_add_u32 s37, s37, 1024
  s_cmp_eq_u32 s37, 20480
  s_cselect_b32 s37, 0, s37
  s_waitcnt vmcnt(12) lgkmcnt(0)
  s_barrier
  s_add_u32 m0, s34, 49152
  s_add_u32 s25, s36, 0
  buffer_load_dwordx4 v244, s[4:7], s25 offen  lds
  s_add_u32 m0, s34, 50176
  s_add_u32 s25, s36, 10240
  buffer_load_dwordx4 v245, s[4:7], s25 offen  lds
  s_add_u32 s36, s36, 128
  s_xor_b32 s25, s16, s18
  s_xor_b32 s26, s17, s19
  s_cmp_eq_u32 s36, 1280
  s_cselect_b32 s36, 0, s36
  s_cselect_b32 s25, s25, 0
  s_cselect_b32 s26, s26, 0
  s_xor_b32 s4, s4, s25
  s_xor_b32 s5, s5, s26
  s_add_u32 m0, s35, 57344
  s_add_u32 s25, s37, 0
  buffer_load_dwordx4 v246, s[8:11], s25 offen sc1 lds
  s_add_u32 m0, s35, 58368
  s_add_u32 s25, s37, 20480
  buffer_load_dwordx4 v246, s[8:11], s25 offen sc1 lds
  s_add_u32 m0, s35, 59392
  s_add_u32 s25, s37, 40960
  buffer_load_dwordx4 v246, s[8:11], s25 offen sc1 lds
  s_add_u32 m0, s35, 60416
  s_add_u32 s25, s37, 61440
  buffer_load_dwordx4 v246, s[8:11], s25 offen sc1 lds
  s_add_u32 s37, s37, 1024
  s_cmp_eq_u32 s37, 20480
  s_cselect_b32 s37, 0, s37
  s_waitcnt vmcnt(12) lgkmcnt(0)
  s_barrier
  s_add_u32 m0, s34, 73728
  s_add_u32 s25, s36, 0
  buffer_load_dwordx4 v244, s[4:7], s25 offen  lds
  s_add_u32 m0, s34, 74752
  s_add_u32 s25, s36, 10240
  buffer_load_dwordx4 v245, s[4:7], s25 offen  lds
  s_add_u32 s36, s36, 128
  s_xor_b32 s25, s16, s18
  s_xor_b32 s26, s17, s19
  s_cmp_eq_u32 s36, 1280
  s_cselect_b32 s36, 0, s36
  s_cselect_b32 s25, s25, 0
  s_cselect_b32 s26, s26, 0
  s_xor_b32 s4, s4, s25
  s_xor_b32 s5, s5, s26
  s_add_u32 m0, s35, 81920
  s_add_u32 s25, s37, 0
  buffer_load_dwordx4 v246, s[8:11], s25 offen sc1 lds
  s_add_u32 m0, s35, 82944
  s_add_u32 s25, s37, 20480
  buffer_load_dwordx4 v246, s[8:11], s25 offen sc1 lds
  s_add_u32 m0, s35, 83968
  s_add_u32 s25, s37, 40960
  buffer_load_dwordx4 v246, s[8:11], s25 offen sc1 lds
  s_add_u32 m0, s35, 84992
  s_add_u32 s25, s37, 61440
  buffer_load_dwordx4 v246, s[8:11], s25 offen sc1 lds
  s_add_u32 s37, s37, 1024
  s_cmp_eq_u32 s37, 20480
  s_cselect_b32 s37, 0, s37
  s_waitcnt vmcnt(12) lgkmcnt(0)
  s_barrier
  s_add_u32 m0, s34, 98304
  s_add_u32 s25, s36, 0
  buffer_load_dwordx4 v244, s[4:7], s25 offen  lds
  s_add_u32 m0, s34, 99328
  s_add_u32 s25, s36, 10240
  buffer_load_dwordx4 v245, s[4:7], s25 offen  lds
  s_add_u32 s36, s36, 128
  s_xor_b32 s25, s16, s18
  s_xor_b32 s26, s17, s19
  s_cmp_eq_u32 s36, 1280
  s_cselect_b32 s36, 0, s36
  s_cselect_b32 s25, s25, 0
  s_cselect_b32 s26, s26, 0
  s_xor_b32 s4, s4, s25
  s_xor_b32 s5, s5, s26
  s_add_u32 m0, s35, 106496
  s_add_u32 s25, s37, 0
  buffer_load_dwordx4 v246, s[8:11], s25 offen sc1 lds
  s_add_u32 m0, s35, 107520
  s_add_u32 s25, s37, 20480
  buffer_load_dwordx4 v246, s[8:11], s25 offen sc1 lds
  s_add_u32 m0, s35, 108544
  s_add_u32 s25, s37, 40960
  buffer_load_dwordx4 v246, s[8:11], s25 offen sc1 lds
  s_add_u32 m0, s35, 109568
  s_add_u32 s25, s37, 61440
  buffer_load_dwordx4 v246, s[8:11], s25 offen sc1 lds
  s_add_u32 s37, s37, 1024
  s_cmp_eq_u32 s37, 20480
  s_cselect_b32 s37, 0, s37
  s_waitcnt vmcnt(12) lgkmcnt(0)
  s_barrier
  s_add_u32 m0, s34, 0
  s_add_u32 s25, s36, 0
  buffer_load_dwordx4 v244, s[4:7], s25 offen  lds
  s_add_u32 m0, s34, 1024
  s_add_u32 s25, s36, 10240
  buffer_load_dwordx4 v245, s[4:7], s25 offen  lds
  s_add_u32 s36, s36, 128
  s_xor_b32 s25, s16, s18
  s_xor_b32 s26, s17, s19
  s_cmp_eq_u32 s36, 1280
  s_cselect_b32 s36, 0, s36
  s_cselect_b32 s25, s25, 0
  s_cselect_b32 s26, s26, 0
  s_xor_b32 s4, s4, s25
  s_xor_b32 s5, s5, s26
  s_add_u32 m0, s35, 8192
  s_add_u32 s25, s37, 0
  buffer_load_dwordx4 v246, s[8:11], s25 offen sc1 lds
  s_add_u32 m0, s35, 9216
  s_add_u32 s25, s37, 20480
  buffer_load_dwordx4 v246, s[8:11], s25 offen sc1 lds
  s_add_u32 m0, s35, 10240
  s_add_u32 s25, s37, 40960
  buffer_load_dwordx4 v246, s[8:11], s25 offen sc1 lds
  s_add_u32 m0, s35, 11264
  s_add_u32 s25, s37, 61440
  buffer_load_dwordx4 v246, s[8:11], s25 offen sc1 lds
  s_add_u32 s37, s37, 1024
  s_cmp_eq_u32 s37, 20480
  s_cselect_b32 s37, 0, s37
  s_waitcnt vmcnt(12) lgkmcnt(0)
  s_barrier
  s_add_u32 m0, s34, 24576
  s_add_u32 s25, s36, 0
  buffer_load_dwordx4 v244, s[4:7], s25 offen  lds
  s_add_u32 m0, s34, 25600
  s_add_u32 s25, s36, 10240
  buffer_load_dwordx4 v245, s[4:7], s25 offen  lds
  s_add_u32 s36, s36, 128
  s_xor_b32 s25, s16, s18
  s_xor_b32 s26, s17, s19
  s_cmp_eq_u32 s36, 1280
  s_cselect_b32 s36, 0, s36
  s_cselect_b32 s25, s25, 0
  s_cselect_b32 s26, s26, 0
  s_xor_b32 s4, s4, s25
  s_xor_b32 s5, s5, s26
  s_add_u32 m0, s35, 32768
  s_add_u32 s25, s37, 0
  buffer_load_dwordx4 v246, s[8:11], s25 offen sc1 lds
  s_add_u32 m0, s35, 33792
  s_add_u32 s25, s37, 20480
  buffer_load_dwordx4 v246, s[8:11], s25 offen sc1 lds
  s_add_u32 m0, s35, 34816
  s_add_u32 s25, s37, 40960
  buffer_load_dwordx4 v246, s[8:11], s25 offen sc1 lds
  s_add_u32 m0, s35, 35840
  s_add_u32 s25, s37, 61440
  buffer_load_dwordx4 v246, s[8:11], s25 offen sc1 lds
  s_add_u32 s37, s37, 1024
  s_cmp_eq_u32 s37, 20480
  s_cselect_b32 s37, 0, s37
  s_waitcnt vmcnt(12) lgkmcnt(0)
  s_barrier
  s_add_u32 m0, s34, 49152
  s_add_u32 s25, s36, 0
  buffer_load_dwordx4 v244, s[4:7], s25 offen  lds
  s_add_u32 m0, s34, 50176
  s_add_u32 s25, s36, 10240
  buffer_load_dwordx4 v245, s[4:7], s25 offen  lds
  s_add_u32 s36, s36, 128
  s_xor_b32 s25, s16, s18
  s_xor_b32 s26, s17, s19
  s_cmp_eq_u32 s36, 1280
  s_cselect_b32 s36, 0, s36
  s_cselect_b32 s25, s25, 0
  s_cselect_b32 s26, s26, 0
  s_xor_b32 s4, s4, s25
  s_xor_b32 s5, s5, s26
  s_add_u32 m0, s35, 57344
  s_add_u32 s25, s37, 0
  buffer_load_dwordx4 v246, s[8:11], s25 offen sc1 lds
  s_add_u32 m0, s35, 58368
  s_add_u32 s25, s37, 20480
  buffer_load_dwordx4 v246, s[8:11], s25 offen sc1 lds
  s_add_u32 m0, s35, 59392
  s_add_u32 s25, s37, 40960
  buffer_load_dwordx4 v246, s[8:11], s25 offen sc1 lds
  s_add_u32 m0, s35, 60416
  s_add_u32 s25, s37, 61440
  buffer_load_dwordx4 v246, s[8:11], s25 offen sc1 lds
  s_add_u32 s37, s37, 1024
  s_cmp_eq_u32 s37, 20480
  s_cselect_b32 s37, 0, s37
  s_waitcnt vmcnt(12) lgkmcnt(0)
  s_barrier
  s_add_u32 m0, s34, 73728
  s_add_u32 s25, s36, 0
  buffer_load_dwordx4 v244, s[4:7], s25 offen  lds
  s_add_u32 m0, s34, 74752
  s_add_u32 s25, s36, 10240
  buffer_load_dwordx4 v245, s[4:7], s25 offen  lds
  s_add_u32 s36, s36, 128
  s_xor_b32 s25, s16, s18
  s_xor_b32 s26, s17, s19
  s_cmp_eq_u32 s36, 1280
  s_cselect_b32 s36, 0, s36
  s_cselect_b32 s25, s25, 0
  s_cselect_b32 s26, s26, 0
  s_xor_b32 s4, s4, s25
  s_xor_b32 s5, s5, s26
  s_add_u32 m0, s35, 81920
  s_add_u32 s25, s37, 0
  buffer_load_dwordx4 v246, s[8:11], s25 offen sc1 lds
  s_add_u32 m0, s35, 82944
  s_add_u32 s25, s37, 20480
  buffer_load_dwordx4 v246, s[8:11], s25 offen sc1 lds
  s_add_u32 m0, s35, 83968
  s_add_u32 s25, s37, 40960
  buffer_load_dwordx4 v246, s[8:11], s25 offen sc1 lds
  s_add_u32 m0, s35, 84992
  s_add_u32 s25, s37, 61440
  buffer_load_dwordx4 v246, s[8:11], s25 offen sc1 lds
  s_add_u32 s37, s37, 1024
  s_cmp_eq_u32 s37, 20480
  s_cselect_b32 s37, 0, s37
  s_waitcnt vmcnt(12) lgkmcnt(0)
  s_barrier
  s_add_u32 m0, s34, 98304
  s_add_u32 s25, s36, 0
  buffer_load_dwordx4 v244, s[4:7], s25 offen  lds
  s_add_u32 m0, s34, 99328
  s_add_u32 s25, s36, 10240
  buffer_load_dwordx4 v245, s[4:7], s25 offen  lds
  s_add_u32 s36, s36, 128
  s_xor_b32 s25, s16, s18
  s_xor_b32 s26, s17, s19
  s_cmp_eq_u32 s36, 1280
  s_cselect_b32 s36, 0, s36
  s_cselect_b32 s25, s25, 0
  s_cselect_b32 s26, s26, 0
  s_xor_b32 s4, s4, s25
  s_xor_b32 s5, s5, s26
  s_add_u32 m0, s35, 106496
  s_add_u32 s25, s37, 0
  buffer_load_dwordx4 v246, s[8:11], s25 offen sc1 lds
  s_add_u32 m0, s35, 107520
  s_add_u32 s25, s37, 20480
  buffer_load_dwordx4 v246, s[8:11], s25 offen sc1 lds
  s_add_u32 m0, s35, 108544
  s_add_u32 s25, s37, 40960
  buffer_load_dwordx4 v246, s[8:11], s25 offen sc1 lds
  s_add_u32 m0, s35, 109568
  s_add_u32 s25, s37, 61440
  buffer_load_dwordx4 v246, s[8:11], s25 offen sc1 lds
  s_add_u32 s37, s37, 1024
  s_cmp_eq_u32 s37, 20480
  s_cselect_b32 s37, 0, s37
  s_waitcnt vmcnt(12) lgkmcnt(0)
  s_barrier
  s_add_u32 m0, s34, 0
  s_add_u32 s25, s36, 0
  buffer_load_dwordx4 v244, s[4:7], s25 offen  lds
  s_add_u32 m0, s34, 1024
  s_add_u32 s25, s36, 10240
  buffer_load_dwordx4 v245, s[4:7], s25 offen  lds
  s_add_u32 s36, s36, 128
  s_xor_b32 s25, s16, s18
  s_xor_b32 s26, s17, s19
  s_cmp_eq_u32 s36, 1280
  s_cselect_b32 s36, 0, s36
  s_cselect_b32 s25, s25, 0
  s_cselect_b32 s26, s26, 0
  s_xor_b32 s4, s4, s25
  s_xor_b32 s5, s5, s26
  s_add_u32 m0, s35, 8192
  s_add_u32 s25, s37, 0
  buffer_load_dwordx4 v246, s[8:11], s25 offen sc1 lds
  s_add_u32 m0, s35, 9216
  s_add_u32 s25, s37, 20480
  buffer_load_dwordx4 v246, s[8:11], s25 offen sc1 lds
  s_add_u32 m0, s35, 10240
  s_add_u32 s25, s37, 40960
  buffer_load_dwordx4 v246, s[8:11], s25 offen sc1 lds
  s_add_u32 m0, s35, 11264
  s_add_u32 s25, s37, 61440
  buffer_load_dwordx4 v246, s[8:11], s25 offen sc1 lds
  s_add_u32 s37, s37, 1024
  s_cmp_eq_u32 s37, 20480
  s_cselect_b32 s37, 0, s37
  s_waitcnt vmcnt(12) lgkmcnt(0)
  s_barrier
  s_add_u32 m0, s34, 24576
  s_add_u32 s25, s36, 0
  buffer_load_dwordx4 v244, s[4:7], s25 offen  lds
  s_add_u32 m0, s34, 25600
  s_add_u32 s25, s36, 10240
  buffer_load_dwordx4 v245, s[4:7], s25 offen  lds
  s_add_u32 s36, s36, 128
  s_xor_b32 s25, s16, s18
  s_xor_b32 s26, s17, s19
  s_cmp_eq_u32 s36, 1280
  s_cselect_b32 s36, 0, s36
  s_cselect_b32 s25, s25, 0
  s_cselect_b32 s26, s26, 0
  s_xor_b32 s4, s4, s25
  s_xor_b32 s5, s5, s26
  s_add_u32 m0, s35, 32768
  s_add_u32 s25, s37, 0
  buffer_load_dwordx4 v246, s[8:11], s25 offen sc1 lds
  s_add_u32 m0, s35, 33792
  s_add_u32 s25, s37, 20480
  buffer_load_dwordx4 v246, s[8:11], s25 offen sc1 lds
  s_add_u32 m0, s35, 34816
  s_add_u32 s25, s37, 40960
  buffer_load_dwordx4 v246, s[8:11], s25 offen sc1 lds
  s_add_u32 m0, s35, 35840
  s_add_u32 s25, s37, 61440
  buffer_load_dwordx4 v246, s[8:11], s25 offen sc1 lds
  s_add_u32 s37, s37, 1024
  s_cmp_eq_u32 s37, 20480
  s_cselect_b32 s37, 0, s37
  s_waitcnt vmcnt(12) lgkmcnt(0)
  s_barrier
  s_add_u32 m0, s34, 49152
  s_add_u32 s25, s36, 0
  buffer_load_dwordx4 v244, s[4:7], s25 offen  lds
  s_add_u32 m0, s34, 50176
  s_add_u32 s25, s36, 10240
  buffer_load_dwordx4 v245, s[4:7], s25 offen  lds
  s_add_u32 s36, s36, 128
  s_xor_b32 s25, s16, s18
  s_xor_b32 s26, s17, s19
  s_cmp_eq_u32 s36, 1280
  s_cselect_b32 s36, 0, s36
  s_cselect_b32 s25, s25, 0
  s_cselect_b32 s26, s26, 0
  s_xor_b32 s4, s4, s25
  s_xor_b32 s5, s5, s26
  s_add_u32 m0, s35, 57344
  s_add_u32 s25, s37, 0
  buffer_load_dwordx4 v246, s[8:11], s25 offen sc1 lds
  s_add_u32 m0, s35, 58368
  s_add_u32 s25, s37, 20480
  buffer_load_dwordx4 v246, s[8:11], s25 offen sc1 lds
  s_add_u32 m0, s35, 59392
  s_add_u32 s25, s37, 40960
  buffer_load_dwordx4 v246, s[8:11], s25 offen sc1 lds
  s_add_u32 m0, s35, 60416
  s_add_u32 s25, s37, 61440
  buffer_load_dwordx4 v246, s[8:11], s25 offen sc1 lds
  s_add_u32 s37, s37, 1024
  s_cmp_eq_u32 s37, 20480
  s_cselect_b32 s37, 0, s37
  s_waitcnt vmcnt(12) lgkmcnt(0)
  s_barrier
  s_add_u32 m0, s34, 73728
  s_add_u32 s25, s36, 0
  buffer_load_dwordx4 v244, s[4:7], s25 offen  lds
  s_add_u32 m0, s34, 74752
  s_add_u32 s25, s36, 10240
  buffer_load_dwordx4 v245, s[4:7], s25 offen  lds
  s_add_u32 s36, s36, 128
  s_xor_b32 s25, s16, s18
  s_xor_b32 s26, s17, s19
  s_cmp_eq_u32 s36, 1280
  s_cselect_b32 s36, 0, s36
  s_cselect_b32 s25, s25, 0
  s_cselect_b32 s26, s26, 0
  s_xor_b32 s4, s4, s25
  s_xor_b32 s5, s5, s26
  s_add_u32 m0, s35, 81920
  s_add_u32 s25, s37, 0
  buffer_load_dwordx4 v246, s[8:11], s25 offen sc1 lds
  s_add_u32 m0, s35, 82944
  s_add_u32 s25, s37, 20480
  buffer_load_dwordx4 v246, s[8:11], s25 offen sc1 lds
  s_add_u32 m0, s35, 83968
  s_add_u32 s25, s37, 40960
  buffer_load_dwordx4 v246, s[8:11], s25 offen sc1 lds
  s_add_u32 m0, s35, 84992
  s_add_u32 s25, s37, 61440
  buffer_load_dwordx4 v246, s[8:11], s25 offen sc1 lds
  s_add_u32 s37, s37, 1024
  s_cmp_eq_u32 s37, 20480
  s_cselect_b32 s37, 0, s37
  s_waitcnt vmcnt(12) lgkmcnt(0)
  s_barrier
  s_add_u32 m0, s34, 98304
  s_add_u32 s25, s36, 0
  buffer_load_dwordx4 v244, s[4:7], s25 offen  lds
  s_add_u32 m0, s34, 99328
  s_add_u32 s25, s36, 10240
  buffer_load_dwordx4 v245, s[4:7], s25 offen  lds
  s_add_u32 m0, s35, 106496
  s_add_u32 s25, s37, 0
  buffer_load_dwordx4 v246, s[8:11], s25 offen sc1 lds
  s_add_u32 m0, s35, 107520
  s_add_u32 s25, s37, 20480
  buffer_load_dwordx4 v246, s[8:11], s25 offen sc1 lds
  s_add_u32 m0, s35, 108544
  s_add_u32 s25, s37, 40960
  buffer_load_dwordx4 v246, s[8:11], s25 offen sc1 lds
  s_add_u32 m0, s35, 109568
  s_add_u32 s25, s37, 61440
  buffer_load_dwordx4 v246, s[8:11], s25 offen sc1 lds
  s_waitcnt vmcnt(12) lgkmcnt(0)
  s_barrier
  s_waitcnt vmcnt(6) lgkmcnt(0)
  s_barrier
  s_waitcnt vmcnt(0) lgkmcnt(0)
  s_barrier
  s_barrier
  s_endpgm
L_oproj:
  s_waitcnt vmcnt(0)
  s_barrier
  s_cmp_lg_u32 s20, 0
  s_cbranch_scc1 L_po1
  s_mul_i32 s26, s31, 1280
  s_lshl_b32 s25, s30, 2
  s_add_u32 s26, s26, s25
  s_add_u32 s26, s26, 15777792
  v_lshlrev_b32 v6, 7, v1
  s_mov_b64 exec, 0x3ff
  buffer_store_dword v6, v6, s[12:15], s26 offen sc1
  s_mov_b64 exec, -1
L_po1:
  s_barrier
  ds_read_b64 v[32:33], v192 offset:16384
  ds_read_b64 v[34:35], v192 offset:16640
  ds_read_b64 v[36:37], v192 offset:20480
  ds_read_b64 v[38:39], v192 offset:20736
  ds_read_b64_tr_b16 v[40:41], v200 offset:0
  ds_read_b64_tr_b16 v[42:43], v200 offset:1024
  ds_read_b64_tr_b16 v[44:45], v201 offset:0
  ds_read_b64_tr_b16 v[46:47], v201 offset:1024
  ds_read_b64 v[48:49], v192 offset:17408
  ds_read_b64 v[50:51], v192 offset:17664
  ds_read_b64 v[52:53], v192 offset:21504
  ds_read_b64 v[54:55], v192 offset:21760
  ds_read_b64_tr_b16 v[56:57], v200 offset:4096
  ds_read_b64_tr_b16 v[58:59], v200 offset:5120
  ds_read_b64_tr_b16 v[60:61], v201 offset:4096
  ds_read_b64_tr_b16 v[62:63], v201 offset:5120
  s_waitcnt lgkmcnt(8)
  v_mfma_f32_32x32x16_bf16 v[64:79], v[32:35], v[40:43], 0
  ds_read_b64 v[144:145], v192 offset:18432
  ds_read_b64 v[146:147], v192 offset:18688
  v_mfma_f32_32x32x16_bf16 v[80:95], v[32:35], v[44:47], 0
  ds_read_b64 v[148:149], v192 offset:22528
  ds_read_b64 v[150:151], v192 offset:22784
  v_mfma_f32_32x32x16_bf16 v[96:111], v[36:39], v[40:43], 0
  ds_read_b64_tr_b16 v[152:153], v200 offset:8192
  ds_read_b64_tr_b16 v[154:155], v200 offset:9216
  v_mfma_f32_32x32x16_bf16 v[112:127], v[36:39], v[44:47], 0
  ds_read_b64_tr_b16 v[156:157], v201 offset:8192
  ds_read_b64_tr_b16 v[158:159], v201 offset:9216
  s_waitcnt lgkmcnt(8)
  v_mfma_f32_32x32x16_bf16 v[64:79], v[48:51], v[56:59], v[64:79]
  ds_read_b64 v[32:33], v192 offset:19456
  ds_read_b64 v[34:35], v192 offset:19712
  v_mfma_f32_32x32x16_bf16 v[80:95], v[48:51], v[60:63], v[80:95]
  ds_read_b64 v[36:37], v192 offset:23552
  ds_read_b64 v[38:39], v192 offset:23808
  v_mfma_f32_32x32x16_bf16 v[96:111], v[52:55], v[56:59], v[96:111]
  ds_read_b64_tr_b16 v[40:41], v200 offset:12288
  ds_read_b64_tr_b16 v[42:43], v200 offset:13312
  v_mfma_f32_32x32x16_bf16 v[112:127], v[52:55], v[60:63], v[112:127]
  ds_read_b64_tr_b16 v[44:45], v201 offset:12288
  ds_read_b64_tr_b16 v[46:47], v201 offset:13312
  s_waitcnt lgkmcnt(0)
  s_barrier
  v_mfma_f32_32x32x16_bf16 v[64:79], v[144:147], v[152:155], v[64:79]
  ds_read_b64 v[48:49], v192 offset:32768
  ds_read_b64 v[50:51], v192 offset:33024
  v_mfma_f32_32x32x16_bf16 v[80:95], v[144:147], v[156:159], v[80:95]
  ds_read_b64 v[52:53], v192 offset:36864
  ds_read_b64 v[54:55], v192 offset:37120
  v_mfma_f32_32x32x16_bf16 v[96:111], v[148:151], v[152:155], v[96:111]
  ds_read_b64_tr_b16 v[56:57], v200 offset:16384
  ds_read_b64_tr_b16 v[58:59], v200 offset:17408
  v_mfma_f32_32x32x16_bf16 v[112:127], v[148:151], v[156:159], v[112:127]
  ds_read_b64_tr_b16 v[60:61], v201 offset:16384
  ds_read_b64_tr_b16 v[62:63], v201 offset:17408
  s_waitcnt lgkmcnt(8)
  v_mfma_f32_32x32x16_bf16 v[64:79], v[32:35], v[40:43], v[64:79]
  ds_read_b64 v[144:145], v192 offset:33792
  ds_read_b64 v[146:147], v192 offset:34048
  v_mfma_f32_32x32x16_bf16 v[80:95], v[32:35], v[44:47], v[80:95]
  ds_read_b64 v[148:149], v192 offset:37888
  ds_read_b64 v[150:151], v192 offset:38144
  v_mfma_f32_32x32x16_bf16 v[96:111], v[36:39], v[40:43], v[96:111]
  ds_read_b64_tr_b16 v[152:153], v200 offset:20480
  ds_read_b64_tr_b16 v[154:155], v200 offset:21504
  v_mfma_f32_32x32x16_bf16 v[112:127], v[36:39], v[44:47], v[112:127]
  ds_read_b64_tr_b16 v[156:157], v201 offset:20480
  ds_read_b64_tr_b16 v[158:159], v201 offset:21504
  s_waitcnt lgkmcnt(8)
  v_mfma_f32_32x32x16_bf16 v[64:79], v[48:51], v[56:59], v[64:79]
  ds_read_b64 v[32:33], v192 offset:34816
  ds_read_b64 v[34:35], v192 offset:35072
  v_mfma_f32_32x32x16_bf16 v[80:95], v[48:51], v[60:63], v[80:95]
  ds_read_b64 v[36:37], v192 offset:38912
  ds_read_b64 v[38:39], v192 offset:39168
  v_mfma_f32_32x32x16_bf16 v[96:111], v[52:55], v[56:59], v[96:111]
  ds_read_b64_tr_b16 v[40:41], v200 offset:24576
  ds_read_b64_tr_b16 v[42:43], v200 offset:25600
  v_mfma_f32_32x32x16_bf16 v[112:127], v[52:55], v[60:63], v[112:127]
  ds_read_b64_tr_b16 v[44:45], v201 offset:24576
  ds_read_b64_tr_b16 v[46:47], v201 offset:25600
  s_waitcnt lgkmcnt(8)
  v_mfma_f32_32x32x16_bf16 v[64:79], v[144:147], v[152:155], v[64:79]
  ds_read_b64 v[48:49], v192 offset:35840
  ds_read_b64 v[50:51], v192 offset:36096
  v_mfma_f32_32x32x16_bf16 v[80:95], v[144:147], v[156:159], v[80:95]
  ds_read_b64 v[52:53], v192 offset:39936
  ds_read_b64 v[54:55], v192 offset:40192
  v_mfma_f32_32x32x16_bf16 v[96:111], v[148:151], v[152:155], v[96:111]
  ds_read_b64_tr_b16 v[56:57], v200 offset:28672
  ds_read_b64_tr_b16 v[58:59], v200 offset:29696
  v_mfma_f32_32x32x16_bf16 v[112:127], v[148:151], v[156:159], v[112:127]
  ds_read_b64_tr_b16 v[60:61], v201 offset:28672
  ds_read_b64_tr_b16 v[62:63], v201 offset:29696
  s_waitcnt lgkmcnt(0)
  s_barrier
  v_mfma_f32_32x32x16_bf16 v[64:79], v[32:35], v[40:43], v[64:79]
  ds_read_b64 v[144:145], v192 offset:49152
  ds_read_b64 v[146:147], v192 offset:49408
  v_mfma_f32_32x32x16_bf16 v[80:95], v[32:35], v[44:47], v[80:95]
  ds_read_b64 v[148:149], v192 offset:53248
  ds_read_b64 v[150:151], v192 offset:53504
  v_mfma_f32_32x32x16_bf16 v[96:111], v[36:39], v[40:43], v[96:111]
  ds_read_b64_tr_b16 v[152:153], v200 offset:32768
  ds_read_b64_tr_b16 v[154:155], v200 offset:33792
  v_mfma_f32_32x32x16_bf16 v[112:127], v[36:39], v[44:47], v[112:127]
  ds_read_b64_tr_b16 v[156:157], v201 offset:32768
  ds_read_b64_tr_b16 v[158:159], v201 offset:33792
  s_waitcnt lgkmcnt(8)
  v_mfma_f32_32x32x16_bf16 v[64:79], v[48:51], v[56:59], v[64:79]
  ds_read_b64 v[32:33], v192 offset:50176
  ds_read_b64 v[34:35], v192 offset:50432
  v_mfma_f32_32x32x16_bf16 v[80:95], v[48:51], v[60:63], v[80:95]
  ds_read_b64 v[36:37], v192 offset:54272
  ds_read_b64 v[38:39], v192 offset:54528
  v_mfma_f32_32x32x16_bf16 v[96:111], v[52:55], v[56:59], v[96:111]
  ds_read_b64_tr_b16 v[40:41], v200 offset:36864
  ds_read_b64_tr_b16 v[42:43], v200 offset:37888
  v_mfma_f32_32x32x16_bf16 v[112:127], v[52:55], v[60:63], v[112:127]
  ds_read_b64_tr_b16 v[44:45], v201 offset:36864
  ds_read_b64_tr_b16 v[46:47], v201 offset:37888
  s_waitcnt lgkmcnt(8)
  v_mfma_f32_32x32x16_bf16 v[64:79], v[144:147], v[152:155], v[64:79]
  ds_read_b64 v[48:49], v192 offset:51200
  ds_read_b64 v[50:51], v192 offset:51456
  v_mfma_f32_32x32x16_bf16 v[80:95], v[144:147], v[156:159], v[80:95]
  ds_read_b64 v[52:53], v192 offset:55296
  ds_read_b64 v[54:55], v192 offset:55552
  v_mfma_f32_32x32x16_bf16 v[96:111], v[148:151], v[152:155], v[96:111]
  ds_read_b64_tr_b16 v[56:57], v200 offset:40960
  ds_read_b64_tr_b16 v[58:59], v200 offset:41984
  v_mfma_f32_32x32x16_bf16 v[112:127], v[148:151], v[156:159], v[112:127]
  ds_read_b64_tr_b16 v[60:61], v201 offset:40960
  ds_read_b64_tr_b16 v[62:63], v201 offset:41984
  s_waitcnt lgkmcnt(8)
  v_mfma_f32_32x32x16_bf16 v[64:79], v[32:35], v[40:43], v[64:79]
  ds_read_b64 v[144:145], v192 offset:52224
  ds_read_b64 v[146:147], v192 offset:52480
  v_mfma_f32_32x32x16_bf16 v[80:95], v[32:35], v[44:47], v[80:95]
  ds_read_b64 v[148:149], v192 offset:56320
  ds_read_b64 v[150:151], v192 offset:56576
  v_mfma_f32_32x32x16_bf16 v[96:111], v[36:39], v[40:43], v[96:111]
  ds_read_b64_tr_b16 v[152:153], v200 offset:45056
  ds_read_b64_tr_b16 v[154:155], v200 offset:46080
  v_mfma_f32_32x32x16_bf16 v[112:127], v[36:39], v[44:47], v[112:127]
  ds_read_b64_tr_b16 v[156:157], v201 offset:45056
  ds_read_b64_tr_b16 v[158:159], v201 offset:46080
  s_waitcnt lgkmcnt(0)
  s_barrier
  v_mfma_f32_32x32x16_bf16 v[64:79], v[48:51], v[56:59], v[64:79]
  ds_read_b64 v[32:33], v196 offset:0
  ds_read_b64 v[34:35], v196 offset:256
  v_mfma_f32_32x32x16_bf16 v[80:95], v[48:51], v[60:63], v[80:95]
  ds_read_b64 v[36:37], v196 offset:4096
  ds_read_b64 v[38:39], v196 offset:4352
  v_mfma_f32_32x32x16_bf16 v[96:111], v[52:55], v[56:59], v[96:111]
  ds_read_b64_tr_b16 v[40:41], v200 offset:49152
  ds_read_b64_tr_b16 v[42:43], v200 offset:50176
  v_mfma_f32_32x32x16_bf16 v[112:127], v[52:55], v[60:63], v[112:127]
  ds_read_b64_tr_b16 v[44:45], v201 offset:49152
  ds_read_b64_tr_b16 v[46:47], v201 offset:50176
  s_waitcnt lgkmcnt(8)
  v_mfma_f32_32x32x16_bf16 v[64:79], v[144:147], v[152:155], v[64:79]
  ds_read_b64 v[48:49], v196 offset:1024
  ds_read_b64 v[50:51], v196 offset:1280
  v_mfma_f32_32x32x16_bf16 v[80:95], v[144:147], v[156:159], v[80:95]
  ds_read_b64 v[52:53], v196 offset:5120
  ds_read_b64 v[54:55], v196 offset:5376
  v_mfma_f32_32x32x16_bf16 v[96:111], v[148:151], v[152:155], v[96:111]
  ds_read_b64_tr_b16 v[56:57], v200 offset:53248
  ds_read_b64_tr_b16 v[58:59], v200 offset:54272
  v_mfma_f32_32x32x16_bf16 v[112:127], v[148:151], v[156:159], v[112:127]
  ds_read_b64_tr_b16 v[60:61], v201 offset:53248
  ds_read_b64_tr_b16 v[62:63], v201 offset:54272
  s_waitcnt lgkmcnt(8)
  v_mfma_f32_32x32x16_bf16 v[64:79], v[32:35], v[40:43], v[64:79]
  ds_read_b64 v[144:145], v196 offset:2048
  ds_read_b64 v[146:147], v196 offset:2304
  v_mfma_f32_32x32x16_bf16 v[80:95], v[32:35], v[44:47], v[80:95]
  ds_read_b64 v[148:149], v196 offset:6144
  ds_read_b64 v[150:151], v196 offset:6400
  v_mfma_f32_32x32x16_bf16 v[96:111], v[36:39], v[40:43], v[96:111]
  ds_read_b64_tr_b16 v[152:153], v200 offset:57344
  ds_read_b64_tr_b16 v[154:155], v200 offset:58368
  v_mfma_f32_32x32x16_bf16 v[112:127], v[36:39], v[44:47], v[112:127]
  ds_read_b64_tr_b16 v[156:157], v201 offset:57344
  ds_read_b64_tr_b16 v[158:159], v201 offset:58368
  s_waitcnt lgkmcnt(8)
  v_mfma_f32_32x32x16_bf16 v[64:79], v[48:51], v[56:59], v[64:79]
  ds_read_b64 v[32:33], v196 offset:3072
  ds_read_b64 v[34:35], v196 offset:3328
  v_mfma_f32_32x32x16_bf16 v[80:95], v[48:51], v[60:63], v[80:95]
  ds_read_b64 v[36:37], v196 offset:7168
  ds_read_b64 v[38:39], v196 offset:7424
  v_mfma_f32_32x32x16_bf16 v[96:111], v[52:55], v[56:59], v[96:111]
  ds_read_b64_tr_b16 v[40:41], v200 offset:61440
  ds_read_b64_tr_b16 v[42:43], v200 offset:62464
  v_mfma_f32_32x32x16_bf16 v[112:127], v[52:55], v[60:63], v[112:127]
  ds_read_b64_tr_b16 v[44:45], v201 offset:61440
  ds_read_b64_tr_b16 v[46:47], v201 offset:62464
  s_waitcnt lgkmcnt(0)
  s_barrier
  v_mfma_f32_32x32x16_bf16 v[64:79], v[144:147], v[152:155], v[64:79]
  ds_read_b64 v[48:49], v196 offset:16384
  ds_read_b64 v[50:51], v196 offset:16640
  v_mfma_f32_32x32x16_bf16 v[80:95], v[144:147], v[156:159], v[80:95]
  ds_read_b64 v[52:53], v196 offset:20480
  ds_read_b64 v[54:55], v196 offset:20736
  v_mfma_f32_32x32x16_bf16 v[96:111], v[148:151], v[152:155], v[96:111]
  ds_read_b64_tr_b16 v[56:57], v204 offset:0
  ds_read_b64_tr_b16 v[58:59], v204 offset:1024
  v_mfma_f32_32x32x16_bf16 v[112:127], v[148:151], v[156:159], v[112:127]
  ds_read_b64_tr_b16 v[60:61], v205 offset:0
  ds_read_b64_tr_b16 v[62:63], v205 offset:1024
  s_waitcnt lgkmcnt(8)
  v_mfma_f32_32x32x16_bf16 v[64:79], v[32:35], v[40:43], v[64:79]
  ds_read_b64 v[144:145], v196 offset:17408
  ds_read_b64 v[146:147], v196 offset:17664
  v_mfma_f32_32x32x16_bf16 v[80:95], v[32:35], v[44:47], v[80:95]
  ds_read_b64 v[148:149], v196 offset:21504
  ds_read_b64 v[150:151], v196 offset:21760
  v_mfma_f32_32x32x16_bf16 v[96:111], v[36:39], v[40:43], v[96:111]
  ds_read_b64_tr_b16 v[152:153], v204 offset:4096
  ds_read_b64_tr_b16 v[154:155], v204 offset:5120
  v_mfma_f32_32x32x16_bf16 v[112:127], v[36:39], v[44:47], v[112:127]
  ds_read_b64_tr_b16 v[156:157], v205 offset:4096
  ds_read_b64_tr_b16 v[158:159], v205 offset:5120
  s_waitcnt lgkmcnt(8)
  v_mfma_f32_32x32x16_bf16 v[64:79], v[48:51], v[56:59], v[64:79]
  ds_read_b64 v[32:33], v196 offset:18432
  ds_read_b64 v[34:35], v196 offset:18688
  v_mfma_f32_32x32x16_bf16 v[80:95], v[48:51], v[60:63], v[80:95]
  ds_read_b64 v[36:37], v196 offset:22528
  ds_read_b64 v[38:39], v196 offset:22784
  v_mfma_f32_32x32x16_bf16 v[96:111], v[52:55], v[56:59], v[96:111]
  ds_read_b64_tr_b16 v[40:41], v204 offset:8192
  ds_read_b64_tr_b16 v[42:43], v204 offset:9216
  v_mfma_f32_32x32x16_bf16 v[112:127], v[52:55], v[60:63], v[112:127]
  ds_read_b64_tr_b16 v[44:45], v205 offset:8192
  ds_read_b64_tr_b16 v[46:47], v205 offset:9216
  s_waitcnt lgkmcnt(8)
  v_mfma_f32_32x32x16_bf16 v[64:79], v[144:147], v[152:155], v[64:79]
  ds_read_b64 v[48:49], v196 offset:19456
  ds_read_b64 v[50:51], v196 offset:19712
  v_mfma_f32_32x32x16_bf16 v[80:95], v[144:147], v[156:159], v[80:95]
  ds_read_b64 v[52:53], v196 offset:23552
  ds_read_b64 v[54:55], v196 offset:23808
  v_mfma_f32_32x32x16_bf16 v[96:111], v[148:151], v[152:155], v[96:111]
  ds_read_b64_tr_b16 v[56:57], v204 offset:12288
  ds_read_b64_tr_b16 v[58:59], v204 offset:13312
  v_mfma_f32_32x32x16_bf16 v[112:127], v[148:151], v[156:159], v[112:127]
  ds_read_b64_tr_b16 v[60:61], v205 offset:12288
  ds_read_b64_tr_b16 v[62:63], v205 offset:13312
  s_waitcnt lgkmcnt(0)
  s_barrier
  v_mfma_f32_32x32x16_bf16 v[64:79], v[32:35], v[40:43], v[64:79]
  ds_read_b64 v[144:145], v192 offset:16384
  ds_read_b64 v[146:147], v192 offset:16640
  v_mfma_f32_32x32x16_bf16 v[80:95], v[32:35], v[44:47], v[80:95]
  ds_read_b64 v[148:149], v192 offset:20480
  ds_read_b64 v[150:151], v192 offset:20736
  v_mfma_f32_32x32x16_bf16 v[96:111], v[36:39], v[40:43], v[96:111]
  ds_read_b64_tr_b16 v[152:153], v200 offset:0
  ds_read_b64_tr_b16 v[154:155], v200 offset:1024
  v_mfma_f32_32x32x16_bf16 v[112:127], v[36:39], v[44:47], v[112:127]
  ds_read_b64_tr_b16 v[156:157], v201 offset:0
  ds_read_b64_tr_b16 v[158:159], v201 offset:1024
  s_waitcnt lgkmcnt(8)
  v_mfma_f32_32x32x16_bf16 v[64:79], v[48:51], v[56:59], v[64:79]
  ds_read_b64 v[32:33], v192 offset:17408
  ds_read_b64 v[34:35], v192 offset:17664
  v_mfma_f32_32x32x16_bf16 v[80:95], v[48:51], v[60:63], v[80:95]
  ds_read_b64 v[36:37], v192 offset:21504
  ds_read_b64 v[38:39], v192 offset:21760
  v_mfma_f32_32x32x16_bf16 v[96:111], v[52:55], v[56:59], v[96:111]
  ds_read_b64_tr_b16 v[40:41], v200 offset:4096
  ds_read_b64_tr_b16 v[42:43], v200 offset:5120
  v_mfma_f32_32x32x16_bf16 v[112:127], v[52:55], v[60:63], v[112:127]
  ds_read_b64_tr_b16 v[44:45], v201 offset:4096
  ds_read_b64_tr_b16 v[46:47], v201 offset:5120
  s_waitcnt lgkmcnt(8)
  v_mfma_f32_32x32x16_bf16 v[64:79], v[144:147], v[152:155], v[64:79]
  ds_read_b64 v[48:49], v192 offset:18432
  ds_read_b64 v[50:51], v192 offset:18688
  v_mfma_f32_32x32x16_bf16 v[80:95], v[144:147], v[156:159], v[80:95]
  ds_read_b64 v[52:53], v192 offset:22528
  ds_read_b64 v[54:55], v192 offset:22784
  v_mfma_f32_32x32x16_bf16 v[96:111], v[148:151], v[152:155], v[96:111]
  ds_read_b64_tr_b16 v[56:57], v200 offset:8192
  ds_read_b64_tr_b16 v[58:59], v200 offset:9216
  v_mfma_f32_32x32x16_bf16 v[112:127], v[148:151], v[156:159], v[112:127]
  ds_read_b64_tr_b16 v[60:61], v201 offset:8192
  ds_read_b64_tr_b16 v[62:63], v201 offset:9216
  s_waitcnt lgkmcnt(8)
  v_mfma_f32_32x32x16_bf16 v[64:79], v[32:35], v[40:43], v[64:79]
  ds_read_b64 v[144:145], v192 offset:19456
  ds_read_b64 v[146:147], v192 offset:19712
  v_mfma_f32_32x32x16_bf16 v[80:95], v[32:35], v[44:47], v[80:95]
  ds_read_b64 v[148:149], v192 offset:23552
  ds_read_b64 v[150:151], v192 offset:23808
  v_mfma_f32_32x32x16_bf16 v[96:111], v[36:39], v[40:43], v[96:111]
  ds_read_b64_tr_b16 v[152:153], v200 offset:12288
  ds_read_b64_tr_b16 v[154:155], v200 offset:13312
  v_mfma_f32_32x32x16_bf16 v[112:127], v[36:39], v[44:47], v[112:127]
  ds_read_b64_tr_b16 v[156:157], v201 offset:12288
  ds_read_b64_tr_b16 v[158:159], v201 offset:13312
  s_waitcnt lgkmcnt(0)
  s_barrier
  v_mfma_f32_32x32x16_bf16 v[64:79], v[48:51], v[56:59], v[64:79]
  ds_read_b64 v[32:33], v192 offset:32768
  ds_read_b64 v[34:35], v192 offset:33024
  v_mfma_f32_32x32x16_bf16 v[80:95], v[48:51], v[60:63], v[80:95]
  ds_read_b64_tr_b16 v[40:41], v200 offset:16384
  ds_read_b64_tr_b16 v[42:43], v200 offset:17408
  v_mfma_f32_32x32x16_bf16 v[96:111], v[52:55], v[56:59], v[96:111]
  ds_read_b64_tr_b16 v[44:45], v201 offset:16384
  ds_read_b64_tr_b16 v[46:47], v201 offset:17408
  v_mfma_f32_32x32x16_bf16 v[112:127], v[52:55], v[60:63], v[112:127]
  s_waitcnt lgkmcnt(6)
  v_mfma_f32_32x32x16_bf16 v[64:79], v[144:147], v[152:155], v[64:79]
  ds_read_b64 v[48:49], v192 offset:33792
  ds_read_b64 v[50:51], v192 offset:34048
  v_mfma_f32_32x32x16_bf16 v[80:95], v[144:147], v[156:159], v[80:95]
  ds_read_b64_tr_b16 v[56:57], v200 offset:20480
  ds_read_b64_tr_b16 v[58:59], v200 offset:21504
  v_mfma_f32_32x32x16_bf16 v[96:111], v[148:151], v[152:155], v[96:111]
  ds_read_b64_tr_b16 v[60:61], v201 offset:20480
  ds_read_b64_tr_b16 v[62:63], v201 offset:21504
  v_mfma_f32_32x32x16_bf16 v[112:127], v[148:151], v[156:159], v[112:127]
  s_waitcnt lgkmcnt(6)
  v_mfma_f32_32x32x16_bf16 v[64:79], v[32:35], v[40:43], v[64:79]
  ds_read_b64 v[144:145], v192 offset:34816
  ds_read_b64 v[146:147], v192 offset:35072
  ds_read_b64_tr_b16 v[152:153], v200 offset:24576
  v_mfma_f32_32x32x16_bf16 v[80:95], v[32:35], v[44:47], v[80:95]
  ds_read_b64_tr_b16 v[154:155], v200 offset:25600
  ds_read_b64_tr_b16 v[156:157], v201 offset:24576
  ds_read_b64_tr_b16 v[158:159], v201 offset:25600
  s_waitcnt lgkmcnt(6)
  v_mfma_f32_32x32x16_bf16 v[64:79], v[48:51], v[56:59], v[64:79]
  ds_read_b64 v[32:33], v192 offset:35840
  ds_read_b64 v[34:35], v192 offset:36096
  ds_read_b64_tr_b16 v[40:41], v200 offset:28672
  v_mfma_f32_32x32x16_bf16 v[80:95], v[48:51], v[60:63], v[80:95]
  ds_read_b64_tr_b16 v[42:43], v200 offset:29696
  ds_read_b64_tr_b16 v[44:45], v201 offset:28672
  ds_read_b64_tr_b16 v[46:47], v201 offset:29696
  s_waitcnt lgkmcnt(0)
  s_barrier
  v_mfma_f32_32x32x16_bf16 v[64:79], v[144:147], v[152:155], v[64:79]
  ds_read_b64 v[48:49], v192 offset:49152
  ds_read_b64 v[50:51], v192 offset:49408
  ds_read_b64_tr_b16 v[56:57], v200 offset:32768
  v_mfma_f32_32x32x16_bf16 v[80:95], v[144:147], v[156:159], v[80:95]
  ds_read_b64_tr_b16 v[58:59], v200 offset:33792
  ds_read_b64_tr_b16 v[60:61], v201 offset:32768
  ds_read_b64_tr_b16 v[62:63], v201 offset:33792
  s_waitcnt lgkmcnt(6)
  v_mfma_f32_32x32x16_bf16 v[64:79], v[32:35], v[40:43], v[64:79]
  ds_read_b64 v[144:145], v192 offset:50176
  ds_read_b64 v[146:147], v192 offset:50432
  ds_read_b64_tr_b16 v[152:153], v200 offset:36864
  v_mfma_f32_32x32x16_bf16 v[80:95], v[32:35], v[44:47], v[80:95]
  ds_read_b64_tr_b16 v[154:155], v200 offset:37888
  ds_read_b64_tr_b16 v[156:157], v201 offset:36864
  ds_read_b64_tr_b16 v[158:159], v201 offset:37888
  s_waitcnt lgkmcnt(6)
  v_mfma_f32_32x32x16_bf16 v[64:79], v[48:51], v[56:59], v[64:79]
  ds_read_b64 v[32:33], v192 offset:51200
  ds_read_b64 v[34:35], v192 offset:51456
  ds_read_b64_tr_b16 v[40:41], v200 offset:40960
  v_mfma_f32_32x32x16_bf16 v[80:95], v[48:51], v[60:63], v[80:95]
  ds_read_b64_tr_b16 v[42:43], v200 offset:41984
  ds_read_b64_tr_b16 v[44:45], v201 offset:40960
  ds_read_b64_tr_b16 v[46:47], v201 offset:41984
  s_waitcnt lgkmcnt(6)
  v_mfma_f32_32x32x16_bf16 v[64:79], v[144:147], v[152:155], v[64:79]
  ds_read_b64 v[48:49], v192 offset:52224
  ds_read_b64 v[50:51], v192 offset:52480
  ds_read_b64_tr_b16 v[56:57], v200 offset:45056
  v_mfma_f32_32x32x16_bf16 v[80:95], v[144:147], v[156:159], v[80:95]
  ds_read_b64_tr_b16 v[58:59], v200 offset:46080
  ds_read_b64_tr_b16 v[60:61], v201 offset:45056
  ds_read_b64_tr_b16 v[62:63], v201 offset:46080
  s_waitcnt lgkmcnt(0)
  s_barrier
  v_mfma_f32_32x32x16_bf16 v[64:79], v[32:35], v[40:43], v[64:79]
  ds_read_b64 v[144:145], v196 offset:0
  ds_read_b64 v[146:147], v196 offset:256
  ds_read_b64_tr_b16 v[152:153], v200 offset:49152
  v_mfma_f32_32x32x16_bf16 v[80:95], v[32:35], v[44:47], v[80:95]
  ds_read_b64_tr_b16 v[154:155], v200 offset:50176
  ds_read_b64_tr_b16 v[156:157], v201 offset:49152
  ds_read_b64_tr_b16 v[158:159], v201 offset:50176
  s_waitcnt lgkmcnt(6)
  v_mfma_f32_32x32x16_bf16 v[64:79], v[48:51], v[56:59], v[64:79]
  ds_read_b64 v[32:33], v196 offset:1024
  ds_read_b64 v[34:35], v196 offset:1280
  ds_read_b64_tr_b16 v[40:41], v200 offset:53248
  v_mfma_f32_32x32x16_bf16 v[80:95], v[48:51], v[60:63], v[80:95]
  ds_read_b64_tr_b16 v[42:43], v200 offset:54272
  ds_read_b64_tr_b16 v[44:45], v201 offset:53248
  ds_read_b64_tr_b16 v[46:47], v201 offset:54272
  s_waitcnt lgkmcnt(6)
  v_mfma_f32_32x32x16_bf16 v[64:79], v[144:147], v[152:155], v[64:79]
  ds_read_b64 v[48:49], v196 offset:2048
  ds_read_b64 v[50:51], v196 offset:2304
  ds_read_b64_tr_b16 v[56:57], v200 offset:57344
  v_mfma_f32_32x32x16_bf16 v[80:95], v[144:147], v[156:159], v[80:95]
  ds_read_b64_tr_b16 v[58:59], v200 offset:58368
  ds_read_b64_tr_b16 v[60:61], v201 offset:57344
  ds_read_b64_tr_b16 v[62:63], v201 offset:58368
  s_waitcnt lgkmcnt(6)
  v_mfma_f32_32x32x16_bf16 v[64:79], v[32:35], v[40:43], v[64:79]
  ds_read_b64 v[144:145], v196 offset:3072
  ds_read_b64 v[146:147], v196 offset:3328
  ds_read_b64_tr_b16 v[152:153], v200 offset:61440
  v_mfma_f32_32x32x16_bf16 v[80:95], v[32:35], v[44:47], v[80:95]
  ds_read_b64_tr_b16 v[154:155], v200 offset:62464
  ds_read_b64_tr_b16 v[156:157], v201 offset:61440
  ds_read_b64_tr_b16 v[158:159], v201 offset:62464
  s_waitcnt lgkmcnt(0)
  s_barrier
  v_mfma_f32_32x32x16_bf16 v[64:79], v[48:51], v[56:59], v[64:79]
  ds_read_b64 v[32:33], v196 offset:16384
  ds_read_b64 v[34:35], v196 offset:16640
  ds_read_b64_tr_b16 v[40:41], v204 offset:0
  v_mfma_f32_32x32x16_bf16 v[80:95], v[48:51], v[60:63], v[80:95]
  ds_read_b64_tr_b16 v[42:43], v204 offset:1024
  ds_read_b64_tr_b16 v[44:45], v205 offset:0
  ds_read_b64_tr_b16 v[46:47], v205 offset:1024
  s_waitcnt lgkmcnt(6)
  v_mfma_f32_32x32x16_bf16 v[64:79], v[144:147], v[152:155], v[64:79]
  ds_read_b64 v[48:49], v196 offset:17408
  ds_read_b64 v[50:51], v196 offset:17664
  ds_read_b64_tr_b16 v[56:57], v204 offset:4096
  v_mfma_f32_32x32x16_bf16 v[80:95], v[144:147], v[156:159], v[80:95]
  ds_read_b64_tr_b16 v[58:59], v204 offset:5120
  ds_read_b64_tr_b16 v[60:61], v205 offset:4096
  ds_read_b64_tr_b16 v[62:63], v205 offset:5120
  s_waitcnt lgkmcnt(6)
  v_mfma_f32_32x32x16_bf16 v[64:79], v[32:35], v[40:43], v[64:79]
  ds_read_b64 v[144:145], v196 offset:18432
  ds_read_b64 v[146:147], v196 offset:18688
  ds_read_b64_tr_b16 v[152:153], v204 offset:8192
  v_mfma_f32_32x32x16_bf16 v[80:95], v[32:35], v[44:47], v[80:95]
  ds_read_b64_tr_b16 v[154:155], v204 offset:9216
  ds_read_b64_tr_b16 v[156:157], v205 offset:8192
  ds_read_b64_tr_b16 v[158:159], v205 offset:9216
  s_waitcnt lgkmcnt(6)
  v_mfma_f32_32x32x16_bf16 v[64:79], v[48:51], v[56:59], v[64:79]
  ds_read_b64 v[32:33], v196 offset:19456
  ds_read_b64 v[34:35], v196 offset:19712
  ds_read_b64_tr_b16 v[40:41], v204 offset:12288
  v_mfma_f32_32x32x16_bf16 v[80:95], v[48:51], v[60:63], v[80:95]
  ds_read_b64_tr_b16 v[42:43], v204 offset:13312
  ds_read_b64_tr_b16 v[44:45], v205 offset:12288
  ds_read_b64_tr_b16 v[46:47], v205 offset:13312
  s_waitcnt lgkmcnt(6)
  v_mfma_f32_32x32x16_bf16 v[64:79], v[144:147], v[152:155], v[64:79]
  ds_read_b64 v[52:53], v192 offset:36864
  ds_read_b64 v[54:55], v192 offset:37120
  ds_read_b64_tr_b16 v[56:57], v200 offset:16384
  v_mfma_f32_32x32x16_bf16 v[80:95], v[144:147], v[156:159], v[80:95]
  ds_read_b64_tr_b16 v[58:59], v200 offset:17408
  ds_read_b64_tr_b16 v[60:61], v201 offset:16384
  ds_read_b64_tr_b16 v[62:63], v201 offset:17408
  s_waitcnt lgkmcnt(6)
  v_mfma_f32_32x32x16_bf16 v[64:79], v[32:35], v[40:43], v[64:79]
  ds_read_b64 v[148:149], v192 offset:37888
  ds_read_b64 v[150:151], v192 offset:38144
  ds_read_b64_tr_b16 v[152:153], v200 offset:20480
  v_mfma_f32_32x32x16_bf16 v[80:95], v[32:35], v[44:47], v[80:95]
  ds_read_b64_tr_b16 v[154:155], v200 offset:21504
  ds_read_b64_tr_b16 v[156:157], v201 offset:20480
  ds_read_b64_tr_b16 v[158:159], v201 offset:21504
  s_waitcnt lgkmcnt(6)
  v_mfma_f32_32x32x16_bf16 v[96:111], v[52:55], v[56:59], v[96:111]
  ds_read_b64 v[36:37], v192 offset:38912
  ds_read_b64 v[38:39], v192 offset:39168
  ds_read_b64_tr_b16 v[40:41], v200 offset:24576
  v_mfma_f32_32x32x16_bf16 v[112:127], v[52:55], v[60:63], v[112:127]
  ds_read_b64_tr_b16 v[42:43], v200 offset:25600
  ds_read_b64_tr_b16 v[44:45], v201 offset:24576
  ds_read_b64_tr_b16 v[46:47], v201 offset:25600
  s_waitcnt lgkmcnt(6)
  v_mfma_f32_32x32x16_bf16 v[96:111], v[148:151], v[152:155], v[96:111]
  ds_read_b64 v[52:53], v192 offset:39936
  ds_read_b64 v[54:55], v192 offset:40192
  ds_read_b64_tr_b16 v[56:57], v200 offset:28672
  v_mfma_f32_32x32x16_bf16 v[112:127], v[148:151], v[156:159], v[112:127]
  ds_read_b64_tr_b16 v[58:59], v200 offset:29696
  ds_read_b64_tr_b16 v[60:61], v201 offset:28672
  ds_read_b64_tr_b16 v[62:63], v201 offset:29696
  s_mov_b32 s25, 0
  buffer_store_dword v64, v254, s[68:71], s25 offen offset:0 sc1
  buffer_store_dword v80, v254, s[68:71], s25 offen offset:128 sc1
  s_mov_b32 s25, 5120
  buffer_store_dword v65, v254, s[68:71], s25 offen offset:0 sc1
  buffer_store_dword v81, v254, s[68:71], s25 offen offset:128 sc1
  s_waitcnt lgkmcnt(6)
  v_mfma_f32_32x32x16_bf16 v[96:111], v[36:39], v[40:43], v[96:111]
  ds_read_b64 v[148:149], v192 offset:53248
  ds_read_b64 v[150:151], v192 offset:53504
  ds_read_b64_tr_b16 v[152:153], v200 offset:32768
  v_mfma_f32_32x32x16_bf16 v[112:127], v[36:39], v[44:47], v[112:127]
  ds_read_b64_tr_b16 v[154:155], v200 offset:33792
  ds_read_b64_tr_b16 v[156:157], v201 offset:32768
  ds_read_b64_tr_b16 v[158:159], v201 offset:33792
  s_mov_b32 s25, 10240
  buffer_store_dword v66, v254, s[68:71], s25 offen offset:0 sc1
  buffer_store_dword v82, v254, s[68:71], s25 offen offset:128 sc1
  s_mov_b32 s25, 15360
  buffer_store_dword v67, v254, s[68:71], s25 offen offset:0 sc1
  buffer_store_dword v83, v254, s[68:71], s25 offen offset:128 sc1
  s_waitcnt lgkmcnt(6)
  v_mfma_f32_32x32x16_bf16 v[96:111], v[52:55], v[56:59], v[96:111]
  ds_read_b64 v[36:37], v192 offset:54272
  ds_read_b64 v[38:39], v192 offset:54528
  ds_read_b64_tr_b16 v[40:41], v200 offset:36864
  v_mfma_f32_32x32x16_bf16 v[112:127], v[52:55], v[60:63], v[112:127]
  ds_read_b64_tr_b16 v[42:43], v200 offset:37888
  ds_read_b64_tr_b16 v[44:45], v201 offset:36864
  ds_read_b64_tr_b16 v[46:47], v201 offset:37888
  s_mov_b32 s25, 40960
  buffer_store_dword v68, v254, s[68:71], s25 offen offset:0 sc1
  buffer_store_dword v84, v254, s[68:71], s25 offen offset:128 sc1
  s_waitcnt lgkmcnt(6)
  v_mfma_f32_32x32x16_bf16 v[96:111], v[148:151], v[152:155], v[96:111]
  ds_read_b64 v[52:53], v192 offset:55296
  ds_read_b64 v[54:55], v192 offset:55552
  ds_read_b64_tr_b16 v[56:57], v200 offset:40960
  v_mfma_f32_32x32x16_bf16 v[112:127], v[148:151], v[156:159], v[112:127]
  ds_read_b64_tr_b16 v[58:59], v200 offset:41984
  ds_read_b64_tr_b16 v[60:61], v201 offset:40960
  ds_read_b64_tr_b16 v[62:63], v201 offset:41984
  s_mov_b32 s25, 46080
  buffer_store_dword v69, v254, s[68:71], s25 offen offset:0 sc1
  buffer_store_dword v85, v254, s[68:71], s25 offen offset:128 sc1
  s_waitcnt lgkmcnt(6)
  v_mfma_f32_32x32x16_bf16 v[96:111], v[36:39], v[40:43], v[96:111]
  ds_read_b64 v[148:149], v192 offset:56320
  ds_read_b64 v[150:151], v192 offset:56576
  ds_read_b64_tr_b16 v[152:153], v200 offset:45056
  v_mfma_f32_32x32x16_bf16 v[112:127], v[36:39], v[44:47], v[112:127]
  ds_read_b64_tr_b16 v[154:155], v200 offset:46080
  ds_read_b64_tr_b16 v[156:157], v201 offset:45056
  ds_read_b64_tr_b16 v[158:159], v201 offset:46080
  s_mov_b32 s25, 51200
  buffer_store_dword v70, v254, s[68:71], s25 offen offset:0 sc1
  buffer_store_dword v86, v254, s[68:71], s25 offen offset:128 sc1
  s_waitcnt lgkmcnt(6)
  v_mfma_f32_32x32x16_bf16 v[96:111], v[52:55], v[56:59], v[96:111]
  ds_read_b64 v[36:37], v196 offset:4096
  ds_read_b64 v[38:39], v196 offset:4352
  ds_read_b64_tr_b16 v[40:41], v200 offset:49152
  v_mfma_f32_32x32x16_bf16 v[112:127], v[52:55], v[60:63], v[112:127]
  ds_read_b64_tr_b16 v[42:43], v200 offset:50176
  ds_read_b64_tr_b16 v[44:45], v201 offset:49152
  ds_read_b64_tr_b16 v[46:47], v201 offset:50176
  s_mov_b32 s25, 56320
  buffer_store_dword v71, v254, s[68:71], s25 offen offset:0 sc1
  buffer_store_dword v87, v254, s[68:71], s25 offen offset:128 sc1
  s_waitcnt lgkmcnt(6)
  v_mfma_f32_32x32x16_bf16 v[96:111], v[148:151], v[152:155], v[96:111]
  ds_read_b64 v[52:53], v196 offset:5120
  ds_read_b64 v[54:55], v196 offset:5376
  ds_read_b64_tr_b16 v[56:57], v200 offset:53248
  v_mfma_f32_32x32x16_bf16 v[112:127], v[148:151], v[156:159], v[112:127]
  ds_read_b64_tr_b16 v[58:59], v200 offset:54272
  ds_read_b64_tr_b16 v[60:61], v201 offset:53248
  ds_read_b64_tr_b16 v[62:63], v201 offset:54272
  s_mov_b32 s25, 81920
  buffer_store_dword v72, v254, s[68:71], s25 offen offset:0 sc1
  buffer_store_dword v88, v254, s[68:71], s25 offen offset:128 sc1
  s_waitcnt lgkmcnt(6)
  v_mfma_f32_32x32x16_bf16 v[96:111], v[36:39], v[40:43], v[96:111]
  ds_read_b64 v[148:149], v196 offset:6144
  ds_read_b64 v[150:151], v196 offset:6400
  ds_read_b64_tr_b16 v[152:153], v200 offset:57344
  v_mfma_f32_32x32x16_bf16 v[112:127], v[36:39], v[44:47], v[112:127]
  ds_read_b64_tr_b16 v[154:155], v200 offset:58368
  ds_read_b64_tr_b16 v[156:157], v201 offset:57344
  ds_read_b64_tr_b16 v[158:159], v201 offset:58368
  s_mov_b32 s25, 87040
  buffer_store_dword v73, v254, s[68:71], s25 offen offset:0 sc1
  buffer_store_dword v89, v254, s[68:71], s25 offen offset:128 sc1
  s_waitcnt lgkmcnt(6)
  v_mfma_f32_32x32x16_bf16 v[96:111], v[52:55], v[56:59], v[96:111]
  ds_read_b64 v[36:37], v196 offset:7168
  ds_read_b64 v[38:39], v196 offset:7424
  ds_read_b64_tr_b16 v[40:41], v200 offset:61440
  v_mfma_f32_32x32x16_bf16 v[112:127], v[52:55], v[60:63], v[112:127]
  ds_read_b64_tr_b16 v[42:43], v200 offset:62464
  ds_read_b64_tr_b16 v[44:45], v201 offset:61440
  ds_read_b64_tr_b16 v[46:47], v201 offset:62464
  s_mov_b32 s25, 92160
  buffer_store_dword v74, v254, s[68:71], s25 offen offset:0 sc1
  buffer_store_dword v90, v254, s[68:71], s25 offen offset:128 sc1
  s_waitcnt lgkmcnt(6)
  v_mfma_f32_32x32x16_bf16 v[96:111], v[148:151], v[152:155], v[96:111]
  ds_read_b64 v[52:53], v196 offset:20480
  ds_read_b64 v[54:55], v196 offset:20736
  ds_read_b64_tr_b16 v[56:57], v204 offset:0
  v_mfma_f32_32x32x16_bf16 v[112:127], v[148:151], v[156:159], v[112:127]
  ds_read_b64_tr_b16 v[58:59], v204 offset:1024
  ds_read_b64_tr_b16 v[60:61], v205 offset:0
  ds_read_b64_tr_b16 v[62:63], v205 offset:1024
  s_mov_b32 s25, 97280
  buffer_store_dword v75, v254, s[68:71], s25 offen offset:0 sc1
  buffer_store_dword v91, v254, s[68:71], s25 offen offset:128 sc1
  s_waitcnt lgkmcnt(6)
  v_mfma_f32_32x32x16_bf16 v[96:111], v[36:39], v[40:43], v[96:111]
  ds_read_b64 v[148:149], v196 offset:21504
  ds_read_b64 v[150:151], v196 offset:21760
  ds_read_b64_tr_b16 v[152:153], v204 offset:4096
  v_mfma_f32_32x32x16_bf16 v[112:127], v[36:39], v[44:47], v[112:127]
  ds_read_b64_tr_b16 v[154:155], v204 offset:5120
  ds_read_b64_tr_b16 v[156:157], v205 offset:4096
  ds_read_b64_tr_b16 v[158:159], v205 offset:5120
  s_mov_b32 s25, 122880
  buffer_store_dword v76, v254, s[68:71], s25 offen offset:0 sc1
  buffer_store_dword v92, v254, s[68:71], s25 offen offset:128 sc1
  s_waitcnt lgkmcnt(6)
  v_mfma_f32_32x32x16_bf16 v[96:111], v[52:55], v[56:59], v[96:111]
  ds_read_b64 v[36:37], v196 offset:22528
  ds_read_b64 v[38:39], v196 offset:22784
  ds_read_b64_tr_b16 v[40:41], v204 offset:8192
  v_mfma_f32_32x32x16_bf16 v[112:127], v[52:55], v[60:63], v[112:127]
  ds_read_b64_tr_b16 v[42:43], v204 offset:9216
  ds_read_b64_tr_b16 v[44:45], v205 offset:8192
  ds_read_b64_tr_b16 v[46:47], v205 offset:9216
  s_mov_b32 s25, 128000
  buffer_store_dword v77, v254, s[68:71], s25 offen offset:0 sc1
  buffer_store_dword v93, v254, s[68:71], s25 offen offset:128 sc1
  s_waitcnt lgkmcnt(6)
  v_mfma_f32_32x32x16_bf16 v[96:111], v[148:151], v[152:155], v[96:111]
  ds_read_b64 v[52:53], v196 offset:23552
  ds_read_b64 v[54:55], v196 offset:23808
  ds_read_b64_tr_b16 v[56:57], v204 offset:12288
  v_mfma_f32_32x32x16_bf16 v[112:127], v[148:151], v[156:159], v[112:127]
  ds_read_b64_tr_b16 v[58:59], v204 offset:13312
  ds_read_b64_tr_b16 v[60:61], v205 offset:12288
  ds_read_b64_tr_b16 v[62:63], v205 offset:13312
  s_mov_b32 s25, 133120
  buffer_store_dword v78, v254, s[68:71], s25 offen offset:0 sc1
  buffer_store_dword v94, v254, s[68:71], s25 offen offset:128 sc1
  s_waitcnt lgkmcnt(6)
  v_mfma_f32_32x32x16_bf16 v[96:111], v[36:39], v[40:43], v[96:111]
  v_mfma_f32_32x32x16_bf16 v[112:127], v[36:39], v[44:47], v[112:127]
  s_mov_b32 s25, 138240
  buffer_store_dword v79, v254, s[68:71], s25 offen offset:0 sc1
  buffer_store_dword v95, v254, s[68:71], s25 offen offset:128 sc1
  s_waitcnt lgkmcnt(0)
  v_mfma_f32_32x32x16_bf16 v[96:111], v[52:55], v[56:59], v[96:111]
  v_mfma_f32_32x32x16_bf16 v[112:127], v[52:55], v[60:63], v[112:127]
  s_mov_b32 s25, 163840
  s_nop 9
  buffer_store_dword v96, v254, s[68:71], s25 offen offset:0 sc1
  buffer_store_dword v112, v254, s[68:71], s25 offen offset:128 sc1
  s_mov_b32 s25, 168960
  buffer_store_dword v97, v254, s[68:71], s25 offen offset:0 sc1
  buffer_store_dword v113, v254, s[68:71], s25 offen offset:128 sc1
  s_mov_b32 s25, 174080
  buffer_store_dword v98, v254, s[68:71], s25 offen offset:0 sc1
  buffer_store_dword v114, v254, s[68:71], s25 offen offset:128 sc1
  s_mov_b32 s25, 179200
  buffer_store_dword v99, v254, s[68:71], s25 offen offset:0 sc1
  buffer_store_dword v115, v254, s[68:71], s25 offen offset:128 sc1
  s_mov_b32 s25, 204800
  buffer_store_dword v100, v254, s[68:71], s25 offen offset:0 sc1
  buffer_store_dword v116, v254, s[68:71], s25 offen offset:128 sc1
  s_mov_b32 s25, 209920
  buffer_store_dword v101, v254, s[68:71], s25 offen offset:0 sc1
  buffer_store_dword v117, v254, s[68:71], s25 offen offset:128 sc1
  s_mov_b32 s25, 215040
  buffer_store_dword v102, v254, s[68:71], s25 offen offset:0 sc1
  buffer_store_dword v118, v254, s[68:71], s25 offen offset:128 sc1
  s_mov_b32 s25, 220160
  buffer_store_dword v103, v254, s[68:71], s25 offen offset:0 sc1
  buffer_store_dword v119, v254, s[68:71], s25 offen offset:128 sc1
  s_mov_b32 s25, 245760
  buffer_store_dword v104, v254, s[68:71], s25 offen offset:0 sc1
  buffer_store_dword v120, v254, s[68:71], s25 offen offset:128 sc1
  s_mov_b32 s25, 250880
  buffer_store_dword v105, v254, s[68:71], s25 offen offset:0 sc1
  buffer_store_dword v121, v254, s[68:71], s25 offen offset:128 sc1
  s_mov_b32 s25, 256000
  buffer_store_dword v106, v254, s[68:71], s25 offen offset:0 sc1
  buffer_store_dword v122, v254, s[68:71], s25 offen offset:128 sc1
  s_mov_b32 s25, 261120
  buffer_store_dword v107, v254, s[68:71], s25 offen offset:0 sc1
  buffer_store_dword v123, v254, s[68:71], s25 offen offset:128 sc1
  s_mov_b32 s25, 286720
  buffer_store_dword v108, v254, s[68:71], s25 offen offset:0 sc1
  buffer_store_dword v124, v254, s[68:71], s25 offen offset:128 sc1
  s_mov_b32 s25, 291840
  buffer_store_dword v109, v254, s[68:71], s25 offen offset:0 sc1
  buffer_store_dword v125, v254, s[68:71], s25 offen offset:128 sc1
  s_mov_b32 s25, 296960
  buffer_store_dword v110, v254, s[68:71], s25 offen offset:0 sc1
  buffer_store_dword v126, v254, s[68:71], s25 offen offset:128 sc1
  s_mov_b32 s25, 302080
  buffer_store_dword v111, v254, s[68:71], s25 offen offset:0 sc1
  buffer_store_dword v127, v254, s[68:71], s25 offen offset:128 sc1
  s_endpgm
L_opp:
  s_waitcnt vmcnt(2)
  v_cmp_eq_u32 vcc, -1, v253
  s_nop 1
  s_cbranch_vccnz L_op_late
  s_add_u32 m0, s34, 81920
  s_add_u32 s25, s36, 0
  buffer_load_dwordx4 v244, s[4:7], s25 offen sc1 lds
  s_add_u32 m0, s34, 82944
  s_add_u32 s25, s36, 1024
  buffer_load_dwordx4 v244, s[4:7], s25 offen sc1 lds
  s_add_u32 m0, s34, 83968
  s_add_u32 s25, s36, 2048
  buffer_load_dwordx4 v244, s[4:7], s25 offen sc1 lds
  s_add_u32 m0, s34, 84992
  s_add_u32 s25, s36, 3072
  buffer_load_dwordx4 v244, s[4:7], s25 offen sc1 lds
  s_add_u32 s36, s36, 4096
  s_cmp_eq_u32 s36, 20480
  s_cselect_b32 s36, 0, s36
  s_add_u32 m0, s34, 98304
  s_add_u32 s25, s36, 0
  buffer_load_dwordx4 v244, s[4:7], s25 offen sc1 lds
  s_add_u32 m0, s34, 99328
  s_add_u32 s25, s36, 1024
  buffer_load_dwordx4 v244, s[4:7], s25 offen sc1 lds
  s_add_u32 m0, s34, 100352
  s_add_u32 s25, s36, 2048
  buffer_load_dwordx4 v244, s[4:7], s25 offen sc1 lds
  s_add_u32 m0, s34, 101376
  s_add_u32 s25, s36, 3072
  buffer_load_dwordx4 v244, s[4:7], s25 offen sc1 lds
  s_add_u32 s36, s36, 4096
  s_cmp_eq_u32 s36, 20480
  s_cselect_b32 s36, 0, s36
  s_waitcnt vmcnt(8)
  s_barrier
  s_branch L_op_run
L_op_late:
  s_waitcnt vmcnt(0)
  s_barrier
L_op1:
  buffer_load_dword v253, v252, s[12:15], s3 offen offset:0 sc1
  s_waitcnt vmcnt(0)
  v_cmp_eq_u32 vcc, -1, v253
  s_nop 1
  s_cbranch_vccz L_op1g
  s_sleep 2
  s_branch L_op1
L_op1g:
  s_add_u32 m0, s34, 81920
  s_add_u32 s25, s36, 0
  buffer_load_dwordx4 v244, s[4:7], s25 offen sc1 lds
  s_add_u32 m0, s34, 82944
  s_add_u32 s25, s36, 1024
  buffer_load_dwordx4 v244, s[4:7], s25 offen sc1 lds
  s_add_u32 m0, s34, 83968
  s_add_u32 s25, s36, 2048
  buffer_load_dwordx4 v244, s[4:7], s25 offen sc1 lds
  s_add_u32 m0, s34, 84992
  s_add_u32 s25, s36, 3072
  buffer_load_dwordx4 v244, s[4:7], s25 offen sc1 lds
  s_add_u32 s36, s36, 4096
  s_cmp_eq_u32 s36, 20480
  s_cselect_b32 s36, 0, s36
  s_add_u32 m0, s34, 98304
  s_add_u32 s25, s36, 0
  buffer_load_dwordx4 v244, s[4:7], s25 offen sc1 lds
  s_add_u32 m0, s34, 99328
  s_add_u32 s25, s36, 1024
  buffer_load_dwordx4 v244, s[4:7], s25 offen sc1 lds
  s_add_u32 m0, s34, 100352
  s_add_u32 s25, s36, 2048
  buffer_load_dwordx4 v244, s[4:7], s25 offen sc1 lds
  s_add_u32 m0, s34, 101376
  s_add_u32 s25, s36, 3072
  buffer_load_dwordx4 v244, s[4:7], s25 offen sc1 lds
  s_add_u32 s36, s36, 4096
  s_cmp_eq_u32 s36, 20480
  s_cselect_b32 s36, 0, s36
L_op_run:
  s_waitcnt vmcnt(4)
  s_barrier
  s_add_u32 m0, s34, 114688
  s_add_u32 s25, s36, 0
  buffer_load_dwordx4 v244, s[4:7], s25 offen sc1 lds
  s_add_u32 m0, s34, 115712
  s_add_u32 s25, s36, 1024
  buffer_load_dwordx4 v244, s[4:7], s25 offen sc1 lds
  s_add_u32 m0, s34, 116736
  s_add_u32 s25, s36, 2048
  buffer_load_dwordx4 v244, s[4:7], s25 offen sc1 lds
  s_add_u32 m0, s34, 117760
  s_add_u32 s25, s36, 3072
  buffer_load_dwordx4 v244, s[4:7], s25 offen sc1 lds
  s_add_u32 s36, s36, 4096
  s_cmp_eq_u32 s36, 20480
  s_cselect_b32 s36, 0, s36
  s_add_u32 m0, s34, 131072
  s_add_u32 s25, s36, 0
  buffer_load_dwordx4 v244, s[4:7], s25 offen sc1 lds
  s_add_u32 m0, s34, 132096
  s_add_u32 s25, s36, 1024
  buffer_load_dwordx4 v244, s[4:7], s25 offen sc1 lds
  s_add_u32 m0, s34, 133120
  s_add_u32 s25, s36, 2048
  buffer_load_dwordx4 v244, s[4:7], s25 offen sc1 lds
  s_add_u32 m0, s34, 134144
  s_add_u32 s25, s36, 3072
  buffer_load_dwordx4 v244, s[4:7], s25 offen sc1 lds
  s_add_u32 s36, s36, 4096
  s_cmp_eq_u32 s36, 20480
  s_cselect_b32 s36, 0, s36
  s_waitcnt vmcnt(8) lgkmcnt(0)
  s_barrier
  s_add_u32 m0, s34, 147456
  s_add_u32 s25, s36, 0
  buffer_load_dwordx4 v244, s[4:7], s25 offen sc1 lds
  s_add_u32 m0, s34, 148480
  s_add_u32 s25, s36, 1024
  buffer_load_dwordx4 v244, s[4:7], s25 offen sc1 lds
  s_add_u32 m0, s34, 149504
  s_add_u32 s25, s36, 2048
  buffer_load_dwordx4 v244, s[4:7], s25 offen sc1 lds
  s_add_u32 m0, s34, 150528
  s_add_u32 s25, s36, 3072
  buffer_load_dwordx4 v244, s[4:7], s25 offen sc1 lds
  s_add_u32 s36, s36, 4096
  s_cmp_eq_u32 s36, 20480
  s_cselect_b32 s36, 0, s36
L_op2:
  buffer_load_dword v253, v252, s[12:15], s3 offen offset:64 sc1
  s_waitcnt vmcnt(0)
  v_cmp_eq_u32 vcc, -1, v253
  s_nop 1
  s_cbranch_vccz L_op2g
  s_sleep 2
  s_branch L_op2
L_op2g:
  s_waitcnt vmcnt(8) lgkmcnt(0)
  s_barrier
  s_add_u32 m0, s34, 81920
  s_add_u32 s25, s36, 20480
  buffer_load_dwordx4 v244, s[4:7], s25 offen sc1 lds
  s_add_u32 m0, s34, 82944
  s_add_u32 s25, s36, 21504
  buffer_load_dwordx4 v244, s[4:7], s25 offen sc1 lds
  s_add_u32 m0, s34, 83968
  s_add_u32 s25, s36, 22528
  buffer_load_dwordx4 v244, s[4:7], s25 offen sc1 lds
  s_add_u32 m0, s34, 84992
  s_add_u32 s25, s36, 23552
  buffer_load_dwordx4 v244, s[4:7], s25 offen sc1 lds
  s_add_u32 s36, s36, 4096
  s_cmp_eq_u32 s36, 20480
  s_cselect_b32 s36, 0, s36
  s_add_u32 m0, s35, 0
  s_add_u32 s25, s37, 409600
  buffer_load_dwordx4 v246, s[8:11], s25 offen  lds
  s_add_u32 m0, s35, 1024
  s_add_u32 s25, s37, 414720
  buffer_load_dwordx4 v246, s[8:11], s25 offen  lds
  s_add_u32 m0, s35, 2048
  s_add_u32 s25, s37, 419840
  buffer_load_dwordx4 v246, s[8:11], s25 offen  lds
  s_add_u32 m0, s35, 3072
  s_add_u32 s25, s37, 424960
  buffer_load_dwordx4 v246, s[8:11], s25 offen  lds
  s_add_u32 s37, s37, 81920
  s_cmp_eq_u32 s37, 409600
  s_cselect_b32 s37, 0, s37
  s_waitcnt vmcnt(12) lgkmcnt(0)
  s_barrier
  s_add_u32 m0, s34, 98304
  s_add_u32 s25, s36, 20480
  buffer_load_dwordx4 v244, s[4:7], s25 offen sc1 lds
  s_add_u32 m0, s34, 99328
  s_add_u32 s25, s36, 21504
  buffer_load_dwordx4 v244, s[4:7], s25 offen sc1 lds
  s_add_u32 m0, s34, 100352
  s_add_u32 s25, s36, 22528
  buffer_load_dwordx4 v244, s[4:7], s25 offen sc1 lds
  s_add_u32 m0, s34, 101376
  s_add_u32 s25, s36, 23552
  buffer_load_dwordx4 v244, s[4:7], s25 offen sc1 lds
  s_add_u32 s36, s36, 4096
  s_cmp_eq_u32 s36, 20480
  s_cselect_b32 s36, 0, s36
  s_add_u32 m0, s35, 16384
  s_add_u32 s25, s37, 409600
  buffer_load_dwordx4 v246, s[8:11], s25 offen  lds
  s_add_u32 m0, s35, 17408
  s_add_u32 s25, s37, 414720
  buffer_load_dwordx4 v246, s[8:11], s25 offen  lds
  s_add_u32 m0, s35, 18432
  s_add_u32 s25, s37, 419840
  buffer_load_dwordx4 v246, s[8:11], s25 offen  lds
  s_add_u32 m0, s35, 19456
  s_add_u32 s25, s37, 424960
  buffer_load_dwordx4 v246, s[8:11], s25 offen  lds
  s_add_u32 s37, s37, 81920
  s_cmp_eq_u32 s37, 409600
  s_cselect_b32 s37, 0, s37
  s_waitcnt vmcnt(16) lgkmcnt(0)
  s_barrier
  s_add_u32 m0, s34, 114688
  s_add_u32 s25, s36, 20480
  buffer_load_dwordx4 v244, s[4:7], s25 offen sc1 lds
  s_add_u32 m0, s34, 115712
  s_add_u32 s25, s36, 21504
  buffer_load_dwordx4 v244, s[4:7], s25 offen sc1 lds
  s_add_u32 m0, s34, 116736
  s_add_u32 s25, s36, 22528
  buffer_load_dwordx4 v244, s[4:7], s25 offen sc1 lds
  s_add_u32 m0, s34, 117760
  s_add_u32 s25, s36, 23552
  buffer_load_dwordx4 v244, s[4:7], s25 offen sc1 lds
  s_add_u32 s36, s36, 4096
  s_cmp_eq_u32 s36, 20480
  s_cselect_b32 s36, 0, s36
  s_add_u32 m0, s35, 32768
  s_add_u32 s25, s37, 409600
  buffer_load_dwordx4 v246, s[8:11], s25 offen  lds
  s_add_u32 m0, s35, 33792
  s_add_u32 s25, s37, 414720
  buffer_load_dwordx4 v246, s[8:11], s25 offen  lds
  s_add_u32 m0, s35, 34816
  s_add_u32 s25, s37, 419840
  buffer_load_dwordx4 v246, s[8:11], s25 offen  lds
  s_add_u32 m0, s35, 35840
  s_add_u32 s25, s37, 424960
  buffer_load_dwordx4 v246, s[8:11], s25 offen  lds
  s_add_u32 s37, s37, 81920
  s_cmp_eq_u32 s37, 409600
  s_cselect_b32 s37, 0, s37
  s_waitcnt vmcnt(16) lgkmcnt(0)
  s_barrier
  s_add_u32 m0, s34, 131072
  s_add_u32 s25, s36, 20480
  buffer_load_dwordx4 v244, s[4:7], s25 offen sc1 lds
  s_add_u32 m0, s34, 132096
  s_add_u32 s25, s36, 21504
  buffer_load_dwordx4 v244, s[4:7], s25 offen sc1 lds
  s_add_u32 m0, s34, 133120
  s_add_u32 s25, s36, 22528
  buffer_load_dwordx4 v244, s[4:7], s25 offen sc1 lds
  s_add_u32 m0, s34, 134144
  s_add_u32 s25, s36, 23552
  buffer_load_dwordx4 v244, s[4:7], s25 offen sc1 lds
  s_add_u32 s36, s36, 4096
  s_cmp_eq_u32 s36, 20480
  s_cselect_b32 s36, 0, s36
  s_add_u32 m0, s35, 49152
  s_add_u32 s25, s37, 409600
  buffer_load_dwordx4 v246, s[8:11], s25 offen  lds
  s_add_u32 m0, s35, 50176
  s_add_u32 s25, s37, 414720
  buffer_load_dwordx4 v246, s[8:11], s25 offen  lds
  s_add_u32 m0, s35, 51200
  s_add_u32 s25, s37, 419840
  buffer_load_dwordx4 v246, s[8:11], s25 offen  lds
  s_add_u32 m0, s35, 52224
  s_add_u32 s25, s37, 424960
  buffer_load_dwordx4 v246, s[8:11], s25 offen  lds
  s_add_u32 s37, s37, 81920
  s_cmp_eq_u32 s37, 409600
  s_cselect_b32 s37, 0, s37
  s_waitcnt vmcnt(16) lgkmcnt(0)
  s_barrier
  s_add_u32 m0, s34, 147456
  s_add_u32 s25, s36, 20480
  buffer_load_dwordx4 v244, s[4:7], s25 offen sc1 lds
  s_add_u32 m0, s34, 148480
  s_add_u32 s25, s36, 21504
  buffer_load_dwordx4 v244, s[4:7], s25 offen sc1 lds
  s_add_u32 m0, s34, 149504
  s_add_u32 s25, s36, 22528
  buffer_load_dwordx4 v244, s[4:7], s25 offen sc1 lds
  s_add_u32 m0, s34, 150528
  s_add_u32 s25, s36, 23552
  buffer_load_dwordx4 v244, s[4:7], s25 offen sc1 lds
  s_add_u32 m0, s35, 65536
  s_add_u32 s25, s37, 409600
  buffer_load_dwordx4 v246, s[8:11], s25 offen  lds
  s_add_u32 m0, s35, 66560
  s_add_u32 s25, s37, 414720
  buffer_load_dwordx4 v246, s[8:11], s25 offen  lds
  s_add_u32 m0, s35, 67584
  s_add_u32 s25, s37, 419840
  buffer_load_dwordx4 v246, s[8:11], s25 offen  lds
  s_add_u32 m0, s35, 68608
  s_add_u32 s25, s37, 424960
  buffer_load_dwordx4 v246, s[8:11], s25 offen  lds
  s_waitcnt vmcnt(16) lgkmcnt(0)
  s_barrier
  s_waitcnt vmcnt(8) lgkmcnt(0)
  s_barrier
  s_waitcnt vmcnt(0) lgkmcnt(0)
  s_barrier
  s_endpgm
L_spare:
  s_waitcnt vmcnt(0)
  s_barrier
  s_cmp_lg_u32 s20, 0
  s_cbranch_scc1 L_po2
  s_mul_i32 s26, s31, 1280
  s_lshl_b32 s25, s30, 2
  s_add_u32 s26, s26, s25
  s_add_u32 s26, s26, 15777792
  v_lshlrev_b32 v6, 7, v1
  s_mov_b64 exec, 0x3ff
  buffer_store_dword v6, v6, s[12:15], s26 offen sc1
  s_mov_b64 exec, -1
L_po2:
  v_and_b32 v252, 15, v1
  v_lshlrev_b32 v252, 2, v252
  v_lshlrev_b32 v6, 7, v1
  s_mul_i32 s3, s53, 1280
  s_add_u32 s3, s3, 15777792
  s_lshl_b32 s25, s53, 3
  s_add_u32 s25, s25, s20
  s_mul_i32 s25, s25, 40960
  s_mul_i32 s26, s47, 10240
  s_add_u32 s25, s25, s26
  s_add_u32 s25, s25, 7864320
  s_cmp_lg_u32 s20, 0
  s_cbranch_scc1 L_wf3
  s_add_u32 s26, s3, 0
  v_lshlrev_b32 v9, 2, v1
  s_mov_b32 exec_lo, 0xffff
  s_mov_b32 exec_hi, 0
L_wp3:
  buffer_load_dword v8, v9, s[12:15], s26 offen sc1
  s_waitcnt vmcnt(0)
  v_cmp_eq_u32 vcc, -1, v8
  s_nop 1
  s_cbranch_vccz L_wg3
  s_sleep 2
  s_branch L_wp3
L_wg3:
  s_mov_b64 exec, -1
L_wf3:
  s_barrier
  buffer_load_dword v7, v6, s[12:15], s25 offen sc1
  s_add_u32 s26, s25, 8192
  s_mov_b32 exec_lo, 0xffff
  s_mov_b32 exec_hi, 0
  buffer_load_dword v7, v6, s[12:15], s26 offen sc1
  s_mov_b64 exec, -1
  s_add_u32 s25, s25, 20480
  s_cmp_lg_u32 s20, 0
  s_cbranch_scc1 L_wf4
  s_add_u32 s26, s3, 64
  v_lshlrev_b32 v9, 2, v1
  s_mov_b32 exec_lo, 0xffff
  s_mov_b32 exec_hi, 0
L_wp4:
  buffer_load_dword v8, v9, s[12:15], s26 offen sc1
  s_waitcnt vmcnt(0)
  v_cmp_eq_u32 vcc, -1, v8
  s_nop 1
  s_cbranch_vccz L_wg4
  s_sleep 2
  s_branch L_wp4
L_wg4:
  s_mov_b64 exec, -1
L_wf4:
  s_barrier
  buffer_load_dword v7, v6, s[12:15], s25 offen sc1
  s_add_u32 s26, s25, 8192
  s_mov_b32 exec_lo, 0xffff
  s_mov_b32 exec_hi, 0
  buffer_load_dword v7, v6, s[12:15], s26 offen sc1
  s_mov_b64 exec, -1
  s_add_u32 s25, s25, 20480
  s_endpgm
L_exit:
  s_endpgm
.section .rodata,"a"
.p2align 6
.amdhsa_kernel concat_heads__ssm_conv_s5__softmax_full_mha__prompt_kernel
  .amdhsa_next_free_vgpr 256
  .amdhsa_next_free_sgpr 102
  .amdhsa_accum_offset 256
  .amdhsa_group_segment_fixed_size 0
  .amdhsa_kernarg_size 120
  .amdhsa_user_sgpr_count 2
  .amdhsa_user_sgpr_kernarg_segment_ptr 1
  .amdhsa_system_sgpr_workgroup_id_x 1
.end_amdhsa_kernel
```
